```python
import torch

def _softmax(x, axis=-1):
    return torch.softmax(x, dim=axis)
def _gelu(x):
    return torch.nn.functional.gelu(x, approximate="tanh")
def _silu(x):
    return torch.nn.functional.silu(x)
def _sigmoid(x):
    return torch.sigmoid(x)
def _layernorm(x, axis=-1, eps=1e-5):
    m = x.mean(dim=axis, keepdim=True)
    v = x.var(dim=axis, keepdim=True, unbiased=False)
    return (x - m) / torch.sqrt(v + eps)
def _scatter_add(tgt, idx, src, axis=0):
    return tgt.clone().index_add_(axis, idx, src)
def _segment_sum(src, seg, n):
    out = torch.zeros((n,) + src.shape[1:], dtype=src.dtype)
    return out.index_add_(0, seg, src)
def _pad(x, pw):
    flat = tuple(v for pair in reversed(pw) for v in pair)
    return torch.nn.functional.pad(x, flat)

kernel_name = 'gated_mix__sliding_block__mixer_s_mlp__prompt'

def setup_inputs():

    _w = (lambda a: (lambda t: t.to(torch.bfloat16) if t.is_floating_point() else t)(torch.as_tensor(a)))
    def _A_setup():
        B, S, D = 1, 2048, 448
        return {
            "x": _w((lambda *s: torch.randn(*s, dtype=torch.bfloat16) * 0.05)(B, S, D)),
            "wqkv": _w((lambda *s: torch.randn(*s, dtype=torch.bfloat16) * 3.2)(D, 3 * D)),
            "wo": _w((lambda *s: torch.randn(*s, dtype=torch.bfloat16) * 0.05)(D, D)),
        }
    _A_in = _A_setup()

    def _B_setup():
        B, S, D, F = 1, 2048, 448, 1792
        return {
            "x":  _w((lambda *s: torch.randn(*s, dtype=torch.bfloat16) * 0.05)(B, S, D)),
            "w1": _w((lambda *s: torch.randn(*s, dtype=torch.bfloat16) * 3.2)(D, D) * (D ** -0.5)),
            "w2": _w((lambda *s: torch.randn(*s, dtype=torch.bfloat16) * 3.2)(D, D) * (D ** -0.5)),
            "w3": _w((lambda *s: torch.randn(*s, dtype=torch.bfloat16) * 3.2)(D, F) * (D ** -0.5)),
            "w4": _w((lambda *s: torch.randn(*s, dtype=torch.bfloat16) * 3.2)(F, D) * (F ** -0.5)),
        }
    _B_in = _B_setup()

    return {
        "A_x": _A_in["x"],
        "A_wqkv": _A_in["wqkv"],
        "A_wo": _A_in["wo"],
        "B_x": _B_in["x"],
        "B_w1": _B_in["w1"],
        "B_w2": _B_in["w2"],
        "B_w3": _B_in["w3"],
        "B_w4": _B_in["w4"],
        "gate_w": _w((lambda *s: torch.randn(*s, dtype=torch.bfloat16) * 0.05)(448) * 16.0),
    }

def reference(A_x, A_wqkv, A_wo, B_x, B_w1, B_w2, B_w3, B_w4, gate_w):
    def _A_ref(x, wqkv, wo):
        B, S, D = x.shape
        H = 16; Dh = D // H; W = 256
        qkv = (lambda x, *d: x.permute(*d))((x @ wqkv).reshape(B, S, 3, H, Dh), 2, 0, 3, 1, 4)
        q, k, v = qkv[0], qkv[1], qkv[2]
        scores = torch.einsum("bhqd,bhkd->bhqk", q, k) * (Dh ** -0.5)
        idx = torch.arange(S)
        mask = (idx[:, None] - idx[None, :] >= 0) & (idx[:, None] - idx[None, :] < W)
        scores = torch.where(mask[None, None], scores, -1e9)
        p = _softmax(scores, axis=-1)
        o = torch.einsum("bhqk,bhkd->bhqd", p, v)
        return (lambda x, *d: x.permute(*d))(o, 0, 2, 1, 3).reshape(B, S, D) @ wo

    def _B_ref(x, w1, w2, w3, w4):
        B, S, D = x.shape
        h = _gelu(_layernorm(x, axis=-1) @ w1)
        c = D // 4
        g0 = _pad(h[:, :, 0*c:1*c], ((0, 0), (1, 0), (0, 0)))[:, :S, :]
        g1 = _pad(h[:, :, 1*c:2*c], ((0, 0), (0, 1), (0, 0)))[:, 1:, :]
        g2 = _pad(h[:, :, 2*c:3*c], ((0, 0), (2, 0), (0, 0)))[:, :S, :]
        g3 = _pad(h[:, :, 3*c:   ], ((0, 0), (0, 2), (0, 0)))[:, 2:, :]
        hs = torch.concatenate([g0, g1, g2, g3], axis=-1) @ w2
        x1 = x + hs
        h2 = _gelu(_layernorm(x1, axis=-1) @ w3) @ w4
        return x1 + h2

    x = A_x
    g = _sigmoid((x * gate_w).sum(-1, keepdims=True))
    a = _A_ref(x, A_wqkv, A_wo)
    b = _B_ref(x, B_w1, B_w2, B_w3, B_w4)
    return g * a + (1 - g) * b
```

```asm
; @launch grid=(256,1,1) block=(512,1,1) lds=163840
.amdgcn_target "amdgcn-amd-amdhsa--gfx950"
.text
.globl gated_mix__sliding_block__mixer_s_mlp__prompt_kernel
.p2align 8
.type gated_mix__sliding_block__mixer_s_mlp__prompt_kernel,@function
gated_mix__sliding_block__mixer_s_mlp__prompt_kernel:
    s_cmp_ge_u32 s2, 256
    s_cbranch_scc1 L_end
    s_load_dwordx16 s[64:79], s[0:1], 0
    s_load_dwordx8 s[80:87], s[0:1], 64
    v_and_b32 v1, 63, v0
    v_lshrrev_b32 v6, 6, v0
    v_and_b32 v2, 15, v0
    v_readfirstlane_b32 s3, v6
    v_bfe_u32 v3, v0, 4, 2
    v_lshlrev_b32 v4, 4, v1
    s_and_b32 s31, s2, 7
    s_lshr_b32 s30, s2, 3
    s_lshl_b32 s24, s31, 1
    s_and_b32 s32, s30, 1
    s_add_u32 s24, s24, s32
    s_lshr_b32 s25, s30, 1
    s_mov_b32 s28, s25
    s_lshl_b32 s26, s31, 2
    s_and_b32 s32, s30, 3
    s_add_u32 s26, s26, s32
    s_lshr_b32 s27, s30, 2
    s_waitcnt lgkmcnt(0)
    s_mov_b32 s12, s86
    s_mov_b32 s13, s87
    s_mov_b32 s14, 0x1600000
    s_mov_b32 s15, 0x00020000
    s_mov_b32 s16, s84
    s_mov_b32 s17, s85
    s_mov_b32 s18, 0x100
    s_mov_b32 s19, 0x00020000
    s_add_u32 s32, s86, 0x1486000
    s_addc_u32 s33, s87, 0
    s_load_dword s29, s[32:33], 0
    s_cmp_ge_u32 s30, 28
    s_cbranch_scc1 L_spare
    s_mov_b32 s4, s64
    s_mov_b32 s5, s65
    s_mov_b32 s6, 0x1c0000
    s_mov_b32 s7, 0x00020000
    s_mul_i32 s32, s25, 192
    s_lshl_b32 s33, s25, 6
    s_lshl_b32 s34, s24, 7
    s_lshl_b32 s35, s3, 4
    s_add_u32 s34, s34, s35
    v_lshrrev_b32 v6, 3, v1
    v_and_b32 v7, 7, v1
    v_xor_b32 v7, v7, v6
    v_add_u32 v6, s34, v6
    v_mul_u32_u24 v168, 896, v6
    v_lshl_add_u32 v168, v7, 4, v168
    s_mul_i32 s36, s3, 6144
    s_lshl_b32 s48, s3, 11
    s_add_u32 s48, s48, 98304
    s_mul_i32 s37, s24, 3
    s_add_u32 s37, s37, s25
    s_mul_i32 s38, s37, 9363
    s_lshr_b32 s38, s38, 16
    s_mul_i32 s38, s38, 7
    s_sub_u32 s56, s37, s38
    s_add_u32 s57, s56, 1
    s_cmp_eq_u32 s57, 7
    s_cselect_b32 s57, 0, s57
    s_add_u32 s58, s57, 1
    s_cmp_eq_u32 s58, 7
    s_cselect_b32 s58, 0, s58
    s_add_u32 s59, s58, 1
    s_cmp_eq_u32 s59, 7
    s_cselect_b32 s59, 0, s59
    s_add_u32 s60, s59, 1
    s_cmp_eq_u32 s60, 7
    s_cselect_b32 s60, 0, s60
    s_add_u32 s61, s60, 1
    s_cmp_eq_u32 s61, 7
    s_cselect_b32 s61, 0, s61
    s_add_u32 s62, s61, 1
    s_cmp_eq_u32 s62, 7
    s_cselect_b32 s62, 0, s62
    s_cmp_ge_u32 s3, 6
    s_cbranch_scc1 Lroleh_1
    s_add_u32 s8, s66, s32
    s_addc_u32 s9, s67, 0
    s_sub_u32 s10, 0x126000, s32
    s_mov_b32 s11, 0x00020000
    s_cmp_ge_u32 s3, 3
    s_cselect_b32 s42, 1, 0
    s_mul_i32 s43, s42, 3
    s_sub_u32 s43, s3, s43
    s_lshl_b32 s44, s43, 6
    v_add_u32 v6, s44, v1
    v_mul_u32_u24 v7, 5462, v6
    v_lshrrev_b32 v7, 16, v7
    v_mul_u32_u24 v8, 12, v7
    v_sub_u32 v6, v6, v8
    v_bfe_u32 v8, v7, 2, 1
    v_lshlrev_b32 v8, 1, v8
    v_xor_b32 v6, v6, v8
    v_lshrrev_b32 v8, 2, v7
    v_lshlrev_b32 v8, 3, v8
    v_and_b32 v7, 3, v7
    s_lshl_b32 s44, s42, 2
    v_add3_u32 v8, v8, v7, s44
    v_mul_u32_u24 v169, 2688, v8
    v_lshl_add_u32 v169, v6, 4, v169
    s_mul_i32 s39, s42, 3072
    s_lshl_b32 s44, s43, 10
    s_add_u32 s39, s39, s44
    s_add_u32 s39, s39, 77824
    s_movk_i32 s40, 6144
    s_mov_b32 s41, 86016
    s_add_u32 s37, s36, 0
    s_mov_b32 m0, s37
    s_lshl_b32 s38, s56, 7
    buffer_load_dwordx4 v168, s[4:7], s38 offen lds
    s_add_u32 s37, s36, 1024
    s_mov_b32 m0, s37
    s_lshl_b32 s38, s56, 7
    s_add_u32 s38, s38, 7168
    buffer_load_dwordx4 v168, s[4:7], s38 offen lds
    s_add_u32 s37, s36, 2048
    s_mov_b32 m0, s37
    s_lshl_b32 s38, s57, 7
    buffer_load_dwordx4 v168, s[4:7], s38 offen lds
    s_add_u32 s37, s36, 3072
    s_mov_b32 m0, s37
    s_lshl_b32 s38, s57, 7
    s_add_u32 s38, s38, 7168
    buffer_load_dwordx4 v168, s[4:7], s38 offen lds
    s_add_u32 s37, s36, 4096
    s_mov_b32 m0, s37
    s_lshl_b32 s38, s58, 7
    buffer_load_dwordx4 v168, s[4:7], s38 offen lds
    s_add_u32 s37, s36, 5120
    s_mov_b32 m0, s37
    s_lshl_b32 s38, s58, 7
    s_add_u32 s38, s38, 7168
    buffer_load_dwordx4 v168, s[4:7], s38 offen lds
    s_add_u32 s37, s48, 0
    s_mov_b32 m0, s37
    s_lshl_b32 s38, s59, 7
    buffer_load_dwordx4 v168, s[4:7], s38 offen lds
    s_add_u32 s37, s48, 1024
    s_mov_b32 m0, s37
    s_lshl_b32 s38, s59, 7
    s_add_u32 s38, s38, 7168
    buffer_load_dwordx4 v168, s[4:7], s38 offen lds
    v_add_u32 v178, s34, v2
    v_and_b32 v6, 7, v2
    v_xor_b32 v6, v6, v3
    v_lshlrev_b32 v6, 4, v6
    v_lshl_add_u32 v6, v2, 7, v6
    v_add_u32 v170, s36, v6
    v_xor_b32 v171, 64, v170
    v_add_u32 v179, s48, v6
    v_xor_b32 v180, 64, v179
    v_lshrrev_b32 v6, 2, v2
    v_lshl_add_u32 v6, v3, 2, v6
    v_and_b32 v7, 3, v2
    v_lshlrev_b32 v7, 3, v7
    v_and_b32 v8, 1, v3
    v_lshlrev_b32 v8, 5, v8
    v_lshl_add_u32 v9, v6, 6, v7
    v_add_u32 v9, 49152, v9
    v_add_u32 v172, v9, v8
    v_xor_b32 v10, 32, v8
    v_add_u32 v173, v9, v10
    v_mul_u32_u24 v9, 192, v6
    v_add3_u32 v174, v9, v7, v8
    v_add3_u32 v175, v9, v7, v10
    v_add_u32 v174, 77824, v174
    v_add_u32 v175, 77824, v175
    v_add_u32 v176, 43008, v174
    v_add_u32 v177, 43008, v175
    v_mov_b32 v184, 0x3f803f80
    v_mov_b32 v185, 0x3f803f80
    v_mov_b32 v186, 0x3f803f80
    v_mov_b32 v187, 0x3f803f80
    s_waitcnt vmcnt(6)
    s_barrier
    ds_read_b128 v[16:19], v170 offset:0
    ds_read_b128 v[20:23], v171 offset:0
    ds_read_b64_tr_b16 v[104:105], v172 offset:0
    ds_read_b64_tr_b16 v[106:107], v172 offset:1024
    ds_read_b64_tr_b16 v[108:109], v173 offset:0
    ds_read_b64_tr_b16 v[110:111], v173 offset:1024
    ds_read_b64_tr_b16 v[112:113], v172 offset:2048
    ds_read_b64_tr_b16 v[114:115], v172 offset:3072
    ds_read_b64_tr_b16 v[116:117], v173 offset:2048
    ds_read_b64_tr_b16 v[118:119], v173 offset:3072
    s_add_u32 s37, s48, 16384
    s_mov_b32 m0, s37
    s_lshl_b32 s38, s60, 7
    buffer_load_dwordx4 v168, s[4:7], s38 offen lds
    s_add_u32 s37, s48, 17408
    s_mov_b32 m0, s37
    s_lshl_b32 s38, s60, 7
    s_add_u32 s38, s38, 7168
    buffer_load_dwordx4 v168, s[4:7], s38 offen lds
    s_waitcnt lgkmcnt(8)
    v_mfma_f32_16x16x32_bf16 v[80:83], v[184:187], v[16:19], 0
    v_mfma_f32_16x16x32_bf16 v[84:87], v[16:19], v[16:19], 0
    v_mfma_f32_16x16x32_bf16 v[80:83], v[184:187], v[20:23], v[80:83]
    v_mfma_f32_16x16x32_bf16 v[84:87], v[20:23], v[20:23], v[84:87]
    s_waitcnt lgkmcnt(4)
    v_mfma_f32_16x16x32_bf16 v[72:75], v[104:107], v[16:19], 0
    v_mfma_f32_16x16x32_bf16 v[76:79], v[108:111], v[16:19], 0
    v_mfma_f32_16x16x32_bf16 v[88:91], v[104:107], v[184:187], 0
    v_mfma_f32_16x16x32_bf16 v[92:95], v[108:111], v[184:187], 0
    s_waitcnt lgkmcnt(0)
    v_mfma_f32_16x16x32_bf16 v[72:75], v[112:115], v[20:23], v[72:75]
    v_mfma_f32_16x16x32_bf16 v[76:79], v[116:119], v[20:23], v[76:79]
    v_mfma_f32_16x16x32_bf16 v[88:91], v[112:115], v[184:187], v[88:91]
    v_mfma_f32_16x16x32_bf16 v[92:95], v[116:119], v[184:187], v[92:95]
    s_waitcnt vmcnt(6)
    s_barrier
    ds_read_b128 v[24:27], v170 offset:2048
    ds_read_b128 v[28:31], v171 offset:2048
    ds_read_b64_tr_b16 v[104:105], v172 offset:4096
    ds_read_b64_tr_b16 v[106:107], v172 offset:5120
    ds_read_b64_tr_b16 v[108:109], v173 offset:4096
    ds_read_b64_tr_b16 v[110:111], v173 offset:5120
    ds_read_b64_tr_b16 v[112:113], v172 offset:6144
    ds_read_b64_tr_b16 v[114:115], v172 offset:7168
    ds_read_b64_tr_b16 v[116:117], v173 offset:6144
    ds_read_b64_tr_b16 v[118:119], v173 offset:7168
    s_add_u32 s37, s48, 32768
    s_mov_b32 m0, s37
    s_lshl_b32 s38, s61, 7
    buffer_load_dwordx4 v168, s[4:7], s38 offen lds
    s_add_u32 s37, s48, 33792
    s_mov_b32 m0, s37
    s_lshl_b32 s38, s61, 7
    s_add_u32 s38, s38, 7168
    buffer_load_dwordx4 v168, s[4:7], s38 offen lds
    s_waitcnt lgkmcnt(8)
    v_mfma_f32_16x16x32_bf16 v[80:83], v[184:187], v[24:27], v[80:83]
    v_mfma_f32_16x16x32_bf16 v[84:87], v[24:27], v[24:27], v[84:87]
    v_mfma_f32_16x16x32_bf16 v[80:83], v[184:187], v[28:31], v[80:83]
    v_mfma_f32_16x16x32_bf16 v[84:87], v[28:31], v[28:31], v[84:87]
    s_waitcnt lgkmcnt(4)
    v_mfma_f32_16x16x32_bf16 v[72:75], v[104:107], v[24:27], v[72:75]
    v_mfma_f32_16x16x32_bf16 v[76:79], v[108:111], v[24:27], v[76:79]
    v_mfma_f32_16x16x32_bf16 v[88:91], v[104:107], v[184:187], v[88:91]
    v_mfma_f32_16x16x32_bf16 v[92:95], v[108:111], v[184:187], v[92:95]
    s_waitcnt lgkmcnt(0)
    v_mfma_f32_16x16x32_bf16 v[72:75], v[112:115], v[28:31], v[72:75]
    v_mfma_f32_16x16x32_bf16 v[76:79], v[116:119], v[28:31], v[76:79]
    v_mfma_f32_16x16x32_bf16 v[88:91], v[112:115], v[184:187], v[88:91]
    v_mfma_f32_16x16x32_bf16 v[92:95], v[116:119], v[184:187], v[92:95]
    s_waitcnt vmcnt(6)
    s_barrier
    ds_read_b128 v[32:35], v170 offset:4096
    ds_read_b128 v[36:39], v171 offset:4096
    ds_read_b64_tr_b16 v[104:105], v172 offset:8192
    ds_read_b64_tr_b16 v[106:107], v172 offset:9216
    ds_read_b64_tr_b16 v[108:109], v173 offset:8192
    ds_read_b64_tr_b16 v[110:111], v173 offset:9216
    ds_read_b64_tr_b16 v[112:113], v172 offset:10240
    ds_read_b64_tr_b16 v[114:115], v172 offset:11264
    ds_read_b64_tr_b16 v[116:117], v173 offset:10240
    ds_read_b64_tr_b16 v[118:119], v173 offset:11264
    s_add_u32 s37, s48, 49152
    s_mov_b32 m0, s37
    s_lshl_b32 s38, s62, 7
    buffer_load_dwordx4 v168, s[4:7], s38 offen lds
    s_add_u32 s37, s48, 50176
    s_mov_b32 m0, s37
    s_lshl_b32 s38, s62, 7
    s_add_u32 s38, s38, 7168
    buffer_load_dwordx4 v168, s[4:7], s38 offen lds
    s_waitcnt lgkmcnt(8)
    v_mfma_f32_16x16x32_bf16 v[80:83], v[184:187], v[32:35], v[80:83]
    v_mfma_f32_16x16x32_bf16 v[84:87], v[32:35], v[32:35], v[84:87]
    v_mfma_f32_16x16x32_bf16 v[80:83], v[184:187], v[36:39], v[80:83]
    v_mfma_f32_16x16x32_bf16 v[84:87], v[36:39], v[36:39], v[84:87]
    s_waitcnt lgkmcnt(4)
    v_mfma_f32_16x16x32_bf16 v[72:75], v[104:107], v[32:35], v[72:75]
    v_mfma_f32_16x16x32_bf16 v[76:79], v[108:111], v[32:35], v[76:79]
    v_mfma_f32_16x16x32_bf16 v[88:91], v[104:107], v[184:187], v[88:91]
    v_mfma_f32_16x16x32_bf16 v[92:95], v[108:111], v[184:187], v[92:95]
    s_waitcnt lgkmcnt(0)
    v_mfma_f32_16x16x32_bf16 v[72:75], v[112:115], v[36:39], v[72:75]
    v_mfma_f32_16x16x32_bf16 v[76:79], v[116:119], v[36:39], v[76:79]
    v_mfma_f32_16x16x32_bf16 v[88:91], v[112:115], v[184:187], v[88:91]
    v_mfma_f32_16x16x32_bf16 v[92:95], v[116:119], v[184:187], v[92:95]
    s_waitcnt vmcnt(6)
    s_barrier
    ds_read_b128 v[40:43], v179 offset:0
    ds_read_b128 v[44:47], v180 offset:0
    ds_read_b64_tr_b16 v[104:105], v172 offset:12288
    ds_read_b64_tr_b16 v[106:107], v172 offset:13312
    ds_read_b64_tr_b16 v[108:109], v173 offset:12288
    ds_read_b64_tr_b16 v[110:111], v173 offset:13312
    ds_read_b64_tr_b16 v[112:113], v172 offset:14336
    ds_read_b64_tr_b16 v[114:115], v172 offset:15360
    ds_read_b64_tr_b16 v[116:117], v173 offset:14336
    ds_read_b64_tr_b16 v[118:119], v173 offset:15360
    s_mul_i32 s37, s40, 0
    s_add_u32 s37, s37, s39
    s_mov_b32 m0, s37
    s_lshl_b32 s38, s56, 1
    s_mul_i32 s38, s38, s41
    buffer_load_dwordx4 v169, s[8:11], s38 offen lds
    s_mul_i32 s37, s40, 1
    s_add_u32 s37, s37, s39
    s_mov_b32 m0, s37
    s_lshl_b32 s38, s56, 1
    s_add_u32 s38, s38, 1
    s_mul_i32 s38, s38, s41
    buffer_load_dwordx4 v169, s[8:11], s38 offen lds
    s_mul_i32 s37, s40, 2
    s_add_u32 s37, s37, s39
    s_mov_b32 m0, s37
    s_lshl_b32 s38, s57, 1
    s_mul_i32 s38, s38, s41
    buffer_load_dwordx4 v169, s[8:11], s38 offen lds
    s_waitcnt lgkmcnt(8)
    v_mfma_f32_16x16x32_bf16 v[80:83], v[184:187], v[40:43], v[80:83]
    v_mfma_f32_16x16x32_bf16 v[84:87], v[40:43], v[40:43], v[84:87]
    v_mfma_f32_16x16x32_bf16 v[80:83], v[184:187], v[44:47], v[80:83]
    v_mfma_f32_16x16x32_bf16 v[84:87], v[44:47], v[44:47], v[84:87]
    s_waitcnt lgkmcnt(4)
    v_mfma_f32_16x16x32_bf16 v[72:75], v[104:107], v[40:43], v[72:75]
    v_mfma_f32_16x16x32_bf16 v[76:79], v[108:111], v[40:43], v[76:79]
    v_mfma_f32_16x16x32_bf16 v[88:91], v[104:107], v[184:187], v[88:91]
    v_mfma_f32_16x16x32_bf16 v[92:95], v[108:111], v[184:187], v[92:95]
    s_waitcnt lgkmcnt(0)
    v_mfma_f32_16x16x32_bf16 v[72:75], v[112:115], v[44:47], v[72:75]
    v_mfma_f32_16x16x32_bf16 v[76:79], v[116:119], v[44:47], v[76:79]
    v_mfma_f32_16x16x32_bf16 v[88:91], v[112:115], v[184:187], v[88:91]
    v_mfma_f32_16x16x32_bf16 v[92:95], v[116:119], v[184:187], v[92:95]
    s_waitcnt vmcnt(7)
    s_barrier
    ds_read_b128 v[48:51], v179 offset:16384
    ds_read_b128 v[52:55], v180 offset:16384
    ds_read_b64_tr_b16 v[104:105], v172 offset:16384
    ds_read_b64_tr_b16 v[106:107], v172 offset:17408
    ds_read_b64_tr_b16 v[108:109], v173 offset:16384
    ds_read_b64_tr_b16 v[110:111], v173 offset:17408
    ds_read_b64_tr_b16 v[112:113], v172 offset:18432
    ds_read_b64_tr_b16 v[114:115], v172 offset:19456
    ds_read_b64_tr_b16 v[116:117], v173 offset:18432
    ds_read_b64_tr_b16 v[118:119], v173 offset:19456
    s_mul_i32 s37, s40, 3
    s_add_u32 s37, s37, s39
    s_mov_b32 m0, s37
    s_lshl_b32 s38, s57, 1
    s_add_u32 s38, s38, 1
    s_mul_i32 s38, s38, s41
    buffer_load_dwordx4 v169, s[8:11], s38 offen lds
    s_mul_i32 s37, s40, 4
    s_add_u32 s37, s37, s39
    s_mov_b32 m0, s37
    s_lshl_b32 s38, s58, 1
    s_mul_i32 s38, s38, s41
    buffer_load_dwordx4 v169, s[8:11], s38 offen lds
    s_mul_i32 s37, s40, 5
    s_add_u32 s37, s37, s39
    s_mov_b32 m0, s37
    s_lshl_b32 s38, s58, 1
    s_add_u32 s38, s38, 1
    s_mul_i32 s38, s38, s41
    buffer_load_dwordx4 v169, s[8:11], s38 offen lds
    s_waitcnt lgkmcnt(8)
    v_mfma_f32_16x16x32_bf16 v[80:83], v[184:187], v[48:51], v[80:83]
    v_mfma_f32_16x16x32_bf16 v[84:87], v[48:51], v[48:51], v[84:87]
    v_mfma_f32_16x16x32_bf16 v[80:83], v[184:187], v[52:55], v[80:83]
    v_mfma_f32_16x16x32_bf16 v[84:87], v[52:55], v[52:55], v[84:87]
    s_waitcnt lgkmcnt(4)
    v_mfma_f32_16x16x32_bf16 v[72:75], v[104:107], v[48:51], v[72:75]
    v_mfma_f32_16x16x32_bf16 v[76:79], v[108:111], v[48:51], v[76:79]
    v_mfma_f32_16x16x32_bf16 v[88:91], v[104:107], v[184:187], v[88:91]
    v_mfma_f32_16x16x32_bf16 v[92:95], v[108:111], v[184:187], v[92:95]
    s_waitcnt lgkmcnt(0)
    v_mfma_f32_16x16x32_bf16 v[72:75], v[112:115], v[52:55], v[72:75]
    v_mfma_f32_16x16x32_bf16 v[76:79], v[116:119], v[52:55], v[76:79]
    v_mfma_f32_16x16x32_bf16 v[88:91], v[112:115], v[184:187], v[88:91]
    v_mfma_f32_16x16x32_bf16 v[92:95], v[116:119], v[184:187], v[92:95]
    s_waitcnt vmcnt(8)
    s_barrier
    ds_read_b128 v[56:59], v179 offset:32768
    ds_read_b128 v[60:63], v180 offset:32768
    ds_read_b64_tr_b16 v[104:105], v172 offset:20480
    ds_read_b64_tr_b16 v[106:107], v172 offset:21504
    ds_read_b64_tr_b16 v[108:109], v173 offset:20480
    ds_read_b64_tr_b16 v[110:111], v173 offset:21504
    ds_read_b64_tr_b16 v[112:113], v172 offset:22528
    ds_read_b64_tr_b16 v[114:115], v172 offset:23552
    ds_read_b64_tr_b16 v[116:117], v173 offset:22528
    ds_read_b64_tr_b16 v[118:119], v173 offset:23552
    s_mul_i32 s37, s40, 6
    s_add_u32 s37, s37, s39
    s_mov_b32 m0, s37
    s_lshl_b32 s38, s59, 1
    s_mul_i32 s38, s38, s41
    buffer_load_dwordx4 v169, s[8:11], s38 offen lds
    s_mul_i32 s37, s40, 7
    s_add_u32 s37, s37, s39
    s_mov_b32 m0, s37
    s_lshl_b32 s38, s59, 1
    s_add_u32 s38, s38, 1
    s_mul_i32 s38, s38, s41
    buffer_load_dwordx4 v169, s[8:11], s38 offen lds
    s_waitcnt lgkmcnt(8)
    v_mfma_f32_16x16x32_bf16 v[80:83], v[184:187], v[56:59], v[80:83]
    v_mfma_f32_16x16x32_bf16 v[84:87], v[56:59], v[56:59], v[84:87]
    v_mfma_f32_16x16x32_bf16 v[80:83], v[184:187], v[60:63], v[80:83]
    v_mfma_f32_16x16x32_bf16 v[84:87], v[60:63], v[60:63], v[84:87]
    s_waitcnt lgkmcnt(4)
    v_mfma_f32_16x16x32_bf16 v[72:75], v[104:107], v[56:59], v[72:75]
    v_mfma_f32_16x16x32_bf16 v[76:79], v[108:111], v[56:59], v[76:79]
    v_mfma_f32_16x16x32_bf16 v[88:91], v[104:107], v[184:187], v[88:91]
    v_mfma_f32_16x16x32_bf16 v[92:95], v[108:111], v[184:187], v[92:95]
    s_waitcnt lgkmcnt(0)
    v_mfma_f32_16x16x32_bf16 v[72:75], v[112:115], v[60:63], v[72:75]
    v_mfma_f32_16x16x32_bf16 v[76:79], v[116:119], v[60:63], v[76:79]
    v_mfma_f32_16x16x32_bf16 v[88:91], v[112:115], v[184:187], v[88:91]
    v_mfma_f32_16x16x32_bf16 v[92:95], v[116:119], v[184:187], v[92:95]
    s_waitcnt vmcnt(8)
    s_barrier
    ds_read_b128 v[64:67], v179 offset:49152
    ds_read_b128 v[68:71], v180 offset:49152
    ds_read_b64_tr_b16 v[104:105], v172 offset:24576
    ds_read_b64_tr_b16 v[106:107], v172 offset:25600
    ds_read_b64_tr_b16 v[108:109], v173 offset:24576
    ds_read_b64_tr_b16 v[110:111], v173 offset:25600
    ds_read_b64_tr_b16 v[112:113], v172 offset:26624
    ds_read_b64_tr_b16 v[114:115], v172 offset:27648
    ds_read_b64_tr_b16 v[116:117], v173 offset:26624
    ds_read_b64_tr_b16 v[118:119], v173 offset:27648
    s_mul_i32 s37, s40, 8
    s_add_u32 s37, s37, s39
    s_mov_b32 m0, s37
    s_lshl_b32 s38, s60, 1
    s_mul_i32 s38, s38, s41
    buffer_load_dwordx4 v169, s[8:11], s38 offen lds
    s_mul_i32 s37, s40, 9
    s_add_u32 s37, s37, s39
    s_mov_b32 m0, s37
    s_lshl_b32 s38, s60, 1
    s_add_u32 s38, s38, 1
    s_mul_i32 s38, s38, s41
    buffer_load_dwordx4 v169, s[8:11], s38 offen lds
    s_mul_i32 s37, s40, 10
    s_add_u32 s37, s37, s39
    s_mov_b32 m0, s37
    s_lshl_b32 s38, s61, 1
    s_mul_i32 s38, s38, s41
    buffer_load_dwordx4 v169, s[8:11], s38 offen lds
    s_waitcnt lgkmcnt(8)
    v_mfma_f32_16x16x32_bf16 v[80:83], v[184:187], v[64:67], v[80:83]
    v_mfma_f32_16x16x32_bf16 v[84:87], v[64:67], v[64:67], v[84:87]
    v_mfma_f32_16x16x32_bf16 v[80:83], v[184:187], v[68:71], v[80:83]
    v_mfma_f32_16x16x32_bf16 v[84:87], v[68:71], v[68:71], v[84:87]
    s_waitcnt lgkmcnt(4)
    v_mfma_f32_16x16x32_bf16 v[72:75], v[104:107], v[64:67], v[72:75]
    v_mfma_f32_16x16x32_bf16 v[76:79], v[108:111], v[64:67], v[76:79]
    v_mfma_f32_16x16x32_bf16 v[88:91], v[104:107], v[184:187], v[88:91]
    v_mfma_f32_16x16x32_bf16 v[92:95], v[108:111], v[184:187], v[92:95]
    s_waitcnt lgkmcnt(0)
    v_mfma_f32_16x16x32_bf16 v[72:75], v[112:115], v[68:71], v[72:75]
    v_mfma_f32_16x16x32_bf16 v[76:79], v[116:119], v[68:71], v[76:79]
    v_mfma_f32_16x16x32_bf16 v[88:91], v[112:115], v[184:187], v[88:91]
    v_mfma_f32_16x16x32_bf16 v[92:95], v[116:119], v[184:187], v[92:95]
    s_branch Lp1join_2
Lroleh_1:
    s_add_u32 s8, s72, s33
    s_addc_u32 s9, s73, 0
    s_sub_u32 s10, 0x62000, s33
    s_mov_b32 s11, 0x00020000
    s_sub_u32 s42, s3, 6
    v_lshrrev_b32 v7, 2, v1
    v_and_b32 v6, 3, v1
    v_bfe_u32 v8, v7, 2, 1
    v_lshlrev_b32 v8, 1, v8
    v_xor_b32 v6, v6, v8
    v_lshrrev_b32 v8, 2, v7
    v_lshlrev_b32 v8, 3, v8
    v_and_b32 v7, 3, v7
    s_lshl_b32 s44, s42, 2
    v_add3_u32 v8, v8, v7, s44
    v_mul_u32_u24 v169, 896, v8
    v_lshl_add_u32 v169, v6, 4, v169
    s_lshl_b32 s39, s42, 10
    s_add_u32 s39, s39, 49152
    s_movk_i32 s40, 2048
    s_mov_b32 s41, 28672
    s_mul_i32 s37, s40, 0
    s_add_u32 s37, s37, s39
    s_mov_b32 m0, s37
    s_lshl_b32 s38, s56, 1
    s_mul_i32 s38, s38, s41
    buffer_load_dwordx4 v169, s[8:11], s38 offen lds
    s_mul_i32 s37, s40, 1
    s_add_u32 s37, s37, s39
    s_mov_b32 m0, s37
    s_lshl_b32 s38, s56, 1
    s_add_u32 s38, s38, 1
    s_mul_i32 s38, s38, s41
    buffer_load_dwordx4 v169, s[8:11], s38 offen lds
    s_add_u32 s37, s36, 0
    s_mov_b32 m0, s37
    s_lshl_b32 s38, s56, 7
    buffer_load_dwordx4 v168, s[4:7], s38 offen lds
    s_add_u32 s37, s36, 1024
    s_mov_b32 m0, s37
    s_lshl_b32 s38, s56, 7
    s_add_u32 s38, s38, 7168
    buffer_load_dwordx4 v168, s[4:7], s38 offen lds
    s_mul_i32 s37, s40, 2
    s_add_u32 s37, s37, s39
    s_mov_b32 m0, s37
    s_lshl_b32 s38, s57, 1
    s_mul_i32 s38, s38, s41
    buffer_load_dwordx4 v169, s[8:11], s38 offen lds
    s_mul_i32 s37, s40, 3
    s_add_u32 s37, s37, s39
    s_mov_b32 m0, s37
    s_lshl_b32 s38, s57, 1
    s_add_u32 s38, s38, 1
    s_mul_i32 s38, s38, s41
    buffer_load_dwordx4 v169, s[8:11], s38 offen lds
    s_add_u32 s37, s36, 2048
    s_mov_b32 m0, s37
    s_lshl_b32 s38, s57, 7
    buffer_load_dwordx4 v168, s[4:7], s38 offen lds
    s_add_u32 s37, s36, 3072
    s_mov_b32 m0, s37
    s_lshl_b32 s38, s57, 7
    s_add_u32 s38, s38, 7168
    buffer_load_dwordx4 v168, s[4:7], s38 offen lds
    s_mul_i32 s37, s40, 4
    s_add_u32 s37, s37, s39
    s_mov_b32 m0, s37
    s_lshl_b32 s38, s58, 1
    s_mul_i32 s38, s38, s41
    buffer_load_dwordx4 v169, s[8:11], s38 offen lds
    s_mul_i32 s37, s40, 5
    s_add_u32 s37, s37, s39
    s_mov_b32 m0, s37
    s_lshl_b32 s38, s58, 1
    s_add_u32 s38, s38, 1
    s_mul_i32 s38, s38, s41
    buffer_load_dwordx4 v169, s[8:11], s38 offen lds
    s_add_u32 s37, s36, 4096
    s_mov_b32 m0, s37
    s_lshl_b32 s38, s58, 7
    buffer_load_dwordx4 v168, s[4:7], s38 offen lds
    s_add_u32 s37, s36, 5120
    s_mov_b32 m0, s37
    s_lshl_b32 s38, s58, 7
    s_add_u32 s38, s38, 7168
    buffer_load_dwordx4 v168, s[4:7], s38 offen lds
    s_mul_i32 s37, s40, 6
    s_add_u32 s37, s37, s39
    s_mov_b32 m0, s37
    s_lshl_b32 s38, s59, 1
    s_mul_i32 s38, s38, s41
    buffer_load_dwordx4 v169, s[8:11], s38 offen lds
    s_mul_i32 s37, s40, 7
    s_add_u32 s37, s37, s39
    s_mov_b32 m0, s37
    s_lshl_b32 s38, s59, 1
    s_add_u32 s38, s38, 1
    s_mul_i32 s38, s38, s41
    buffer_load_dwordx4 v169, s[8:11], s38 offen lds
    s_add_u32 s37, s48, 0
    s_mov_b32 m0, s37
    s_lshl_b32 s38, s59, 7
    buffer_load_dwordx4 v168, s[4:7], s38 offen lds
    s_add_u32 s37, s48, 1024
    s_mov_b32 m0, s37
    s_lshl_b32 s38, s59, 7
    s_add_u32 s38, s38, 7168
    buffer_load_dwordx4 v168, s[4:7], s38 offen lds
    v_add_u32 v178, s34, v2
    v_and_b32 v6, 7, v2
    v_xor_b32 v6, v6, v3
    v_lshlrev_b32 v6, 4, v6
    v_lshl_add_u32 v6, v2, 7, v6
    v_add_u32 v170, s36, v6
    v_xor_b32 v171, 64, v170
    v_add_u32 v179, s48, v6
    v_xor_b32 v180, 64, v179
    v_lshrrev_b32 v6, 2, v2
    v_lshl_add_u32 v6, v3, 2, v6
    v_and_b32 v7, 3, v2
    v_lshlrev_b32 v7, 3, v7
    v_and_b32 v8, 1, v3
    v_lshlrev_b32 v8, 5, v8
    v_lshl_add_u32 v9, v6, 6, v7
    v_add_u32 v9, 49152, v9
    v_add_u32 v172, v9, v8
    v_xor_b32 v10, 32, v8
    v_add_u32 v173, v9, v10
    v_mul_u32_u24 v9, 192, v6
    v_add3_u32 v174, v9, v7, v8
    v_add3_u32 v175, v9, v7, v10
    v_add_u32 v174, 77824, v174
    v_add_u32 v175, 77824, v175
    v_add_u32 v176, 43008, v174
    v_add_u32 v177, 43008, v175
    v_mov_b32 v184, 0x3f803f80
    v_mov_b32 v185, 0x3f803f80
    v_mov_b32 v186, 0x3f803f80
    v_mov_b32 v187, 0x3f803f80
    s_waitcnt vmcnt(12)
    s_barrier
    ds_read_b128 v[16:19], v170 offset:0
    ds_read_b128 v[20:23], v171 offset:0
    ds_read_b64_tr_b16 v[104:105], v172 offset:0
    ds_read_b64_tr_b16 v[106:107], v172 offset:1024
    ds_read_b64_tr_b16 v[108:109], v173 offset:0
    ds_read_b64_tr_b16 v[110:111], v173 offset:1024
    ds_read_b64_tr_b16 v[112:113], v172 offset:2048
    ds_read_b64_tr_b16 v[114:115], v172 offset:3072
    ds_read_b64_tr_b16 v[116:117], v173 offset:2048
    ds_read_b64_tr_b16 v[118:119], v173 offset:3072
    s_mul_i32 s37, s40, 8
    s_add_u32 s37, s37, s39
    s_mov_b32 m0, s37
    s_lshl_b32 s38, s60, 1
    s_mul_i32 s38, s38, s41
    buffer_load_dwordx4 v169, s[8:11], s38 offen lds
    s_mul_i32 s37, s40, 9
    s_add_u32 s37, s37, s39
    s_mov_b32 m0, s37
    s_lshl_b32 s38, s60, 1
    s_add_u32 s38, s38, 1
    s_mul_i32 s38, s38, s41
    buffer_load_dwordx4 v169, s[8:11], s38 offen lds
    s_add_u32 s37, s48, 16384
    s_mov_b32 m0, s37
    s_lshl_b32 s38, s60, 7
    buffer_load_dwordx4 v168, s[4:7], s38 offen lds
    s_add_u32 s37, s48, 17408
    s_mov_b32 m0, s37
    s_lshl_b32 s38, s60, 7
    s_add_u32 s38, s38, 7168
    buffer_load_dwordx4 v168, s[4:7], s38 offen lds
    s_waitcnt lgkmcnt(8)
    v_mfma_f32_16x16x32_bf16 v[80:83], v[184:187], v[16:19], 0
    v_mfma_f32_16x16x32_bf16 v[84:87], v[16:19], v[16:19], 0
    v_mfma_f32_16x16x32_bf16 v[80:83], v[184:187], v[20:23], v[80:83]
    v_mfma_f32_16x16x32_bf16 v[84:87], v[20:23], v[20:23], v[84:87]
    s_waitcnt lgkmcnt(4)
    v_mfma_f32_16x16x32_bf16 v[72:75], v[104:107], v[16:19], 0
    v_mfma_f32_16x16x32_bf16 v[76:79], v[108:111], v[16:19], 0
    v_mfma_f32_16x16x32_bf16 v[88:91], v[104:107], v[184:187], 0
    v_mfma_f32_16x16x32_bf16 v[92:95], v[108:111], v[184:187], 0
    s_waitcnt lgkmcnt(0)
    v_mfma_f32_16x16x32_bf16 v[72:75], v[112:115], v[20:23], v[72:75]
    v_mfma_f32_16x16x32_bf16 v[76:79], v[116:119], v[20:23], v[76:79]
    v_mfma_f32_16x16x32_bf16 v[88:91], v[112:115], v[184:187], v[88:91]
    v_mfma_f32_16x16x32_bf16 v[92:95], v[116:119], v[184:187], v[92:95]
    s_waitcnt vmcnt(12)
    s_barrier
    ds_read_b128 v[24:27], v170 offset:2048
    ds_read_b128 v[28:31], v171 offset:2048
    ds_read_b64_tr_b16 v[104:105], v172 offset:4096
    ds_read_b64_tr_b16 v[106:107], v172 offset:5120
    ds_read_b64_tr_b16 v[108:109], v173 offset:4096
    ds_read_b64_tr_b16 v[110:111], v173 offset:5120
    ds_read_b64_tr_b16 v[112:113], v172 offset:6144
    ds_read_b64_tr_b16 v[114:115], v172 offset:7168
    ds_read_b64_tr_b16 v[116:117], v173 offset:6144
    ds_read_b64_tr_b16 v[118:119], v173 offset:7168
    s_mul_i32 s37, s40, 10
    s_add_u32 s37, s37, s39
    s_mov_b32 m0, s37
    s_lshl_b32 s38, s61, 1
    s_mul_i32 s38, s38, s41
    buffer_load_dwordx4 v169, s[8:11], s38 offen lds
    s_mul_i32 s37, s40, 11
    s_add_u32 s37, s37, s39
    s_mov_b32 m0, s37
    s_lshl_b32 s38, s61, 1
    s_add_u32 s38, s38, 1
    s_mul_i32 s38, s38, s41
    buffer_load_dwordx4 v169, s[8:11], s38 offen lds
    s_add_u32 s37, s48, 32768
    s_mov_b32 m0, s37
    s_lshl_b32 s38, s61, 7
    buffer_load_dwordx4 v168, s[4:7], s38 offen lds
    s_add_u32 s37, s48, 33792
    s_mov_b32 m0, s37
    s_lshl_b32 s38, s61, 7
    s_add_u32 s38, s38, 7168
    buffer_load_dwordx4 v168, s[4:7], s38 offen lds
    s_waitcnt lgkmcnt(8)
    v_mfma_f32_16x16x32_bf16 v[80:83], v[184:187], v[24:27], v[80:83]
    v_mfma_f32_16x16x32_bf16 v[84:87], v[24:27], v[24:27], v[84:87]
    v_mfma_f32_16x16x32_bf16 v[80:83], v[184:187], v[28:31], v[80:83]
    v_mfma_f32_16x16x32_bf16 v[84:87], v[28:31], v[28:31], v[84:87]
    s_waitcnt lgkmcnt(4)
    v_mfma_f32_16x16x32_bf16 v[72:75], v[104:107], v[24:27], v[72:75]
    v_mfma_f32_16x16x32_bf16 v[76:79], v[108:111], v[24:27], v[76:79]
    v_mfma_f32_16x16x32_bf16 v[88:91], v[104:107], v[184:187], v[88:91]
    v_mfma_f32_16x16x32_bf16 v[92:95], v[108:111], v[184:187], v[92:95]
    s_waitcnt lgkmcnt(0)
    v_mfma_f32_16x16x32_bf16 v[72:75], v[112:115], v[28:31], v[72:75]
    v_mfma_f32_16x16x32_bf16 v[76:79], v[116:119], v[28:31], v[76:79]
    v_mfma_f32_16x16x32_bf16 v[88:91], v[112:115], v[184:187], v[88:91]
    v_mfma_f32_16x16x32_bf16 v[92:95], v[116:119], v[184:187], v[92:95]
    s_waitcnt vmcnt(12)
    s_barrier
    ds_read_b128 v[32:35], v170 offset:4096
    ds_read_b128 v[36:39], v171 offset:4096
    ds_read_b64_tr_b16 v[104:105], v172 offset:8192
    ds_read_b64_tr_b16 v[106:107], v172 offset:9216
    ds_read_b64_tr_b16 v[108:109], v173 offset:8192
    ds_read_b64_tr_b16 v[110:111], v173 offset:9216
    ds_read_b64_tr_b16 v[112:113], v172 offset:10240
    ds_read_b64_tr_b16 v[114:115], v172 offset:11264
    ds_read_b64_tr_b16 v[116:117], v173 offset:10240
    ds_read_b64_tr_b16 v[118:119], v173 offset:11264
    s_mul_i32 s37, s40, 12
    s_add_u32 s37, s37, s39
    s_mov_b32 m0, s37
    s_lshl_b32 s38, s62, 1
    s_mul_i32 s38, s38, s41
    buffer_load_dwordx4 v169, s[8:11], s38 offen lds
    s_mul_i32 s37, s40, 13
    s_add_u32 s37, s37, s39
    s_mov_b32 m0, s37
    s_lshl_b32 s38, s62, 1
    s_add_u32 s38, s38, 1
    s_mul_i32 s38, s38, s41
    buffer_load_dwordx4 v169, s[8:11], s38 offen lds
    s_add_u32 s37, s48, 49152
    s_mov_b32 m0, s37
    s_lshl_b32 s38, s62, 7
    buffer_load_dwordx4 v168, s[4:7], s38 offen lds
    s_add_u32 s37, s48, 50176
    s_mov_b32 m0, s37
    s_lshl_b32 s38, s62, 7
    s_add_u32 s38, s38, 7168
    buffer_load_dwordx4 v168, s[4:7], s38 offen lds
    s_waitcnt lgkmcnt(8)
    v_mfma_f32_16x16x32_bf16 v[80:83], v[184:187], v[32:35], v[80:83]
    v_mfma_f32_16x16x32_bf16 v[84:87], v[32:35], v[32:35], v[84:87]
    v_mfma_f32_16x16x32_bf16 v[80:83], v[184:187], v[36:39], v[80:83]
    v_mfma_f32_16x16x32_bf16 v[84:87], v[36:39], v[36:39], v[84:87]
    s_waitcnt lgkmcnt(4)
    v_mfma_f32_16x16x32_bf16 v[72:75], v[104:107], v[32:35], v[72:75]
    v_mfma_f32_16x16x32_bf16 v[76:79], v[108:111], v[32:35], v[76:79]
    v_mfma_f32_16x16x32_bf16 v[88:91], v[104:107], v[184:187], v[88:91]
    v_mfma_f32_16x16x32_bf16 v[92:95], v[108:111], v[184:187], v[92:95]
    s_waitcnt lgkmcnt(0)
    v_mfma_f32_16x16x32_bf16 v[72:75], v[112:115], v[36:39], v[72:75]
    v_mfma_f32_16x16x32_bf16 v[76:79], v[116:119], v[36:39], v[76:79]
    v_mfma_f32_16x16x32_bf16 v[88:91], v[112:115], v[184:187], v[88:91]
    v_mfma_f32_16x16x32_bf16 v[92:95], v[116:119], v[184:187], v[92:95]
    s_waitcnt vmcnt(12)
    s_barrier
    ds_read_b128 v[40:43], v179 offset:0
    ds_read_b128 v[44:47], v180 offset:0
    ds_read_b64_tr_b16 v[104:105], v172 offset:12288
    ds_read_b64_tr_b16 v[106:107], v172 offset:13312
    ds_read_b64_tr_b16 v[108:109], v173 offset:12288
    ds_read_b64_tr_b16 v[110:111], v173 offset:13312
    ds_read_b64_tr_b16 v[112:113], v172 offset:14336
    ds_read_b64_tr_b16 v[114:115], v172 offset:15360
    ds_read_b64_tr_b16 v[116:117], v173 offset:14336
    ds_read_b64_tr_b16 v[118:119], v173 offset:15360
    s_waitcnt lgkmcnt(8)
    v_mfma_f32_16x16x32_bf16 v[80:83], v[184:187], v[40:43], v[80:83]
    v_mfma_f32_16x16x32_bf16 v[84:87], v[40:43], v[40:43], v[84:87]
    v_mfma_f32_16x16x32_bf16 v[80:83], v[184:187], v[44:47], v[80:83]
    v_mfma_f32_16x16x32_bf16 v[84:87], v[44:47], v[44:47], v[84:87]
    s_waitcnt lgkmcnt(4)
    v_mfma_f32_16x16x32_bf16 v[72:75], v[104:107], v[40:43], v[72:75]
    v_mfma_f32_16x16x32_bf16 v[76:79], v[108:111], v[40:43], v[76:79]
    v_mfma_f32_16x16x32_bf16 v[88:91], v[104:107], v[184:187], v[88:91]
    v_mfma_f32_16x16x32_bf16 v[92:95], v[108:111], v[184:187], v[92:95]
    s_waitcnt lgkmcnt(0)
    v_mfma_f32_16x16x32_bf16 v[72:75], v[112:115], v[44:47], v[72:75]
    v_mfma_f32_16x16x32_bf16 v[76:79], v[116:119], v[44:47], v[76:79]
    v_mfma_f32_16x16x32_bf16 v[88:91], v[112:115], v[184:187], v[88:91]
    v_mfma_f32_16x16x32_bf16 v[92:95], v[116:119], v[184:187], v[92:95]
    s_waitcnt vmcnt(8)
    s_barrier
    ds_read_b128 v[48:51], v179 offset:16384
    ds_read_b128 v[52:55], v180 offset:16384
    ds_read_b64_tr_b16 v[104:105], v172 offset:16384
    ds_read_b64_tr_b16 v[106:107], v172 offset:17408
    ds_read_b64_tr_b16 v[108:109], v173 offset:16384
    ds_read_b64_tr_b16 v[110:111], v173 offset:17408
    ds_read_b64_tr_b16 v[112:113], v172 offset:18432
    ds_read_b64_tr_b16 v[114:115], v172 offset:19456
    ds_read_b64_tr_b16 v[116:117], v173 offset:18432
    ds_read_b64_tr_b16 v[118:119], v173 offset:19456
    s_waitcnt lgkmcnt(8)
    v_mfma_f32_16x16x32_bf16 v[80:83], v[184:187], v[48:51], v[80:83]
    v_mfma_f32_16x16x32_bf16 v[84:87], v[48:51], v[48:51], v[84:87]
    v_mfma_f32_16x16x32_bf16 v[80:83], v[184:187], v[52:55], v[80:83]
    v_mfma_f32_16x16x32_bf16 v[84:87], v[52:55], v[52:55], v[84:87]
    s_waitcnt lgkmcnt(4)
    v_mfma_f32_16x16x32_bf16 v[72:75], v[104:107], v[48:51], v[72:75]
    v_mfma_f32_16x16x32_bf16 v[76:79], v[108:111], v[48:51], v[76:79]
    v_mfma_f32_16x16x32_bf16 v[88:91], v[104:107], v[184:187], v[88:91]
    v_mfma_f32_16x16x32_bf16 v[92:95], v[108:111], v[184:187], v[92:95]
    s_waitcnt lgkmcnt(0)
    v_mfma_f32_16x16x32_bf16 v[72:75], v[112:115], v[52:55], v[72:75]
    v_mfma_f32_16x16x32_bf16 v[76:79], v[116:119], v[52:55], v[76:79]
    v_mfma_f32_16x16x32_bf16 v[88:91], v[112:115], v[184:187], v[88:91]
    v_mfma_f32_16x16x32_bf16 v[92:95], v[116:119], v[184:187], v[92:95]
    s_waitcnt vmcnt(4)
    s_barrier
    ds_read_b128 v[56:59], v179 offset:32768
    ds_read_b128 v[60:63], v180 offset:32768
    ds_read_b64_tr_b16 v[104:105], v172 offset:20480
    ds_read_b64_tr_b16 v[106:107], v172 offset:21504
    ds_read_b64_tr_b16 v[108:109], v173 offset:20480
    ds_read_b64_tr_b16 v[110:111], v173 offset:21504
    ds_read_b64_tr_b16 v[112:113], v172 offset:22528
    ds_read_b64_tr_b16 v[114:115], v172 offset:23552
    ds_read_b64_tr_b16 v[116:117], v173 offset:22528
    ds_read_b64_tr_b16 v[118:119], v173 offset:23552
    s_waitcnt lgkmcnt(8)
    v_mfma_f32_16x16x32_bf16 v[80:83], v[184:187], v[56:59], v[80:83]
    v_mfma_f32_16x16x32_bf16 v[84:87], v[56:59], v[56:59], v[84:87]
    v_mfma_f32_16x16x32_bf16 v[80:83], v[184:187], v[60:63], v[80:83]
    v_mfma_f32_16x16x32_bf16 v[84:87], v[60:63], v[60:63], v[84:87]
    s_waitcnt lgkmcnt(4)
    v_mfma_f32_16x16x32_bf16 v[72:75], v[104:107], v[56:59], v[72:75]
    v_mfma_f32_16x16x32_bf16 v[76:79], v[108:111], v[56:59], v[76:79]
    v_mfma_f32_16x16x32_bf16 v[88:91], v[104:107], v[184:187], v[88:91]
    v_mfma_f32_16x16x32_bf16 v[92:95], v[108:111], v[184:187], v[92:95]
    s_waitcnt lgkmcnt(0)
    v_mfma_f32_16x16x32_bf16 v[72:75], v[112:115], v[60:63], v[72:75]
    v_mfma_f32_16x16x32_bf16 v[76:79], v[116:119], v[60:63], v[76:79]
    v_mfma_f32_16x16x32_bf16 v[88:91], v[112:115], v[184:187], v[88:91]
    v_mfma_f32_16x16x32_bf16 v[92:95], v[116:119], v[184:187], v[92:95]
    s_waitcnt vmcnt(0)
    s_barrier
    ds_read_b128 v[64:67], v179 offset:49152
    ds_read_b128 v[68:71], v180 offset:49152
    ds_read_b64_tr_b16 v[104:105], v172 offset:24576
    ds_read_b64_tr_b16 v[106:107], v172 offset:25600
    ds_read_b64_tr_b16 v[108:109], v173 offset:24576
    ds_read_b64_tr_b16 v[110:111], v173 offset:25600
    ds_read_b64_tr_b16 v[112:113], v172 offset:26624
    ds_read_b64_tr_b16 v[114:115], v172 offset:27648
    ds_read_b64_tr_b16 v[116:117], v173 offset:26624
    ds_read_b64_tr_b16 v[118:119], v173 offset:27648
    s_waitcnt lgkmcnt(8)
    v_mfma_f32_16x16x32_bf16 v[80:83], v[184:187], v[64:67], v[80:83]
    v_mfma_f32_16x16x32_bf16 v[84:87], v[64:67], v[64:67], v[84:87]
    v_mfma_f32_16x16x32_bf16 v[80:83], v[184:187], v[68:71], v[80:83]
    v_mfma_f32_16x16x32_bf16 v[84:87], v[68:71], v[68:71], v[84:87]
    s_waitcnt lgkmcnt(4)
    v_mfma_f32_16x16x32_bf16 v[72:75], v[104:107], v[64:67], v[72:75]
    v_mfma_f32_16x16x32_bf16 v[76:79], v[108:111], v[64:67], v[76:79]
    v_mfma_f32_16x16x32_bf16 v[88:91], v[104:107], v[184:187], v[88:91]
    v_mfma_f32_16x16x32_bf16 v[92:95], v[108:111], v[184:187], v[92:95]
    s_waitcnt lgkmcnt(0)
    v_mfma_f32_16x16x32_bf16 v[72:75], v[112:115], v[68:71], v[72:75]
    v_mfma_f32_16x16x32_bf16 v[76:79], v[116:119], v[68:71], v[76:79]
    v_mfma_f32_16x16x32_bf16 v[88:91], v[112:115], v[184:187], v[88:91]
    v_mfma_f32_16x16x32_bf16 v[92:95], v[116:119], v[184:187], v[92:95]
Lp1join_2:
    s_mov_b32 s52, 0xbdd2d3e8
    s_mov_b32 s53, 0xbdd2d3e8
    s_mov_b32 s54, 1.0
    s_mov_b32 s55, 1.0
    v_mov_b32 v144, 0xc0135761
    v_mov_b32 v145, 0xc0135761
    v_lshrrev_b32 v6, 1, v3
    s_lshl_b32 s37, s25, 1
    v_add_u32 v6, s37, v6
    v_mul_u32_u24 v7, 9363, v6
    v_lshrrev_b32 v7, 16, v7
    v_lshrrev_b32 v8, 1, v7
    v_lshlrev_b32 v8, v8, 1
    v_and_b32 v7, 1, v7
    v_sub_u32 v9, 0, v8
    v_cmp_eq_u32 vcc, 1, v7
    s_nop 1
    v_cndmask_b32 v8, v8, v9, vcc
    v_add_u32 v8, v8, v178
    v_mov_b32 v9, 0x800
    v_cmp_lt_u32 s[50:51], v8, v9
    v_and_b32 v8, 2047, v8
    v_lshrrev_b32 v9, 4, v8
    v_mul_u32_u24 v9, 14336, v9
    v_and_b32 v8, 15, v8
    v_lshl_add_u32 v9, v8, 4, v9
    v_lshl_add_u32 v181, v3, 8, v9
    v_and_b32 v6, 3, v2
    v_cmp_eq_u32 vcc, 1, v6
    s_nop 1
    v_cndmask_b32 v7, v84, v85, vcc
    v_cmp_eq_u32 vcc, 2, v6
    s_nop 1
    v_cndmask_b32 v7, v7, v86, vcc
    v_cmp_eq_u32 vcc, 3, v6
    s_nop 1
    v_cndmask_b32 v7, v7, v87, vcc
    v_lshrrev_b32 v6, 2, v2
    v_cmp_eq_u32 vcc, v6, v3
    s_nop 1
    v_cndmask_b32 v7, 0, v7, vcc
    v_mov_b32 v6, v7
    s_nop 1
    v_permlane32_swap_b32 v7, v6
    s_nop 1
    v_add_f32 v7, v7, v6
    v_mov_b32 v6, v7
    s_nop 1
    v_permlane16_swap_b32 v7, v6
    s_nop 1
    v_add_f32 v7, v7, v6
    v_mul_f32 v80, 0x3b124925, v80
    v_mul_f32 v7, 0x3b124925, v7
    v_fma_f32 v7, -v80, v80, v7
    v_max_f32 v7, 0, v7
    v_add_f32 v7, 0x3727c5ac, v7
    v_rsq_f32 v188, v7
    s_nop 0
    v_mul_f32 v190, v80, v188
    v_sub_f32 v190, 0, v190
    v_pk_mul_f32 v[88:89], v[88:89], v[190:191] op_sel_hi:[1,0]
    v_pk_fma_f32 v[72:73], v[72:73], v[188:189], v[88:89] op_sel_hi:[1,0,1]
    v_pk_mul_f32 v[90:91], v[90:91], v[190:191] op_sel_hi:[1,0]
    v_pk_fma_f32 v[74:75], v[74:75], v[188:189], v[90:91] op_sel_hi:[1,0,1]
    v_pk_mul_f32 v[92:93], v[92:93], v[190:191] op_sel_hi:[1,0]
    v_pk_fma_f32 v[76:77], v[76:77], v[188:189], v[92:93] op_sel_hi:[1,0,1]
    v_pk_mul_f32 v[94:95], v[94:95], v[190:191] op_sel_hi:[1,0]
    v_pk_fma_f32 v[78:79], v[78:79], v[188:189], v[94:95] op_sel_hi:[1,0,1]
    v_pk_mul_f32 v[10:11], v[72:73], v[72:73]
    v_pk_fma_f32 v[10:11], v[10:11], s[52:53], v[144:145]
    v_pk_mul_f32 v[10:11], v[10:11], v[72:73]
    v_exp_f32 v10, v10
    v_exp_f32 v11, v11
    s_nop 0
    v_pk_add_f32 v[10:11], v[10:11], s[54:55]
    v_rcp_f32 v10, v10
    v_rcp_f32 v11, v11
    s_nop 0
    v_pk_mul_f32 v[72:73], v[72:73], v[10:11]
    v_cvt_pk_bf16_f32 v152, v72, v73
    v_pk_mul_f32 v[12:13], v[74:75], v[74:75]
    v_pk_fma_f32 v[12:13], v[12:13], s[52:53], v[144:145]
    v_pk_mul_f32 v[12:13], v[12:13], v[74:75]
    v_exp_f32 v12, v12
    v_exp_f32 v13, v13
    s_nop 0
    v_pk_add_f32 v[12:13], v[12:13], s[54:55]
    v_rcp_f32 v12, v12
    v_rcp_f32 v13, v13
    s_nop 0
    v_pk_mul_f32 v[74:75], v[74:75], v[12:13]
    v_cvt_pk_bf16_f32 v153, v74, v75
    v_pk_mul_f32 v[10:11], v[76:77], v[76:77]
    v_pk_fma_f32 v[10:11], v[10:11], s[52:53], v[144:145]
    v_pk_mul_f32 v[10:11], v[10:11], v[76:77]
    v_exp_f32 v10, v10
    v_exp_f32 v11, v11
    s_nop 0
    v_pk_add_f32 v[10:11], v[10:11], s[54:55]
    v_rcp_f32 v10, v10
    v_rcp_f32 v11, v11
    s_nop 0
    v_pk_mul_f32 v[76:77], v[76:77], v[10:11]
    v_cvt_pk_bf16_f32 v154, v76, v77
    v_pk_mul_f32 v[12:13], v[78:79], v[78:79]
    v_pk_fma_f32 v[12:13], v[12:13], s[52:53], v[144:145]
    v_pk_mul_f32 v[12:13], v[12:13], v[78:79]
    v_exp_f32 v12, v12
    v_exp_f32 v13, v13
    s_nop 0
    v_pk_add_f32 v[12:13], v[12:13], s[54:55]
    v_rcp_f32 v12, v12
    v_rcp_f32 v13, v13
    s_nop 0
    v_pk_mul_f32 v[78:79], v[78:79], v[12:13]
    v_cvt_pk_bf16_f32 v155, v78, v79
    s_nop 1
    v_permlane32_swap_b32 v152, v154
    v_permlane32_swap_b32 v153, v155
    s_nop 1
    v_permlane16_swap_b32 v152, v154
    v_permlane16_swap_b32 v153, v155
    v_cndmask_b32 v152, 0, v152, s[50:51]
    v_cndmask_b32 v153, 0, v153, s[50:51]
    v_cndmask_b32 v154, 0, v154, s[50:51]
    v_cndmask_b32 v155, 0, v155, s[50:51]
    s_lshl_b32 s37, s25, 10
    s_add_u32 s37, s37, 0x600000
    buffer_store_dwordx4 v[152:155], v181, s[12:15], s37 offen sc1
    s_lshl_b32 s37, s27, 7
    s_add_u32 s20, s74, s37
    s_addc_u32 s21, s75, 0
    s_sub_u32 s22, 0x62000, s37
    s_mov_b32 s23, 0x00020000
    v_lshrrev_b32 v6, 3, v0
    v_bfe_u32 v7, v6, 2, 2
    v_lshlrev_b32 v7, 3, v7
    v_bfe_u32 v8, v6, 4, 1
    v_lshl_add_u32 v7, v8, 2, v7
    v_and_b32 v8, 35, v6
    v_add_u32 v7, v7, v8
    v_bfe_u32 v8, v6, 1, 2
    v_lshlrev_b32 v8, 1, v8
    v_and_b32 v9, 7, v0
    v_xor_b32 v8, v8, v9
    v_mul_u32_u24 v194, 896, v7
    v_lshl_add_u32 v194, v8, 4, v194
    s_and_b32 s44, s3, 3
    s_lshr_b32 s45, s3, 2
    s_lshl_b32 s46, s26, 2
    s_add_u32 s46, s46, s44
    s_mul_i32 s47, s46, 14336
    s_add_u32 s49, s47, 0x600000
    s_lshl_b32 s37, s45, 10
    s_add_u32 s47, s47, s37
    v_add_u32 v192, s47, v4
    s_lshl_b32 s37, s46, 4
    v_add_u32 v193, s37, v2
    s_lshr_b32 s46, s26, 1
    s_and_b32 s47, s26, 1
    s_lshl_b32 s47, s47, 1
    s_add_u32 s47, s47, s46
    s_add_u32 s47, s47, 15
    s_and_b32 s47, s47, 15
    v_mov_b32 v6, s46
    v_mov_b32 v7, s47
    v_cmp_eq_u32 vcc, 0, v3
    s_nop 1
    v_cndmask_b32 v6, v7, v6, vcc
    v_lshlrev_b32 v6, 7, v6
    v_lshl_add_u32 v6, v2, 2, v6
    v_add_u32 v197, 0x1480000, v6
    s_lshl_b32 s37, s3, 2
    v_add_u32 v6, s37, v3
    v_bfe_u32 v7, v6, 2, 2
    v_lshlrev_b32 v7, 3, v7
    v_bfe_u32 v8, v6, 4, 1
    v_lshl_add_u32 v7, v8, 2, v7
    v_and_b32 v8, 3, v6
    v_add_u32 v7, v7, v8
    v_and_b32 v8, 7, v6
    v_lshlrev_b32 v8, 1, v8
    v_xor_b32 v8, v8, v2
    v_mul_u32_u24 v199, 3584, v7
    v_lshl_add_u32 v199, v8, 4, v199
    s_lshl_b32 s47, s3, 10
    s_and_b32 s101, s24, 1
    s_mul_i32 s101, s101, 7
    s_add_u32 s101, s101, s25
    s_sub_u32 s37, s101, 14
    s_cmp_ge_u32 s101, 14
    s_cselect_b32 s101, s37, s101
    s_cmp_eq_u32 s25, 9
    s_cbranch_scc1 Lcg9_3
    s_cmp_gt_u32 s25, 9
    s_cbranch_scc1 Lcgv_4
    s_waitcnt vmcnt(10)
    s_barrier
    s_cmp_ge_u32 s3, 6
    s_cbranch_scc1 Lnq_6
    s_mul_i32 s37, s40, 11
    s_add_u32 s37, s37, s39
    s_mov_b32 m0, s37
    s_lshl_b32 s38, s61, 1
    s_add_u32 s38, s38, 1
    s_mul_i32 s38, s38, s41
    buffer_load_dwordx4 v169, s[8:11], s38 offen lds
Lnq_6:
    ds_read_b64_tr_b16 v[104:105], v174 offset:0
    ds_read_b64_tr_b16 v[106:107], v174 offset:3072
    ds_read_b64_tr_b16 v[108:109], v175 offset:0
    ds_read_b64_tr_b16 v[110:111], v175 offset:3072
    ds_read_b64_tr_b16 v[112:113], v174 offset:64
    ds_read_b64_tr_b16 v[114:115], v174 offset:3136
    ds_read_b64_tr_b16 v[116:117], v175 offset:64
    ds_read_b64_tr_b16 v[118:119], v175 offset:3136
    ds_read_b64_tr_b16 v[120:121], v174 offset:128
    ds_read_b64_tr_b16 v[122:123], v174 offset:3200
    ds_read_b64_tr_b16 v[124:125], v175 offset:128
    ds_read_b64_tr_b16 v[126:127], v175 offset:3200
    s_cmp_ge_u32 s3, 6
    s_cbranch_scc1 Lnq_7
    s_mul_i32 s37, s40, 12
    s_add_u32 s37, s37, s39
    s_mov_b32 m0, s37
    s_lshl_b32 s38, s62, 1
    s_mul_i32 s38, s38, s41
    buffer_load_dwordx4 v169, s[8:11], s38 offen lds
Lnq_7:
    s_add_u32 s37, s47, 0
    s_mov_b32 m0, s37
    s_mov_b32 s38, 0
    buffer_load_dwordx4 v194, s[20:23], s38 offen lds
    ds_read_b64_tr_b16 v[128:129], v174 offset:6144
    ds_read_b64_tr_b16 v[130:131], v174 offset:9216
    s_waitcnt lgkmcnt(2)
    v_mfma_f32_16x16x32_bf16 v[72:75], v[104:107], v[16:19], 0
    ds_read_b64_tr_b16 v[132:133], v175 offset:6144
    ds_read_b64_tr_b16 v[134:135], v175 offset:9216
    v_mfma_f32_16x16x32_bf16 v[76:79], v[108:111], v[16:19], 0
    ds_read_b64_tr_b16 v[136:137], v174 offset:6208
    ds_read_b64_tr_b16 v[138:139], v174 offset:9280
    v_mfma_f32_16x16x32_bf16 v[80:83], v[112:115], v[16:19], 0
    ds_read_b64_tr_b16 v[140:141], v175 offset:6208
    ds_read_b64_tr_b16 v[142:143], v175 offset:9280
    v_mfma_f32_16x16x32_bf16 v[84:87], v[116:119], v[16:19], 0
    ds_read_b64_tr_b16 v[144:145], v174 offset:6272
    ds_read_b64_tr_b16 v[146:147], v174 offset:9344
    v_mfma_f32_16x16x32_bf16 v[88:91], v[120:123], v[16:19], 0
    ds_read_b64_tr_b16 v[148:149], v175 offset:6272
    ds_read_b64_tr_b16 v[150:151], v175 offset:9344
    v_mfma_f32_16x16x32_bf16 v[92:95], v[124:127], v[16:19], 0
    s_waitcnt vmcnt(1)
    s_barrier
    s_lshl_b32 s37, s24, 7
    s_lshl_b32 s38, s25, 2
    s_add_u32 s37, s37, s38
    s_add_u32 s37, s37, 0x1480000
    s_waitcnt lgkmcnt(0)
    s_mul_i32 s29, s29, 0x9E3779B1
    s_add_u32 s29, s29, 0x7F4A7C15
    s_cmp_lg_u32 s3, 0
    s_cbranch_scc1 Lpub_8
    v_mov_b32 v6, s29
    v_mov_b32 v7, 0
    s_mov_b64 exec, 1
    buffer_store_dword v6, v7, s[12:15], s37 offen sc1
    s_mov_b64 exec, -1
Lpub_8:
    s_cmp_ge_u32 s3, 6
    s_cbranch_scc1 Lnq_9
    s_mul_i32 s37, s40, 13
    s_add_u32 s37, s37, s39
    s_mov_b32 m0, s37
    s_lshl_b32 s38, s62, 1
    s_add_u32 s38, s38, 1
    s_mul_i32 s38, s38, s41
    buffer_load_dwordx4 v169, s[8:11], s38 offen lds
Lnq_9:
    s_add_u32 s37, s47, 8192
    s_mov_b32 m0, s37
    s_mov_b32 s38, 57344
    buffer_load_dwordx4 v194, s[20:23], s38 offen lds
    ds_read_b64_tr_b16 v[104:105], v174 offset:12288
    ds_read_b64_tr_b16 v[106:107], v174 offset:15360
    s_waitcnt lgkmcnt(2)
    v_mfma_f32_16x16x32_bf16 v[72:75], v[128:131], v[20:23], v[72:75]
    ds_read_b64_tr_b16 v[108:109], v175 offset:12288
    ds_read_b64_tr_b16 v[110:111], v175 offset:15360
    v_mfma_f32_16x16x32_bf16 v[76:79], v[132:135], v[20:23], v[76:79]
    ds_read_b64_tr_b16 v[112:113], v174 offset:12352
    ds_read_b64_tr_b16 v[114:115], v174 offset:15424
    v_mfma_f32_16x16x32_bf16 v[80:83], v[136:139], v[20:23], v[80:83]
    ds_read_b64_tr_b16 v[116:117], v175 offset:12352
    ds_read_b64_tr_b16 v[118:119], v175 offset:15424
    v_mfma_f32_16x16x32_bf16 v[84:87], v[140:143], v[20:23], v[84:87]
    ds_read_b64_tr_b16 v[120:121], v174 offset:12416
    ds_read_b64_tr_b16 v[122:123], v174 offset:15488
    v_mfma_f32_16x16x32_bf16 v[88:91], v[144:147], v[20:23], v[88:91]
    ds_read_b64_tr_b16 v[124:125], v175 offset:12416
    ds_read_b64_tr_b16 v[126:127], v175 offset:15488
    v_mfma_f32_16x16x32_bf16 v[92:95], v[148:151], v[20:23], v[92:95]
    s_add_u32 s37, s47, 16384
    s_mov_b32 m0, s37
    s_mov_b32 s38, 114688
    buffer_load_dwordx4 v194, s[20:23], s38 offen lds
    ds_read_b64_tr_b16 v[128:129], v174 offset:18432
    ds_read_b64_tr_b16 v[130:131], v174 offset:21504
    s_waitcnt lgkmcnt(2)
    v_mfma_f32_16x16x32_bf16 v[72:75], v[104:107], v[24:27], v[72:75]
    ds_read_b64_tr_b16 v[132:133], v175 offset:18432
    ds_read_b64_tr_b16 v[134:135], v175 offset:21504
    v_mfma_f32_16x16x32_bf16 v[76:79], v[108:111], v[24:27], v[76:79]
    ds_read_b64_tr_b16 v[136:137], v174 offset:18496
    ds_read_b64_tr_b16 v[138:139], v174 offset:21568
    v_mfma_f32_16x16x32_bf16 v[80:83], v[112:115], v[24:27], v[80:83]
    ds_read_b64_tr_b16 v[140:141], v175 offset:18496
    ds_read_b64_tr_b16 v[142:143], v175 offset:21568
    v_mfma_f32_16x16x32_bf16 v[84:87], v[116:119], v[24:27], v[84:87]
    ds_read_b64_tr_b16 v[144:145], v174 offset:18560
    ds_read_b64_tr_b16 v[146:147], v174 offset:21632
    v_mfma_f32_16x16x32_bf16 v[88:91], v[120:123], v[24:27], v[88:91]
    ds_read_b64_tr_b16 v[148:149], v175 offset:18560
    ds_read_b64_tr_b16 v[150:151], v175 offset:21632
    v_mfma_f32_16x16x32_bf16 v[92:95], v[124:127], v[24:27], v[92:95]
    s_waitcnt vmcnt(12)
    s_barrier
    s_add_u32 s37, s47, 24576
    s_mov_b32 m0, s37
    s_mov_b32 s38, 172032
    buffer_load_dwordx4 v194, s[20:23], s38 offen lds
    ds_read_b64_tr_b16 v[104:105], v174 offset:24576
    ds_read_b64_tr_b16 v[106:107], v174 offset:27648
    s_waitcnt lgkmcnt(2)
    v_mfma_f32_16x16x32_bf16 v[72:75], v[128:131], v[28:31], v[72:75]
    ds_read_b64_tr_b16 v[108:109], v175 offset:24576
    ds_read_b64_tr_b16 v[110:111], v175 offset:27648
    v_mfma_f32_16x16x32_bf16 v[76:79], v[132:135], v[28:31], v[76:79]
    ds_read_b64_tr_b16 v[112:113], v174 offset:24640
    ds_read_b64_tr_b16 v[114:115], v174 offset:27712
    v_mfma_f32_16x16x32_bf16 v[80:83], v[136:139], v[28:31], v[80:83]
    ds_read_b64_tr_b16 v[116:117], v175 offset:24640
    ds_read_b64_tr_b16 v[118:119], v175 offset:27712
    v_mfma_f32_16x16x32_bf16 v[84:87], v[140:143], v[28:31], v[84:87]
    ds_read_b64_tr_b16 v[120:121], v174 offset:24704
    ds_read_b64_tr_b16 v[122:123], v174 offset:27776
    v_mfma_f32_16x16x32_bf16 v[88:91], v[144:147], v[28:31], v[88:91]
    ds_read_b64_tr_b16 v[124:125], v175 offset:24704
    ds_read_b64_tr_b16 v[126:127], v175 offset:27776
    v_mfma_f32_16x16x32_bf16 v[92:95], v[148:151], v[28:31], v[92:95]
    s_add_u32 s37, s47, 32768
    s_mov_b32 m0, s37
    s_mov_b32 s38, 229376
    buffer_load_dwordx4 v194, s[20:23], s38 offen lds
    ds_read_b64_tr_b16 v[128:129], v174 offset:30720
    ds_read_b64_tr_b16 v[130:131], v174 offset:33792
    s_waitcnt lgkmcnt(2)
    v_mfma_f32_16x16x32_bf16 v[72:75], v[104:107], v[32:35], v[72:75]
    ds_read_b64_tr_b16 v[132:133], v175 offset:30720
    ds_read_b64_tr_b16 v[134:135], v175 offset:33792
    v_mfma_f32_16x16x32_bf16 v[76:79], v[108:111], v[32:35], v[76:79]
    ds_read_b64_tr_b16 v[136:137], v174 offset:30784
    ds_read_b64_tr_b16 v[138:139], v174 offset:33856
    v_mfma_f32_16x16x32_bf16 v[80:83], v[112:115], v[32:35], v[80:83]
    ds_read_b64_tr_b16 v[140:141], v175 offset:30784
    ds_read_b64_tr_b16 v[142:143], v175 offset:33856
    v_mfma_f32_16x16x32_bf16 v[84:87], v[116:119], v[32:35], v[84:87]
    ds_read_b64_tr_b16 v[144:145], v174 offset:30848
    ds_read_b64_tr_b16 v[146:147], v174 offset:33920
    v_mfma_f32_16x16x32_bf16 v[88:91], v[120:123], v[32:35], v[88:91]
    ds_read_b64_tr_b16 v[148:149], v175 offset:30848
    ds_read_b64_tr_b16 v[150:151], v175 offset:33920
    v_mfma_f32_16x16x32_bf16 v[92:95], v[124:127], v[32:35], v[92:95]
    s_waitcnt vmcnt(12)
    s_barrier
    s_cmp_lg_u32 s3, 0
    s_cbranch_scc1 Lfi_10
    s_mov_b32 exec_lo, 0x3fff3fff
    s_mov_b32 exec_hi, 0x0
    buffer_load_dword v198, v197, s[12:15], 0 offen sc1
    s_mov_b64 exec, -1
Lfi_10:
    s_add_u32 s37, s47, 40960
    s_mov_b32 m0, s37
    s_mov_b32 s38, 286720
    buffer_load_dwordx4 v194, s[20:23], s38 offen lds
    ds_read_b64_tr_b16 v[104:105], v174 offset:36864
    ds_read_b64_tr_b16 v[106:107], v174 offset:39936
    s_waitcnt lgkmcnt(2)
    v_mfma_f32_16x16x32_bf16 v[72:75], v[128:131], v[36:39], v[72:75]
    ds_read_b64_tr_b16 v[108:109], v175 offset:36864
    ds_read_b64_tr_b16 v[110:111], v175 offset:39936
    v_mfma_f32_16x16x32_bf16 v[76:79], v[132:135], v[36:39], v[76:79]
    ds_read_b64_tr_b16 v[112:113], v174 offset:36928
    ds_read_b64_tr_b16 v[114:115], v174 offset:40000
    v_mfma_f32_16x16x32_bf16 v[80:83], v[136:139], v[36:39], v[80:83]
    ds_read_b64_tr_b16 v[116:117], v175 offset:36928
    ds_read_b64_tr_b16 v[118:119], v175 offset:40000
    v_mfma_f32_16x16x32_bf16 v[84:87], v[140:143], v[36:39], v[84:87]
    ds_read_b64_tr_b16 v[120:121], v174 offset:36992
    ds_read_b64_tr_b16 v[122:123], v174 offset:40064
    v_mfma_f32_16x16x32_bf16 v[88:91], v[144:147], v[36:39], v[88:91]
    ds_read_b64_tr_b16 v[124:125], v175 offset:36992
    ds_read_b64_tr_b16 v[126:127], v175 offset:40064
    v_mfma_f32_16x16x32_bf16 v[92:95], v[148:151], v[36:39], v[92:95]
    s_add_u32 s37, s47, 49152
    s_mov_b32 m0, s37
    s_mov_b32 s38, 344064
    buffer_load_dwordx4 v194, s[20:23], s38 offen lds
    ds_read_b64_tr_b16 v[128:129], v176 offset:0
    ds_read_b64_tr_b16 v[130:131], v176 offset:3072
    s_waitcnt lgkmcnt(2)
    v_mfma_f32_16x16x32_bf16 v[72:75], v[104:107], v[40:43], v[72:75]
    ds_read_b64_tr_b16 v[132:133], v177 offset:0
    ds_read_b64_tr_b16 v[134:135], v177 offset:3072
    v_mfma_f32_16x16x32_bf16 v[76:79], v[108:111], v[40:43], v[76:79]
    ds_read_b64_tr_b16 v[136:137], v176 offset:64
    ds_read_b64_tr_b16 v[138:139], v176 offset:3136
    v_mfma_f32_16x16x32_bf16 v[80:83], v[112:115], v[40:43], v[80:83]
    ds_read_b64_tr_b16 v[140:141], v177 offset:64
    ds_read_b64_tr_b16 v[142:143], v177 offset:3136
    v_mfma_f32_16x16x32_bf16 v[84:87], v[116:119], v[40:43], v[84:87]
    ds_read_b64_tr_b16 v[144:145], v176 offset:128
    ds_read_b64_tr_b16 v[146:147], v176 offset:3200
    v_mfma_f32_16x16x32_bf16 v[88:91], v[120:123], v[40:43], v[88:91]
    ds_read_b64_tr_b16 v[148:149], v177 offset:128
    ds_read_b64_tr_b16 v[150:151], v177 offset:3200
    v_mfma_f32_16x16x32_bf16 v[92:95], v[124:127], v[40:43], v[92:95]
    s_cmp_lg_u32 s3, 0
    s_cbranch_scc1 Lfc_11
    s_mov_b32 exec_lo, 0x3fff3fff
    s_mov_b32 exec_hi, 0x0
    s_mov_b32 s63, 0
    s_waitcnt vmcnt(2)
Lfl_12:
    v_cmp_ne_u32 vcc, s29, v198
    s_nop 1
    s_cbranch_vccz Lfd_13
    s_sleep 4
    buffer_load_dword v198, v197, s[12:15], 0 offen sc1
    s_waitcnt vmcnt(0)
    s_add_u32 s63, s63, 1
    s_cmp_lt_u32 s63, 200000
    s_cbranch_scc1 Lfl_12
    v_mov_b32 v6, 1
    v_mov_b32 v7, 4
    buffer_store_dword v6, v7, s[16:19], 0 offen
Lfd_13:
    s_mov_b64 exec, -1
Lfc_11:
    s_waitcnt vmcnt(12)
    s_barrier
    s_add_u32 s37, s49, 0
    buffer_load_dwordx4 v[200:203], v4, s[12:15], s37 offen sc1
    s_add_u32 s37, s49, 1024
    buffer_load_dwordx4 v[204:207], v4, s[12:15], s37 offen sc1
    s_add_u32 s37, s49, 2048
    buffer_load_dwordx4 v[208:211], v4, s[12:15], s37 offen sc1
    ds_read_b64_tr_b16 v[104:105], v176 offset:6144
    ds_read_b64_tr_b16 v[106:107], v176 offset:9216
    s_waitcnt lgkmcnt(2)
    v_mfma_f32_16x16x32_bf16 v[72:75], v[128:131], v[44:47], v[72:75]
    ds_read_b64_tr_b16 v[108:109], v177 offset:6144
    ds_read_b64_tr_b16 v[110:111], v177 offset:9216
    v_mfma_f32_16x16x32_bf16 v[76:79], v[132:135], v[44:47], v[76:79]
    ds_read_b64_tr_b16 v[112:113], v176 offset:6208
    ds_read_b64_tr_b16 v[114:115], v176 offset:9280
    v_mfma_f32_16x16x32_bf16 v[80:83], v[136:139], v[44:47], v[80:83]
    ds_read_b64_tr_b16 v[116:117], v177 offset:6208
    ds_read_b64_tr_b16 v[118:119], v177 offset:9280
    v_mfma_f32_16x16x32_bf16 v[84:87], v[140:143], v[44:47], v[84:87]
    ds_read_b64_tr_b16 v[120:121], v176 offset:6272
    ds_read_b64_tr_b16 v[122:123], v176 offset:9344
    v_mfma_f32_16x16x32_bf16 v[88:91], v[144:147], v[44:47], v[88:91]
    ds_read_b64_tr_b16 v[124:125], v177 offset:6272
    ds_read_b64_tr_b16 v[126:127], v177 offset:9344
    v_mfma_f32_16x16x32_bf16 v[92:95], v[148:151], v[44:47], v[92:95]
    s_add_u32 s37, s49, 3072
    buffer_load_dwordx4 v[212:215], v4, s[12:15], s37 offen sc1
    s_add_u32 s37, s49, 4096
    buffer_load_dwordx4 v[216:219], v4, s[12:15], s37 offen sc1
    s_add_u32 s37, s49, 5120
    buffer_load_dwordx4 v[220:223], v4, s[12:15], s37 offen sc1
    ds_read_b64_tr_b16 v[128:129], v176 offset:12288
    ds_read_b64_tr_b16 v[130:131], v176 offset:15360
    s_waitcnt lgkmcnt(2)
    v_mfma_f32_16x16x32_bf16 v[72:75], v[104:107], v[48:51], v[72:75]
    ds_read_b64_tr_b16 v[132:133], v177 offset:12288
    ds_read_b64_tr_b16 v[134:135], v177 offset:15360
    v_mfma_f32_16x16x32_bf16 v[76:79], v[108:111], v[48:51], v[76:79]
    ds_read_b64_tr_b16 v[136:137], v176 offset:12352
    ds_read_b64_tr_b16 v[138:139], v176 offset:15424
    v_mfma_f32_16x16x32_bf16 v[80:83], v[112:115], v[48:51], v[80:83]
    ds_read_b64_tr_b16 v[140:141], v177 offset:12352
    ds_read_b64_tr_b16 v[142:143], v177 offset:15424
    v_mfma_f32_16x16x32_bf16 v[84:87], v[116:119], v[48:51], v[84:87]
    ds_read_b64_tr_b16 v[144:145], v176 offset:12416
    ds_read_b64_tr_b16 v[146:147], v176 offset:15488
    v_mfma_f32_16x16x32_bf16 v[88:91], v[120:123], v[48:51], v[88:91]
    ds_read_b64_tr_b16 v[148:149], v177 offset:12416
    ds_read_b64_tr_b16 v[150:151], v177 offset:15488
    v_mfma_f32_16x16x32_bf16 v[92:95], v[124:127], v[48:51], v[92:95]
    s_waitcnt vmcnt(15)
    s_barrier
    s_add_u32 s37, s49, 6144
    buffer_load_dwordx4 v[224:227], v4, s[12:15], s37 offen sc1
    s_add_u32 s37, s49, 7168
    buffer_load_dwordx4 v[228:231], v4, s[12:15], s37 offen sc1
    ds_read_b64_tr_b16 v[104:105], v176 offset:18432
    ds_read_b64_tr_b16 v[106:107], v176 offset:21504
    s_waitcnt lgkmcnt(2)
    v_mfma_f32_16x16x32_bf16 v[72:75], v[128:131], v[52:55], v[72:75]
    ds_read_b64_tr_b16 v[108:109], v177 offset:18432
    ds_read_b64_tr_b16 v[110:111], v177 offset:21504
    v_mfma_f32_16x16x32_bf16 v[76:79], v[132:135], v[52:55], v[76:79]
    ds_read_b64_tr_b16 v[112:113], v176 offset:18496
    ds_read_b64_tr_b16 v[114:115], v176 offset:21568
    v_mfma_f32_16x16x32_bf16 v[80:83], v[136:139], v[52:55], v[80:83]
    ds_read_b64_tr_b16 v[116:117], v177 offset:18496
    ds_read_b64_tr_b16 v[118:119], v177 offset:21568
    v_mfma_f32_16x16x32_bf16 v[84:87], v[140:143], v[52:55], v[84:87]
    ds_read_b64_tr_b16 v[120:121], v176 offset:18560
    ds_read_b64_tr_b16 v[122:123], v176 offset:21632
    v_mfma_f32_16x16x32_bf16 v[88:91], v[144:147], v[52:55], v[88:91]
    ds_read_b64_tr_b16 v[124:125], v177 offset:18560
    ds_read_b64_tr_b16 v[126:127], v177 offset:21632
    v_mfma_f32_16x16x32_bf16 v[92:95], v[148:151], v[52:55], v[92:95]
    s_add_u32 s37, s49, 8192
    buffer_load_dwordx4 v[232:235], v4, s[12:15], s37 offen sc1
    s_add_u32 s37, s49, 9216
    buffer_load_dwordx4 v[236:239], v4, s[12:15], s37 offen sc1
    ds_read_b64_tr_b16 v[128:129], v176 offset:24576
    ds_read_b64_tr_b16 v[130:131], v176 offset:27648
    s_waitcnt lgkmcnt(2)
    v_mfma_f32_16x16x32_bf16 v[72:75], v[104:107], v[56:59], v[72:75]
    ds_read_b64_tr_b16 v[132:133], v177 offset:24576
    ds_read_b64_tr_b16 v[134:135], v177 offset:27648
    v_mfma_f32_16x16x32_bf16 v[76:79], v[108:111], v[56:59], v[76:79]
    ds_read_b64_tr_b16 v[136:137], v176 offset:24640
    ds_read_b64_tr_b16 v[138:139], v176 offset:27712
    v_mfma_f32_16x16x32_bf16 v[80:83], v[112:115], v[56:59], v[80:83]
    ds_read_b64_tr_b16 v[140:141], v177 offset:24640
    ds_read_b64_tr_b16 v[142:143], v177 offset:27712
    v_mfma_f32_16x16x32_bf16 v[84:87], v[116:119], v[56:59], v[84:87]
    ds_read_b64_tr_b16 v[144:145], v176 offset:24704
    ds_read_b64_tr_b16 v[146:147], v176 offset:27776
    v_mfma_f32_16x16x32_bf16 v[88:91], v[120:123], v[56:59], v[88:91]
    ds_read_b64_tr_b16 v[148:149], v177 offset:24704
    ds_read_b64_tr_b16 v[150:151], v177 offset:27776
    v_mfma_f32_16x16x32_bf16 v[92:95], v[124:127], v[56:59], v[92:95]
    s_waitcnt vmcnt(16)
    s_barrier
    s_add_u32 s37, s49, 10240
    buffer_load_dwordx4 v[240:243], v4, s[12:15], s37 offen sc1
    s_add_u32 s37, s49, 11264
    buffer_load_dwordx4 v[244:247], v4, s[12:15], s37 offen sc1
    ds_read_b64_tr_b16 v[104:105], v176 offset:30720
    ds_read_b64_tr_b16 v[106:107], v176 offset:33792
    s_waitcnt lgkmcnt(2)
    v_mfma_f32_16x16x32_bf16 v[72:75], v[128:131], v[60:63], v[72:75]
    ds_read_b64_tr_b16 v[108:109], v177 offset:30720
    ds_read_b64_tr_b16 v[110:111], v177 offset:33792
    v_mfma_f32_16x16x32_bf16 v[76:79], v[132:135], v[60:63], v[76:79]
    ds_read_b64_tr_b16 v[112:113], v176 offset:30784
    ds_read_b64_tr_b16 v[114:115], v176 offset:33856
    v_mfma_f32_16x16x32_bf16 v[80:83], v[136:139], v[60:63], v[80:83]
    ds_read_b64_tr_b16 v[116:117], v177 offset:30784
    ds_read_b64_tr_b16 v[118:119], v177 offset:33856
    v_mfma_f32_16x16x32_bf16 v[84:87], v[140:143], v[60:63], v[84:87]
    ds_read_b64_tr_b16 v[120:121], v176 offset:30848
    ds_read_b64_tr_b16 v[122:123], v176 offset:33920
    v_mfma_f32_16x16x32_bf16 v[88:91], v[144:147], v[60:63], v[88:91]
    ds_read_b64_tr_b16 v[124:125], v177 offset:30848
    ds_read_b64_tr_b16 v[126:127], v177 offset:33920
    v_mfma_f32_16x16x32_bf16 v[92:95], v[148:151], v[60:63], v[92:95]
    s_add_u32 s37, s49, 12288
    buffer_load_dwordx4 v[248:251], v4, s[12:15], s37 offen sc1
    s_add_u32 s37, s49, 13312
    buffer_load_dwordx4 v[252:255], v4, s[12:15], s37 offen sc1
    ds_read_b64_tr_b16 v[128:129], v176 offset:36864
    ds_read_b64_tr_b16 v[130:131], v176 offset:39936
    s_waitcnt lgkmcnt(2)
    v_mfma_f32_16x16x32_bf16 v[72:75], v[104:107], v[64:67], v[72:75]
    ds_read_b64_tr_b16 v[132:133], v177 offset:36864
    ds_read_b64_tr_b16 v[134:135], v177 offset:39936
    v_mfma_f32_16x16x32_bf16 v[76:79], v[108:111], v[64:67], v[76:79]
    ds_read_b64_tr_b16 v[136:137], v176 offset:36928
    ds_read_b64_tr_b16 v[138:139], v176 offset:40000
    v_mfma_f32_16x16x32_bf16 v[80:83], v[112:115], v[64:67], v[80:83]
    ds_read_b64_tr_b16 v[140:141], v177 offset:36928
    ds_read_b64_tr_b16 v[142:143], v177 offset:40000
    v_mfma_f32_16x16x32_bf16 v[84:87], v[116:119], v[64:67], v[84:87]
    ds_read_b64_tr_b16 v[144:145], v176 offset:36992
    ds_read_b64_tr_b16 v[146:147], v176 offset:40064
    v_mfma_f32_16x16x32_bf16 v[88:91], v[120:123], v[64:67], v[88:91]
    ds_read_b64_tr_b16 v[148:149], v177 offset:36992
    ds_read_b64_tr_b16 v[150:151], v177 offset:40064
    v_mfma_f32_16x16x32_bf16 v[92:95], v[124:127], v[64:67], v[92:95]
    s_waitcnt lgkmcnt(0)
    v_mfma_f32_16x16x32_bf16 v[72:75], v[128:131], v[68:71], v[72:75]
    v_mfma_f32_16x16x32_bf16 v[76:79], v[132:135], v[68:71], v[76:79]
    v_mfma_f32_16x16x32_bf16 v[80:83], v[136:139], v[68:71], v[80:83]
    v_mfma_f32_16x16x32_bf16 v[84:87], v[140:143], v[68:71], v[84:87]
    v_mfma_f32_16x16x32_bf16 v[88:91], v[144:147], v[68:71], v[88:91]
    v_mfma_f32_16x16x32_bf16 v[92:95], v[148:151], v[68:71], v[92:95]
    s_waitcnt vmcnt(14)
    s_barrier
    s_lshl_b32 s37, s25, 8
    s_add_u32 s8, s76, s37
    s_addc_u32 s9, s77, 0
    s_sub_u32 s10, 0x188000, s37
    s_mov_b32 s11, 0x00020000
    s_lshl_b32 s42, s24, 3
    s_add_u32 s42, s42, s3
    s_mul_i32 s43, s42, 43008
    s_mul_i32 s40, s25, 3072
    s_add_u32 s43, s43, s40
    v_cvt_pk_bf16_f32 v104, v72, v73
    v_cvt_pk_bf16_f32 v105, v74, v75
    v_cvt_pk_bf16_f32 v106, v76, v77
    v_cvt_pk_bf16_f32 v107, v78, v79
    s_nop 1
    v_permlane32_swap_b32 v104, v106
    v_permlane32_swap_b32 v105, v107
    s_nop 1
    v_permlane16_swap_b32 v104, v106
    v_permlane16_swap_b32 v105, v107
    buffer_store_dwordx4 v[104:107], v4, s[12:15], s43 offen offset:0 sc1
    v_cvt_pk_bf16_f32 v108, v80, v81
    v_cvt_pk_bf16_f32 v109, v82, v83
    v_cvt_pk_bf16_f32 v110, v84, v85
    v_cvt_pk_bf16_f32 v111, v86, v87
    s_nop 1
    v_permlane32_swap_b32 v108, v110
    v_permlane32_swap_b32 v109, v111
    s_nop 1
    v_permlane16_swap_b32 v108, v110
    v_permlane16_swap_b32 v109, v111
    buffer_store_dwordx4 v[108:111], v4, s[12:15], s43 offen offset:1024 sc1
    v_cvt_pk_bf16_f32 v112, v88, v89
    v_cvt_pk_bf16_f32 v113, v90, v91
    v_cvt_pk_bf16_f32 v114, v92, v93
    v_cvt_pk_bf16_f32 v115, v94, v95
    s_nop 1
    v_permlane32_swap_b32 v112, v114
    v_permlane32_swap_b32 v113, v115
    s_nop 1
    v_permlane16_swap_b32 v112, v114
    v_permlane16_swap_b32 v113, v115
    buffer_store_dwordx4 v[112:115], v4, s[12:15], s43 offen offset:2048 sc1
    s_branch Lp1bend_5
Lcg9_3:
    s_waitcnt vmcnt(10)
    s_barrier
    s_cmp_ge_u32 s3, 6
    s_cbranch_scc1 Lnq_14
    s_mul_i32 s37, s40, 11
    s_add_u32 s37, s37, s39
    s_mov_b32 m0, s37
    s_lshl_b32 s38, s61, 1
    s_add_u32 s38, s38, 1
    s_mul_i32 s38, s38, s41
    buffer_load_dwordx4 v169, s[8:11], s38 offen lds
Lnq_14:
    ds_read_b64_tr_b16 v[104:105], v174 offset:0
    ds_read_b64_tr_b16 v[106:107], v174 offset:3072
    ds_read_b64_tr_b16 v[108:109], v175 offset:0
    ds_read_b64_tr_b16 v[110:111], v175 offset:3072
    ds_read_b64_tr_b16 v[112:113], v174 offset:64
    ds_read_b64_tr_b16 v[114:115], v174 offset:3136
    ds_read_b64_tr_b16 v[116:117], v175 offset:64
    ds_read_b64_tr_b16 v[118:119], v175 offset:3136
    ds_read_b64_tr_b16 v[120:121], v174 offset:128
    ds_read_b64_tr_b16 v[122:123], v174 offset:3200
    ds_read_b64_tr_b16 v[124:125], v175 offset:128
    ds_read_b64_tr_b16 v[126:127], v175 offset:3200
    s_cmp_ge_u32 s3, 6
    s_cbranch_scc1 Lnq_15
    s_mul_i32 s37, s40, 12
    s_add_u32 s37, s37, s39
    s_mov_b32 m0, s37
    s_lshl_b32 s38, s62, 1
    s_mul_i32 s38, s38, s41
    buffer_load_dwordx4 v169, s[8:11], s38 offen lds
Lnq_15:
    s_add_u32 s37, s47, 0
    s_mov_b32 m0, s37
    s_mov_b32 s38, 0
    buffer_load_dwordx4 v194, s[20:23], s38 offen lds
    ds_read_b64_tr_b16 v[128:129], v174 offset:6144
    ds_read_b64_tr_b16 v[130:131], v174 offset:9216
    s_waitcnt lgkmcnt(2)
    v_mfma_f32_16x16x32_bf16 v[72:75], v[104:107], v[16:19], 0
    ds_read_b64_tr_b16 v[132:133], v175 offset:6144
    ds_read_b64_tr_b16 v[134:135], v175 offset:9216
    v_mfma_f32_16x16x32_bf16 v[76:79], v[108:111], v[16:19], 0
    ds_read_b64_tr_b16 v[136:137], v174 offset:6208
    ds_read_b64_tr_b16 v[138:139], v174 offset:9280
    v_mfma_f32_16x16x32_bf16 v[80:83], v[16:19], v[112:115], 0
    ds_read_b64_tr_b16 v[140:141], v175 offset:6208
    ds_read_b64_tr_b16 v[142:143], v175 offset:9280
    v_mfma_f32_16x16x32_bf16 v[84:87], v[16:19], v[116:119], 0
    ds_read_b64_tr_b16 v[144:145], v174 offset:6272
    ds_read_b64_tr_b16 v[146:147], v174 offset:9344
    v_mfma_f32_16x16x32_bf16 v[88:91], v[16:19], v[120:123], 0
    ds_read_b64_tr_b16 v[148:149], v175 offset:6272
    ds_read_b64_tr_b16 v[150:151], v175 offset:9344
    v_mfma_f32_16x16x32_bf16 v[92:95], v[16:19], v[124:127], 0
    s_waitcnt vmcnt(1)
    s_barrier
    s_lshl_b32 s37, s24, 7
    s_lshl_b32 s38, s25, 2
    s_add_u32 s37, s37, s38
    s_add_u32 s37, s37, 0x1480000
    s_waitcnt lgkmcnt(0)
    s_mul_i32 s29, s29, 0x9E3779B1
    s_add_u32 s29, s29, 0x7F4A7C15
    s_cmp_lg_u32 s3, 0
    s_cbranch_scc1 Lpub_16
    v_mov_b32 v6, s29
    v_mov_b32 v7, 0
    s_mov_b64 exec, 1
    buffer_store_dword v6, v7, s[12:15], s37 offen sc1
    s_mov_b64 exec, -1
Lpub_16:
    s_cmp_ge_u32 s3, 6
    s_cbranch_scc1 Lnq_17
    s_mul_i32 s37, s40, 13
    s_add_u32 s37, s37, s39
    s_mov_b32 m0, s37
    s_lshl_b32 s38, s62, 1
    s_add_u32 s38, s38, 1
    s_mul_i32 s38, s38, s41
    buffer_load_dwordx4 v169, s[8:11], s38 offen lds
Lnq_17:
    s_add_u32 s37, s47, 8192
    s_mov_b32 m0, s37
    s_mov_b32 s38, 57344
    buffer_load_dwordx4 v194, s[20:23], s38 offen lds
    ds_read_b64_tr_b16 v[104:105], v174 offset:12288
    ds_read_b64_tr_b16 v[106:107], v174 offset:15360
    s_waitcnt lgkmcnt(2)
    v_mfma_f32_16x16x32_bf16 v[72:75], v[128:131], v[20:23], v[72:75]
    ds_read_b64_tr_b16 v[108:109], v175 offset:12288
    ds_read_b64_tr_b16 v[110:111], v175 offset:15360
    v_mfma_f32_16x16x32_bf16 v[76:79], v[132:135], v[20:23], v[76:79]
    ds_read_b64_tr_b16 v[112:113], v174 offset:12352
    ds_read_b64_tr_b16 v[114:115], v174 offset:15424
    v_mfma_f32_16x16x32_bf16 v[80:83], v[20:23], v[136:139], v[80:83]
    ds_read_b64_tr_b16 v[116:117], v175 offset:12352
    ds_read_b64_tr_b16 v[118:119], v175 offset:15424
    v_mfma_f32_16x16x32_bf16 v[84:87], v[20:23], v[140:143], v[84:87]
    ds_read_b64_tr_b16 v[120:121], v174 offset:12416
    ds_read_b64_tr_b16 v[122:123], v174 offset:15488
    v_mfma_f32_16x16x32_bf16 v[88:91], v[20:23], v[144:147], v[88:91]
    ds_read_b64_tr_b16 v[124:125], v175 offset:12416
    ds_read_b64_tr_b16 v[126:127], v175 offset:15488
    v_mfma_f32_16x16x32_bf16 v[92:95], v[20:23], v[148:151], v[92:95]
    s_add_u32 s37, s47, 16384
    s_mov_b32 m0, s37
    s_mov_b32 s38, 114688
    buffer_load_dwordx4 v194, s[20:23], s38 offen lds
    ds_read_b64_tr_b16 v[128:129], v174 offset:18432
    ds_read_b64_tr_b16 v[130:131], v174 offset:21504
    s_waitcnt lgkmcnt(2)
    v_mfma_f32_16x16x32_bf16 v[72:75], v[104:107], v[24:27], v[72:75]
    ds_read_b64_tr_b16 v[132:133], v175 offset:18432
    ds_read_b64_tr_b16 v[134:135], v175 offset:21504
    v_mfma_f32_16x16x32_bf16 v[76:79], v[108:111], v[24:27], v[76:79]
    ds_read_b64_tr_b16 v[136:137], v174 offset:18496
    ds_read_b64_tr_b16 v[138:139], v174 offset:21568
    v_mfma_f32_16x16x32_bf16 v[80:83], v[24:27], v[112:115], v[80:83]
    ds_read_b64_tr_b16 v[140:141], v175 offset:18496
    ds_read_b64_tr_b16 v[142:143], v175 offset:21568
    v_mfma_f32_16x16x32_bf16 v[84:87], v[24:27], v[116:119], v[84:87]
    ds_read_b64_tr_b16 v[144:145], v174 offset:18560
    ds_read_b64_tr_b16 v[146:147], v174 offset:21632
    v_mfma_f32_16x16x32_bf16 v[88:91], v[24:27], v[120:123], v[88:91]
    ds_read_b64_tr_b16 v[148:149], v175 offset:18560
    ds_read_b64_tr_b16 v[150:151], v175 offset:21632
    v_mfma_f32_16x16x32_bf16 v[92:95], v[24:27], v[124:127], v[92:95]
    s_waitcnt vmcnt(12)
    s_barrier
    s_add_u32 s37, s47, 24576
    s_mov_b32 m0, s37
    s_mov_b32 s38, 172032
    buffer_load_dwordx4 v194, s[20:23], s38 offen lds
    ds_read_b64_tr_b16 v[104:105], v174 offset:24576
    ds_read_b64_tr_b16 v[106:107], v174 offset:27648
    s_waitcnt lgkmcnt(2)
    v_mfma_f32_16x16x32_bf16 v[72:75], v[128:131], v[28:31], v[72:75]
    ds_read_b64_tr_b16 v[108:109], v175 offset:24576
    ds_read_b64_tr_b16 v[110:111], v175 offset:27648
    v_mfma_f32_16x16x32_bf16 v[76:79], v[132:135], v[28:31], v[76:79]
    ds_read_b64_tr_b16 v[112:113], v174 offset:24640
    ds_read_b64_tr_b16 v[114:115], v174 offset:27712
    v_mfma_f32_16x16x32_bf16 v[80:83], v[28:31], v[136:139], v[80:83]
    ds_read_b64_tr_b16 v[116:117], v175 offset:24640
    ds_read_b64_tr_b16 v[118:119], v175 offset:27712
    v_mfma_f32_16x16x32_bf16 v[84:87], v[28:31], v[140:143], v[84:87]
    ds_read_b64_tr_b16 v[120:121], v174 offset:24704
    ds_read_b64_tr_b16 v[122:123], v174 offset:27776
    v_mfma_f32_16x16x32_bf16 v[88:91], v[28:31], v[144:147], v[88:91]
    ds_read_b64_tr_b16 v[124:125], v175 offset:24704
    ds_read_b64_tr_b16 v[126:127], v175 offset:27776
    v_mfma_f32_16x16x32_bf16 v[92:95], v[28:31], v[148:151], v[92:95]
    s_add_u32 s37, s47, 32768
    s_mov_b32 m0, s37
    s_mov_b32 s38, 229376
    buffer_load_dwordx4 v194, s[20:23], s38 offen lds
    ds_read_b64_tr_b16 v[128:129], v174 offset:30720
    ds_read_b64_tr_b16 v[130:131], v174 offset:33792
    s_waitcnt lgkmcnt(2)
    v_mfma_f32_16x16x32_bf16 v[72:75], v[104:107], v[32:35], v[72:75]
    ds_read_b64_tr_b16 v[132:133], v175 offset:30720
    ds_read_b64_tr_b16 v[134:135], v175 offset:33792
    v_mfma_f32_16x16x32_bf16 v[76:79], v[108:111], v[32:35], v[76:79]
    ds_read_b64_tr_b16 v[136:137], v174 offset:30784
    ds_read_b64_tr_b16 v[138:139], v174 offset:33856
    v_mfma_f32_16x16x32_bf16 v[80:83], v[32:35], v[112:115], v[80:83]
    ds_read_b64_tr_b16 v[140:141], v175 offset:30784
    ds_read_b64_tr_b16 v[142:143], v175 offset:33856
    v_mfma_f32_16x16x32_bf16 v[84:87], v[32:35], v[116:119], v[84:87]
    ds_read_b64_tr_b16 v[144:145], v174 offset:30848
    ds_read_b64_tr_b16 v[146:147], v174 offset:33920
    v_mfma_f32_16x16x32_bf16 v[88:91], v[32:35], v[120:123], v[88:91]
    ds_read_b64_tr_b16 v[148:149], v175 offset:30848
    ds_read_b64_tr_b16 v[150:151], v175 offset:33920
    v_mfma_f32_16x16x32_bf16 v[92:95], v[32:35], v[124:127], v[92:95]
    s_waitcnt vmcnt(12)
    s_barrier
    s_cmp_lg_u32 s3, 0
    s_cbranch_scc1 Lfi_18
    s_mov_b32 exec_lo, 0x3fff3fff
    s_mov_b32 exec_hi, 0x0
    buffer_load_dword v198, v197, s[12:15], 0 offen sc1
    s_mov_b64 exec, -1
Lfi_18:
    s_add_u32 s37, s47, 40960
    s_mov_b32 m0, s37
    s_mov_b32 s38, 286720
    buffer_load_dwordx4 v194, s[20:23], s38 offen lds
    ds_read_b64_tr_b16 v[104:105], v174 offset:36864
    ds_read_b64_tr_b16 v[106:107], v174 offset:39936
    s_waitcnt lgkmcnt(2)
    v_mfma_f32_16x16x32_bf16 v[72:75], v[128:131], v[36:39], v[72:75]
    ds_read_b64_tr_b16 v[108:109], v175 offset:36864
    ds_read_b64_tr_b16 v[110:111], v175 offset:39936
    v_mfma_f32_16x16x32_bf16 v[76:79], v[132:135], v[36:39], v[76:79]
    ds_read_b64_tr_b16 v[112:113], v174 offset:36928
    ds_read_b64_tr_b16 v[114:115], v174 offset:40000
    v_mfma_f32_16x16x32_bf16 v[80:83], v[36:39], v[136:139], v[80:83]
    ds_read_b64_tr_b16 v[116:117], v175 offset:36928
    ds_read_b64_tr_b16 v[118:119], v175 offset:40000
    v_mfma_f32_16x16x32_bf16 v[84:87], v[36:39], v[140:143], v[84:87]
    ds_read_b64_tr_b16 v[120:121], v174 offset:36992
    ds_read_b64_tr_b16 v[122:123], v174 offset:40064
    v_mfma_f32_16x16x32_bf16 v[88:91], v[36:39], v[144:147], v[88:91]
    ds_read_b64_tr_b16 v[124:125], v175 offset:36992
    ds_read_b64_tr_b16 v[126:127], v175 offset:40064
    v_mfma_f32_16x16x32_bf16 v[92:95], v[36:39], v[148:151], v[92:95]
    s_add_u32 s37, s47, 49152
    s_mov_b32 m0, s37
    s_mov_b32 s38, 344064
    buffer_load_dwordx4 v194, s[20:23], s38 offen lds
    ds_read_b64_tr_b16 v[128:129], v176 offset:0
    ds_read_b64_tr_b16 v[130:131], v176 offset:3072
    s_waitcnt lgkmcnt(2)
    v_mfma_f32_16x16x32_bf16 v[72:75], v[104:107], v[40:43], v[72:75]
    ds_read_b64_tr_b16 v[132:133], v177 offset:0
    ds_read_b64_tr_b16 v[134:135], v177 offset:3072
    v_mfma_f32_16x16x32_bf16 v[76:79], v[108:111], v[40:43], v[76:79]
    ds_read_b64_tr_b16 v[136:137], v176 offset:64
    ds_read_b64_tr_b16 v[138:139], v176 offset:3136
    v_mfma_f32_16x16x32_bf16 v[80:83], v[40:43], v[112:115], v[80:83]
    ds_read_b64_tr_b16 v[140:141], v177 offset:64
    ds_read_b64_tr_b16 v[142:143], v177 offset:3136
    v_mfma_f32_16x16x32_bf16 v[84:87], v[40:43], v[116:119], v[84:87]
    ds_read_b64_tr_b16 v[144:145], v176 offset:128
    ds_read_b64_tr_b16 v[146:147], v176 offset:3200
    v_mfma_f32_16x16x32_bf16 v[88:91], v[40:43], v[120:123], v[88:91]
    ds_read_b64_tr_b16 v[148:149], v177 offset:128
    ds_read_b64_tr_b16 v[150:151], v177 offset:3200
    v_mfma_f32_16x16x32_bf16 v[92:95], v[40:43], v[124:127], v[92:95]
    s_cmp_lg_u32 s3, 0
    s_cbranch_scc1 Lfc_19
    s_mov_b32 exec_lo, 0x3fff3fff
    s_mov_b32 exec_hi, 0x0
    s_mov_b32 s63, 0
    s_waitcnt vmcnt(2)
Lfl_20:
    v_cmp_ne_u32 vcc, s29, v198
    s_nop 1
    s_cbranch_vccz Lfd_21
    s_sleep 4
    buffer_load_dword v198, v197, s[12:15], 0 offen sc1
    s_waitcnt vmcnt(0)
    s_add_u32 s63, s63, 1
    s_cmp_lt_u32 s63, 200000
    s_cbranch_scc1 Lfl_20
    v_mov_b32 v6, 1
    v_mov_b32 v7, 4
    buffer_store_dword v6, v7, s[16:19], 0 offen
Lfd_21:
    s_mov_b64 exec, -1
Lfc_19:
    s_waitcnt vmcnt(12)
    s_barrier
    s_add_u32 s37, s49, 0
    buffer_load_dwordx4 v[200:203], v4, s[12:15], s37 offen sc1
    s_add_u32 s37, s49, 1024
    buffer_load_dwordx4 v[204:207], v4, s[12:15], s37 offen sc1
    s_add_u32 s37, s49, 2048
    buffer_load_dwordx4 v[208:211], v4, s[12:15], s37 offen sc1
    ds_read_b64_tr_b16 v[104:105], v176 offset:6144
    ds_read_b64_tr_b16 v[106:107], v176 offset:9216
    s_waitcnt lgkmcnt(2)
    v_mfma_f32_16x16x32_bf16 v[72:75], v[128:131], v[44:47], v[72:75]
    ds_read_b64_tr_b16 v[108:109], v177 offset:6144
    ds_read_b64_tr_b16 v[110:111], v177 offset:9216
    v_mfma_f32_16x16x32_bf16 v[76:79], v[132:135], v[44:47], v[76:79]
    ds_read_b64_tr_b16 v[112:113], v176 offset:6208
    ds_read_b64_tr_b16 v[114:115], v176 offset:9280
    v_mfma_f32_16x16x32_bf16 v[80:83], v[44:47], v[136:139], v[80:83]
    ds_read_b64_tr_b16 v[116:117], v177 offset:6208
    ds_read_b64_tr_b16 v[118:119], v177 offset:9280
    v_mfma_f32_16x16x32_bf16 v[84:87], v[44:47], v[140:143], v[84:87]
    ds_read_b64_tr_b16 v[120:121], v176 offset:6272
    ds_read_b64_tr_b16 v[122:123], v176 offset:9344
    v_mfma_f32_16x16x32_bf16 v[88:91], v[44:47], v[144:147], v[88:91]
    ds_read_b64_tr_b16 v[124:125], v177 offset:6272
    ds_read_b64_tr_b16 v[126:127], v177 offset:9344
    v_mfma_f32_16x16x32_bf16 v[92:95], v[44:47], v[148:151], v[92:95]
    s_add_u32 s37, s49, 3072
    buffer_load_dwordx4 v[212:215], v4, s[12:15], s37 offen sc1
    s_add_u32 s37, s49, 4096
    buffer_load_dwordx4 v[216:219], v4, s[12:15], s37 offen sc1
    s_add_u32 s37, s49, 5120
    buffer_load_dwordx4 v[220:223], v4, s[12:15], s37 offen sc1
    ds_read_b64_tr_b16 v[128:129], v176 offset:12288
    ds_read_b64_tr_b16 v[130:131], v176 offset:15360
    s_waitcnt lgkmcnt(2)
    v_mfma_f32_16x16x32_bf16 v[72:75], v[104:107], v[48:51], v[72:75]
    ds_read_b64_tr_b16 v[132:133], v177 offset:12288
    ds_read_b64_tr_b16 v[134:135], v177 offset:15360
    v_mfma_f32_16x16x32_bf16 v[76:79], v[108:111], v[48:51], v[76:79]
    ds_read_b64_tr_b16 v[136:137], v176 offset:12352
    ds_read_b64_tr_b16 v[138:139], v176 offset:15424
    v_mfma_f32_16x16x32_bf16 v[80:83], v[48:51], v[112:115], v[80:83]
    ds_read_b64_tr_b16 v[140:141], v177 offset:12352
    ds_read_b64_tr_b16 v[142:143], v177 offset:15424
    v_mfma_f32_16x16x32_bf16 v[84:87], v[48:51], v[116:119], v[84:87]
    ds_read_b64_tr_b16 v[144:145], v176 offset:12416
    ds_read_b64_tr_b16 v[146:147], v176 offset:15488
    v_mfma_f32_16x16x32_bf16 v[88:91], v[48:51], v[120:123], v[88:91]
    ds_read_b64_tr_b16 v[148:149], v177 offset:12416
    ds_read_b64_tr_b16 v[150:151], v177 offset:15488
    v_mfma_f32_16x16x32_bf16 v[92:95], v[48:51], v[124:127], v[92:95]
    s_waitcnt vmcnt(15)
    s_barrier
    s_add_u32 s37, s49, 6144
    buffer_load_dwordx4 v[224:227], v4, s[12:15], s37 offen sc1
    s_add_u32 s37, s49, 7168
    buffer_load_dwordx4 v[228:231], v4, s[12:15], s37 offen sc1
    ds_read_b64_tr_b16 v[104:105], v176 offset:18432
    ds_read_b64_tr_b16 v[106:107], v176 offset:21504
    s_waitcnt lgkmcnt(2)
    v_mfma_f32_16x16x32_bf16 v[72:75], v[128:131], v[52:55], v[72:75]
    ds_read_b64_tr_b16 v[108:109], v177 offset:18432
    ds_read_b64_tr_b16 v[110:111], v177 offset:21504
    v_mfma_f32_16x16x32_bf16 v[76:79], v[132:135], v[52:55], v[76:79]
    ds_read_b64_tr_b16 v[112:113], v176 offset:18496
    ds_read_b64_tr_b16 v[114:115], v176 offset:21568
    v_mfma_f32_16x16x32_bf16 v[80:83], v[52:55], v[136:139], v[80:83]
    ds_read_b64_tr_b16 v[116:117], v177 offset:18496
    ds_read_b64_tr_b16 v[118:119], v177 offset:21568
    v_mfma_f32_16x16x32_bf16 v[84:87], v[52:55], v[140:143], v[84:87]
    ds_read_b64_tr_b16 v[120:121], v176 offset:18560
    ds_read_b64_tr_b16 v[122:123], v176 offset:21632
    v_mfma_f32_16x16x32_bf16 v[88:91], v[52:55], v[144:147], v[88:91]
    ds_read_b64_tr_b16 v[124:125], v177 offset:18560
    ds_read_b64_tr_b16 v[126:127], v177 offset:21632
    v_mfma_f32_16x16x32_bf16 v[92:95], v[52:55], v[148:151], v[92:95]
    s_add_u32 s37, s49, 8192
    buffer_load_dwordx4 v[232:235], v4, s[12:15], s37 offen sc1
    s_add_u32 s37, s49, 9216
    buffer_load_dwordx4 v[236:239], v4, s[12:15], s37 offen sc1
    ds_read_b64_tr_b16 v[128:129], v176 offset:24576
    ds_read_b64_tr_b16 v[130:131], v176 offset:27648
    s_waitcnt lgkmcnt(2)
    v_mfma_f32_16x16x32_bf16 v[72:75], v[104:107], v[56:59], v[72:75]
    ds_read_b64_tr_b16 v[132:133], v177 offset:24576
    ds_read_b64_tr_b16 v[134:135], v177 offset:27648
    v_mfma_f32_16x16x32_bf16 v[76:79], v[108:111], v[56:59], v[76:79]
    ds_read_b64_tr_b16 v[136:137], v176 offset:24640
    ds_read_b64_tr_b16 v[138:139], v176 offset:27712
    v_mfma_f32_16x16x32_bf16 v[80:83], v[56:59], v[112:115], v[80:83]
    ds_read_b64_tr_b16 v[140:141], v177 offset:24640
    ds_read_b64_tr_b16 v[142:143], v177 offset:27712
    v_mfma_f32_16x16x32_bf16 v[84:87], v[56:59], v[116:119], v[84:87]
    ds_read_b64_tr_b16 v[144:145], v176 offset:24704
    ds_read_b64_tr_b16 v[146:147], v176 offset:27776
    v_mfma_f32_16x16x32_bf16 v[88:91], v[56:59], v[120:123], v[88:91]
    ds_read_b64_tr_b16 v[148:149], v177 offset:24704
    ds_read_b64_tr_b16 v[150:151], v177 offset:27776
    v_mfma_f32_16x16x32_bf16 v[92:95], v[56:59], v[124:127], v[92:95]
    s_waitcnt vmcnt(16)
    s_barrier
    s_add_u32 s37, s49, 10240
    buffer_load_dwordx4 v[240:243], v4, s[12:15], s37 offen sc1
    s_add_u32 s37, s49, 11264
    buffer_load_dwordx4 v[244:247], v4, s[12:15], s37 offen sc1
    ds_read_b64_tr_b16 v[104:105], v176 offset:30720
    ds_read_b64_tr_b16 v[106:107], v176 offset:33792
    s_waitcnt lgkmcnt(2)
    v_mfma_f32_16x16x32_bf16 v[72:75], v[128:131], v[60:63], v[72:75]
    ds_read_b64_tr_b16 v[108:109], v177 offset:30720
    ds_read_b64_tr_b16 v[110:111], v177 offset:33792
    v_mfma_f32_16x16x32_bf16 v[76:79], v[132:135], v[60:63], v[76:79]
    ds_read_b64_tr_b16 v[112:113], v176 offset:30784
    ds_read_b64_tr_b16 v[114:115], v176 offset:33856
    v_mfma_f32_16x16x32_bf16 v[80:83], v[60:63], v[136:139], v[80:83]
    ds_read_b64_tr_b16 v[116:117], v177 offset:30784
    ds_read_b64_tr_b16 v[118:119], v177 offset:33856
    v_mfma_f32_16x16x32_bf16 v[84:87], v[60:63], v[140:143], v[84:87]
    ds_read_b64_tr_b16 v[120:121], v176 offset:30848
    ds_read_b64_tr_b16 v[122:123], v176 offset:33920
    v_mfma_f32_16x16x32_bf16 v[88:91], v[60:63], v[144:147], v[88:91]
    ds_read_b64_tr_b16 v[124:125], v177 offset:30848
    ds_read_b64_tr_b16 v[126:127], v177 offset:33920
    v_mfma_f32_16x16x32_bf16 v[92:95], v[60:63], v[148:151], v[92:95]
    s_add_u32 s37, s49, 12288
    buffer_load_dwordx4 v[248:251], v4, s[12:15], s37 offen sc1
    s_add_u32 s37, s49, 13312
    buffer_load_dwordx4 v[252:255], v4, s[12:15], s37 offen sc1
    ds_read_b64_tr_b16 v[128:129], v176 offset:36864
    ds_read_b64_tr_b16 v[130:131], v176 offset:39936
    s_waitcnt lgkmcnt(2)
    v_mfma_f32_16x16x32_bf16 v[72:75], v[104:107], v[64:67], v[72:75]
    ds_read_b64_tr_b16 v[132:133], v177 offset:36864
    ds_read_b64_tr_b16 v[134:135], v177 offset:39936
    v_mfma_f32_16x16x32_bf16 v[76:79], v[108:111], v[64:67], v[76:79]
    ds_read_b64_tr_b16 v[136:137], v176 offset:36928
    ds_read_b64_tr_b16 v[138:139], v176 offset:40000
    v_mfma_f32_16x16x32_bf16 v[80:83], v[64:67], v[112:115], v[80:83]
    ds_read_b64_tr_b16 v[140:141], v177 offset:36928
    ds_read_b64_tr_b16 v[142:143], v177 offset:40000
    v_mfma_f32_16x16x32_bf16 v[84:87], v[64:67], v[116:119], v[84:87]
    ds_read_b64_tr_b16 v[144:145], v176 offset:36992
    ds_read_b64_tr_b16 v[146:147], v176 offset:40064
    v_mfma_f32_16x16x32_bf16 v[88:91], v[64:67], v[120:123], v[88:91]
    ds_read_b64_tr_b16 v[148:149], v177 offset:36992
    ds_read_b64_tr_b16 v[150:151], v177 offset:40064
    v_mfma_f32_16x16x32_bf16 v[92:95], v[64:67], v[124:127], v[92:95]
    s_waitcnt lgkmcnt(0)
    v_mfma_f32_16x16x32_bf16 v[72:75], v[128:131], v[68:71], v[72:75]
    v_mfma_f32_16x16x32_bf16 v[76:79], v[132:135], v[68:71], v[76:79]
    v_mfma_f32_16x16x32_bf16 v[80:83], v[68:71], v[136:139], v[80:83]
    v_mfma_f32_16x16x32_bf16 v[84:87], v[68:71], v[140:143], v[84:87]
    v_mfma_f32_16x16x32_bf16 v[88:91], v[68:71], v[144:147], v[88:91]
    v_mfma_f32_16x16x32_bf16 v[92:95], v[68:71], v[148:151], v[92:95]
    s_waitcnt vmcnt(14)
    s_barrier
    s_lshl_b32 s37, s25, 8
    s_add_u32 s8, s76, s37
    s_addc_u32 s9, s77, 0
    s_sub_u32 s10, 0x188000, s37
    s_mov_b32 s11, 0x00020000
    s_lshl_b32 s42, s24, 3
    s_add_u32 s42, s42, s3
    s_mul_i32 s43, s42, 43008
    s_mul_i32 s40, s25, 3072
    s_add_u32 s43, s43, s40
    v_cvt_pk_bf16_f32 v104, v72, v73
    v_cvt_pk_bf16_f32 v105, v74, v75
    v_cvt_pk_bf16_f32 v106, v76, v77
    v_cvt_pk_bf16_f32 v107, v78, v79
    s_nop 1
    v_permlane32_swap_b32 v104, v106
    v_permlane32_swap_b32 v105, v107
    s_nop 1
    v_permlane16_swap_b32 v104, v106
    v_permlane16_swap_b32 v105, v107
    buffer_store_dwordx4 v[104:107], v4, s[12:15], s43 offen offset:0 sc1
    v_cvt_pk_bf16_f32 v108, v80, v81
    v_cvt_pk_bf16_f32 v109, v82, v83
    v_cvt_pk_bf16_f32 v110, v84, v85
    v_cvt_pk_bf16_f32 v111, v86, v87
    s_nop 1
    v_permlane32_swap_b32 v108, v110
    v_permlane32_swap_b32 v109, v111
    s_nop 1
    v_permlane16_swap_b32 v108, v110
    v_permlane16_swap_b32 v109, v111
    buffer_store_dwordx4 v[108:111], v4, s[12:15], s43 offen offset:1024 sc1
    v_cvt_pk_bf16_f32 v112, v88, v89
    v_cvt_pk_bf16_f32 v113, v90, v91
    v_cvt_pk_bf16_f32 v114, v92, v93
    v_cvt_pk_bf16_f32 v115, v94, v95
    s_nop 1
    v_permlane32_swap_b32 v112, v114
    v_permlane32_swap_b32 v113, v115
    s_nop 1
    v_permlane16_swap_b32 v112, v114
    v_permlane16_swap_b32 v113, v115
    buffer_store_dwordx4 v[112:115], v4, s[12:15], s43 offen offset:2048 sc1
    s_branch Lp1bend_5
Lcgv_4:
    s_waitcnt vmcnt(10)
    s_barrier
    s_cmp_ge_u32 s3, 6
    s_cbranch_scc1 Lnq_22
    s_mul_i32 s37, s40, 11
    s_add_u32 s37, s37, s39
    s_mov_b32 m0, s37
    s_lshl_b32 s38, s61, 1
    s_add_u32 s38, s38, 1
    s_mul_i32 s38, s38, s41
    buffer_load_dwordx4 v169, s[8:11], s38 offen lds
Lnq_22:
    ds_read_b64_tr_b16 v[104:105], v174 offset:0
    ds_read_b64_tr_b16 v[106:107], v174 offset:3072
    ds_read_b64_tr_b16 v[108:109], v175 offset:0
    ds_read_b64_tr_b16 v[110:111], v175 offset:3072
    ds_read_b64_tr_b16 v[112:113], v174 offset:64
    ds_read_b64_tr_b16 v[114:115], v174 offset:3136
    ds_read_b64_tr_b16 v[116:117], v175 offset:64
    ds_read_b64_tr_b16 v[118:119], v175 offset:3136
    ds_read_b64_tr_b16 v[120:121], v174 offset:128
    ds_read_b64_tr_b16 v[122:123], v174 offset:3200
    ds_read_b64_tr_b16 v[124:125], v175 offset:128
    ds_read_b64_tr_b16 v[126:127], v175 offset:3200
    s_cmp_ge_u32 s3, 6
    s_cbranch_scc1 Lnq_23
    s_mul_i32 s37, s40, 12
    s_add_u32 s37, s37, s39
    s_mov_b32 m0, s37
    s_lshl_b32 s38, s62, 1
    s_mul_i32 s38, s38, s41
    buffer_load_dwordx4 v169, s[8:11], s38 offen lds
Lnq_23:
    s_add_u32 s37, s47, 0
    s_mov_b32 m0, s37
    s_mov_b32 s38, 0
    buffer_load_dwordx4 v194, s[20:23], s38 offen lds
    ds_read_b64_tr_b16 v[128:129], v174 offset:6144
    ds_read_b64_tr_b16 v[130:131], v174 offset:9216
    s_waitcnt lgkmcnt(2)
    v_mfma_f32_16x16x32_bf16 v[72:75], v[16:19], v[104:107], 0
    ds_read_b64_tr_b16 v[132:133], v175 offset:6144
    ds_read_b64_tr_b16 v[134:135], v175 offset:9216
    v_mfma_f32_16x16x32_bf16 v[76:79], v[16:19], v[108:111], 0
    ds_read_b64_tr_b16 v[136:137], v174 offset:6208
    ds_read_b64_tr_b16 v[138:139], v174 offset:9280
    v_mfma_f32_16x16x32_bf16 v[80:83], v[16:19], v[112:115], 0
    ds_read_b64_tr_b16 v[140:141], v175 offset:6208
    ds_read_b64_tr_b16 v[142:143], v175 offset:9280
    v_mfma_f32_16x16x32_bf16 v[84:87], v[16:19], v[116:119], 0
    ds_read_b64_tr_b16 v[144:145], v174 offset:6272
    ds_read_b64_tr_b16 v[146:147], v174 offset:9344
    v_mfma_f32_16x16x32_bf16 v[88:91], v[16:19], v[120:123], 0
    ds_read_b64_tr_b16 v[148:149], v175 offset:6272
    ds_read_b64_tr_b16 v[150:151], v175 offset:9344
    v_mfma_f32_16x16x32_bf16 v[92:95], v[16:19], v[124:127], 0
    s_waitcnt vmcnt(1)
    s_barrier
    s_lshl_b32 s37, s24, 7
    s_lshl_b32 s38, s25, 2
    s_add_u32 s37, s37, s38
    s_add_u32 s37, s37, 0x1480000
    s_waitcnt lgkmcnt(0)
    s_mul_i32 s29, s29, 0x9E3779B1
    s_add_u32 s29, s29, 0x7F4A7C15
    s_cmp_lg_u32 s3, 0
    s_cbranch_scc1 Lpub_24
    v_mov_b32 v6, s29
    v_mov_b32 v7, 0
    s_mov_b64 exec, 1
    buffer_store_dword v6, v7, s[12:15], s37 offen sc1
    s_mov_b64 exec, -1
Lpub_24:
    s_cmp_ge_u32 s3, 6
    s_cbranch_scc1 Lnq_25
    s_mul_i32 s37, s40, 13
    s_add_u32 s37, s37, s39
    s_mov_b32 m0, s37
    s_lshl_b32 s38, s62, 1
    s_add_u32 s38, s38, 1
    s_mul_i32 s38, s38, s41
    buffer_load_dwordx4 v169, s[8:11], s38 offen lds
Lnq_25:
    s_add_u32 s37, s47, 8192
    s_mov_b32 m0, s37
    s_mov_b32 s38, 57344
    buffer_load_dwordx4 v194, s[20:23], s38 offen lds
    ds_read_b64_tr_b16 v[104:105], v174 offset:12288
    ds_read_b64_tr_b16 v[106:107], v174 offset:15360
    s_waitcnt lgkmcnt(2)
    v_mfma_f32_16x16x32_bf16 v[72:75], v[20:23], v[128:131], v[72:75]
    ds_read_b64_tr_b16 v[108:109], v175 offset:12288
    ds_read_b64_tr_b16 v[110:111], v175 offset:15360
    v_mfma_f32_16x16x32_bf16 v[76:79], v[20:23], v[132:135], v[76:79]
    ds_read_b64_tr_b16 v[112:113], v174 offset:12352
    ds_read_b64_tr_b16 v[114:115], v174 offset:15424
    v_mfma_f32_16x16x32_bf16 v[80:83], v[20:23], v[136:139], v[80:83]
    ds_read_b64_tr_b16 v[116:117], v175 offset:12352
    ds_read_b64_tr_b16 v[118:119], v175 offset:15424
    v_mfma_f32_16x16x32_bf16 v[84:87], v[20:23], v[140:143], v[84:87]
    ds_read_b64_tr_b16 v[120:121], v174 offset:12416
    ds_read_b64_tr_b16 v[122:123], v174 offset:15488
    v_mfma_f32_16x16x32_bf16 v[88:91], v[20:23], v[144:147], v[88:91]
    ds_read_b64_tr_b16 v[124:125], v175 offset:12416
    ds_read_b64_tr_b16 v[126:127], v175 offset:15488
    v_mfma_f32_16x16x32_bf16 v[92:95], v[20:23], v[148:151], v[92:95]
    s_add_u32 s37, s47, 16384
    s_mov_b32 m0, s37
    s_mov_b32 s38, 114688
    buffer_load_dwordx4 v194, s[20:23], s38 offen lds
    ds_read_b64_tr_b16 v[128:129], v174 offset:18432
    ds_read_b64_tr_b16 v[130:131], v174 offset:21504
    s_waitcnt lgkmcnt(2)
    v_mfma_f32_16x16x32_bf16 v[72:75], v[24:27], v[104:107], v[72:75]
    ds_read_b64_tr_b16 v[132:133], v175 offset:18432
    ds_read_b64_tr_b16 v[134:135], v175 offset:21504
    v_mfma_f32_16x16x32_bf16 v[76:79], v[24:27], v[108:111], v[76:79]
    ds_read_b64_tr_b16 v[136:137], v174 offset:18496
    ds_read_b64_tr_b16 v[138:139], v174 offset:21568
    v_mfma_f32_16x16x32_bf16 v[80:83], v[24:27], v[112:115], v[80:83]
    ds_read_b64_tr_b16 v[140:141], v175 offset:18496
    ds_read_b64_tr_b16 v[142:143], v175 offset:21568
    v_mfma_f32_16x16x32_bf16 v[84:87], v[24:27], v[116:119], v[84:87]
    ds_read_b64_tr_b16 v[144:145], v174 offset:18560
    ds_read_b64_tr_b16 v[146:147], v174 offset:21632
    v_mfma_f32_16x16x32_bf16 v[88:91], v[24:27], v[120:123], v[88:91]
    ds_read_b64_tr_b16 v[148:149], v175 offset:18560
    ds_read_b64_tr_b16 v[150:151], v175 offset:21632
    v_mfma_f32_16x16x32_bf16 v[92:95], v[24:27], v[124:127], v[92:95]
    s_waitcnt vmcnt(12)
    s_barrier
    s_add_u32 s37, s47, 24576
    s_mov_b32 m0, s37
    s_mov_b32 s38, 172032
    buffer_load_dwordx4 v194, s[20:23], s38 offen lds
    ds_read_b64_tr_b16 v[104:105], v174 offset:24576
    ds_read_b64_tr_b16 v[106:107], v174 offset:27648
    s_waitcnt lgkmcnt(2)
    v_mfma_f32_16x16x32_bf16 v[72:75], v[28:31], v[128:131], v[72:75]
    ds_read_b64_tr_b16 v[108:109], v175 offset:24576
    ds_read_b64_tr_b16 v[110:111], v175 offset:27648
    v_mfma_f32_16x16x32_bf16 v[76:79], v[28:31], v[132:135], v[76:79]
    ds_read_b64_tr_b16 v[112:113], v174 offset:24640
    ds_read_b64_tr_b16 v[114:115], v174 offset:27712
    v_mfma_f32_16x16x32_bf16 v[80:83], v[28:31], v[136:139], v[80:83]
    ds_read_b64_tr_b16 v[116:117], v175 offset:24640
    ds_read_b64_tr_b16 v[118:119], v175 offset:27712
    v_mfma_f32_16x16x32_bf16 v[84:87], v[28:31], v[140:143], v[84:87]
    ds_read_b64_tr_b16 v[120:121], v174 offset:24704
    ds_read_b64_tr_b16 v[122:123], v174 offset:27776
    v_mfma_f32_16x16x32_bf16 v[88:91], v[28:31], v[144:147], v[88:91]
    ds_read_b64_tr_b16 v[124:125], v175 offset:24704
    ds_read_b64_tr_b16 v[126:127], v175 offset:27776
    v_mfma_f32_16x16x32_bf16 v[92:95], v[28:31], v[148:151], v[92:95]
    s_add_u32 s37, s47, 32768
    s_mov_b32 m0, s37
    s_mov_b32 s38, 229376
    buffer_load_dwordx4 v194, s[20:23], s38 offen lds
    ds_read_b64_tr_b16 v[128:129], v174 offset:30720
    ds_read_b64_tr_b16 v[130:131], v174 offset:33792
    s_waitcnt lgkmcnt(2)
    v_mfma_f32_16x16x32_bf16 v[72:75], v[32:35], v[104:107], v[72:75]
    ds_read_b64_tr_b16 v[132:133], v175 offset:30720
    ds_read_b64_tr_b16 v[134:135], v175 offset:33792
    v_mfma_f32_16x16x32_bf16 v[76:79], v[32:35], v[108:111], v[76:79]
    ds_read_b64_tr_b16 v[136:137], v174 offset:30784
    ds_read_b64_tr_b16 v[138:139], v174 offset:33856
    v_mfma_f32_16x16x32_bf16 v[80:83], v[32:35], v[112:115], v[80:83]
    ds_read_b64_tr_b16 v[140:141], v175 offset:30784
    ds_read_b64_tr_b16 v[142:143], v175 offset:33856
    v_mfma_f32_16x16x32_bf16 v[84:87], v[32:35], v[116:119], v[84:87]
    ds_read_b64_tr_b16 v[144:145], v174 offset:30848
    ds_read_b64_tr_b16 v[146:147], v174 offset:33920
    v_mfma_f32_16x16x32_bf16 v[88:91], v[32:35], v[120:123], v[88:91]
    ds_read_b64_tr_b16 v[148:149], v175 offset:30848
    ds_read_b64_tr_b16 v[150:151], v175 offset:33920
    v_mfma_f32_16x16x32_bf16 v[92:95], v[32:35], v[124:127], v[92:95]
    s_waitcnt vmcnt(12)
    s_barrier
    s_cmp_lg_u32 s3, 0
    s_cbranch_scc1 Lfi_26
    s_mov_b32 exec_lo, 0x3fff3fff
    s_mov_b32 exec_hi, 0x0
    buffer_load_dword v198, v197, s[12:15], 0 offen sc1
    s_mov_b64 exec, -1
Lfi_26:
    s_add_u32 s37, s47, 40960
    s_mov_b32 m0, s37
    s_mov_b32 s38, 286720
    buffer_load_dwordx4 v194, s[20:23], s38 offen lds
    ds_read_b64_tr_b16 v[104:105], v174 offset:36864
    ds_read_b64_tr_b16 v[106:107], v174 offset:39936
    s_waitcnt lgkmcnt(2)
    v_mfma_f32_16x16x32_bf16 v[72:75], v[36:39], v[128:131], v[72:75]
    ds_read_b64_tr_b16 v[108:109], v175 offset:36864
    ds_read_b64_tr_b16 v[110:111], v175 offset:39936
    v_mfma_f32_16x16x32_bf16 v[76:79], v[36:39], v[132:135], v[76:79]
    ds_read_b64_tr_b16 v[112:113], v174 offset:36928
    ds_read_b64_tr_b16 v[114:115], v174 offset:40000
    v_mfma_f32_16x16x32_bf16 v[80:83], v[36:39], v[136:139], v[80:83]
    ds_read_b64_tr_b16 v[116:117], v175 offset:36928
    ds_read_b64_tr_b16 v[118:119], v175 offset:40000
    v_mfma_f32_16x16x32_bf16 v[84:87], v[36:39], v[140:143], v[84:87]
    ds_read_b64_tr_b16 v[120:121], v174 offset:36992
    ds_read_b64_tr_b16 v[122:123], v174 offset:40064
    v_mfma_f32_16x16x32_bf16 v[88:91], v[36:39], v[144:147], v[88:91]
    ds_read_b64_tr_b16 v[124:125], v175 offset:36992
    ds_read_b64_tr_b16 v[126:127], v175 offset:40064
    v_mfma_f32_16x16x32_bf16 v[92:95], v[36:39], v[148:151], v[92:95]
    s_add_u32 s37, s47, 49152
    s_mov_b32 m0, s37
    s_mov_b32 s38, 344064
    buffer_load_dwordx4 v194, s[20:23], s38 offen lds
    ds_read_b64_tr_b16 v[128:129], v176 offset:0
    ds_read_b64_tr_b16 v[130:131], v176 offset:3072
    s_waitcnt lgkmcnt(2)
    v_mfma_f32_16x16x32_bf16 v[72:75], v[40:43], v[104:107], v[72:75]
    ds_read_b64_tr_b16 v[132:133], v177 offset:0
    ds_read_b64_tr_b16 v[134:135], v177 offset:3072
    v_mfma_f32_16x16x32_bf16 v[76:79], v[40:43], v[108:111], v[76:79]
    ds_read_b64_tr_b16 v[136:137], v176 offset:64
    ds_read_b64_tr_b16 v[138:139], v176 offset:3136
    v_mfma_f32_16x16x32_bf16 v[80:83], v[40:43], v[112:115], v[80:83]
    ds_read_b64_tr_b16 v[140:141], v177 offset:64
    ds_read_b64_tr_b16 v[142:143], v177 offset:3136
    v_mfma_f32_16x16x32_bf16 v[84:87], v[40:43], v[116:119], v[84:87]
    ds_read_b64_tr_b16 v[144:145], v176 offset:128
    ds_read_b64_tr_b16 v[146:147], v176 offset:3200
    v_mfma_f32_16x16x32_bf16 v[88:91], v[40:43], v[120:123], v[88:91]
    ds_read_b64_tr_b16 v[148:149], v177 offset:128
    ds_read_b64_tr_b16 v[150:151], v177 offset:3200
    v_mfma_f32_16x16x32_bf16 v[92:95], v[40:43], v[124:127], v[92:95]
    s_cmp_lg_u32 s3, 0
    s_cbranch_scc1 Lfc_27
    s_mov_b32 exec_lo, 0x3fff3fff
    s_mov_b32 exec_hi, 0x0
    s_mov_b32 s63, 0
    s_waitcnt vmcnt(2)
Lfl_28:
    v_cmp_ne_u32 vcc, s29, v198
    s_nop 1
    s_cbranch_vccz Lfd_29
    s_sleep 4
    buffer_load_dword v198, v197, s[12:15], 0 offen sc1
    s_waitcnt vmcnt(0)
    s_add_u32 s63, s63, 1
    s_cmp_lt_u32 s63, 200000
    s_cbranch_scc1 Lfl_28
    v_mov_b32 v6, 1
    v_mov_b32 v7, 4
    buffer_store_dword v6, v7, s[16:19], 0 offen
Lfd_29:
    s_mov_b64 exec, -1
Lfc_27:
    s_waitcnt vmcnt(12)
    s_barrier
    s_add_u32 s37, s49, 0
    buffer_load_dwordx4 v[200:203], v4, s[12:15], s37 offen sc1
    s_add_u32 s37, s49, 1024
    buffer_load_dwordx4 v[204:207], v4, s[12:15], s37 offen sc1
    s_add_u32 s37, s49, 2048
    buffer_load_dwordx4 v[208:211], v4, s[12:15], s37 offen sc1
    ds_read_b64_tr_b16 v[104:105], v176 offset:6144
    ds_read_b64_tr_b16 v[106:107], v176 offset:9216
    s_waitcnt lgkmcnt(2)
    v_mfma_f32_16x16x32_bf16 v[72:75], v[44:47], v[128:131], v[72:75]
    ds_read_b64_tr_b16 v[108:109], v177 offset:6144
    ds_read_b64_tr_b16 v[110:111], v177 offset:9216
    v_mfma_f32_16x16x32_bf16 v[76:79], v[44:47], v[132:135], v[76:79]
    ds_read_b64_tr_b16 v[112:113], v176 offset:6208
    ds_read_b64_tr_b16 v[114:115], v176 offset:9280
    v_mfma_f32_16x16x32_bf16 v[80:83], v[44:47], v[136:139], v[80:83]
    ds_read_b64_tr_b16 v[116:117], v177 offset:6208
    ds_read_b64_tr_b16 v[118:119], v177 offset:9280
    v_mfma_f32_16x16x32_bf16 v[84:87], v[44:47], v[140:143], v[84:87]
    ds_read_b64_tr_b16 v[120:121], v176 offset:6272
    ds_read_b64_tr_b16 v[122:123], v176 offset:9344
    v_mfma_f32_16x16x32_bf16 v[88:91], v[44:47], v[144:147], v[88:91]
    ds_read_b64_tr_b16 v[124:125], v177 offset:6272
    ds_read_b64_tr_b16 v[126:127], v177 offset:9344
    v_mfma_f32_16x16x32_bf16 v[92:95], v[44:47], v[148:151], v[92:95]
    s_add_u32 s37, s49, 3072
    buffer_load_dwordx4 v[212:215], v4, s[12:15], s37 offen sc1
    s_add_u32 s37, s49, 4096
    buffer_load_dwordx4 v[216:219], v4, s[12:15], s37 offen sc1
    s_add_u32 s37, s49, 5120
    buffer_load_dwordx4 v[220:223], v4, s[12:15], s37 offen sc1
    ds_read_b64_tr_b16 v[128:129], v176 offset:12288
    ds_read_b64_tr_b16 v[130:131], v176 offset:15360
    s_waitcnt lgkmcnt(2)
    v_mfma_f32_16x16x32_bf16 v[72:75], v[48:51], v[104:107], v[72:75]
    ds_read_b64_tr_b16 v[132:133], v177 offset:12288
    ds_read_b64_tr_b16 v[134:135], v177 offset:15360
    v_mfma_f32_16x16x32_bf16 v[76:79], v[48:51], v[108:111], v[76:79]
    ds_read_b64_tr_b16 v[136:137], v176 offset:12352
    ds_read_b64_tr_b16 v[138:139], v176 offset:15424
    v_mfma_f32_16x16x32_bf16 v[80:83], v[48:51], v[112:115], v[80:83]
    ds_read_b64_tr_b16 v[140:141], v177 offset:12352
    ds_read_b64_tr_b16 v[142:143], v177 offset:15424
    v_mfma_f32_16x16x32_bf16 v[84:87], v[48:51], v[116:119], v[84:87]
    ds_read_b64_tr_b16 v[144:145], v176 offset:12416
    ds_read_b64_tr_b16 v[146:147], v176 offset:15488
    v_mfma_f32_16x16x32_bf16 v[88:91], v[48:51], v[120:123], v[88:91]
    ds_read_b64_tr_b16 v[148:149], v177 offset:12416
    ds_read_b64_tr_b16 v[150:151], v177 offset:15488
    v_mfma_f32_16x16x32_bf16 v[92:95], v[48:51], v[124:127], v[92:95]
    s_waitcnt vmcnt(15)
    s_barrier
    s_add_u32 s37, s49, 6144
    buffer_load_dwordx4 v[224:227], v4, s[12:15], s37 offen sc1
    s_add_u32 s37, s49, 7168
    buffer_load_dwordx4 v[228:231], v4, s[12:15], s37 offen sc1
    ds_read_b64_tr_b16 v[104:105], v176 offset:18432
    ds_read_b64_tr_b16 v[106:107], v176 offset:21504
    s_waitcnt lgkmcnt(2)
    v_mfma_f32_16x16x32_bf16 v[72:75], v[52:55], v[128:131], v[72:75]
    ds_read_b64_tr_b16 v[108:109], v177 offset:18432
    ds_read_b64_tr_b16 v[110:111], v177 offset:21504
    v_mfma_f32_16x16x32_bf16 v[76:79], v[52:55], v[132:135], v[76:79]
    ds_read_b64_tr_b16 v[112:113], v176 offset:18496
    ds_read_b64_tr_b16 v[114:115], v176 offset:21568
    v_mfma_f32_16x16x32_bf16 v[80:83], v[52:55], v[136:139], v[80:83]
    ds_read_b64_tr_b16 v[116:117], v177 offset:18496
    ds_read_b64_tr_b16 v[118:119], v177 offset:21568
    v_mfma_f32_16x16x32_bf16 v[84:87], v[52:55], v[140:143], v[84:87]
    ds_read_b64_tr_b16 v[120:121], v176 offset:18560
    ds_read_b64_tr_b16 v[122:123], v176 offset:21632
    v_mfma_f32_16x16x32_bf16 v[88:91], v[52:55], v[144:147], v[88:91]
    ds_read_b64_tr_b16 v[124:125], v177 offset:18560
    ds_read_b64_tr_b16 v[126:127], v177 offset:21632
    v_mfma_f32_16x16x32_bf16 v[92:95], v[52:55], v[148:151], v[92:95]
    s_add_u32 s37, s49, 8192
    buffer_load_dwordx4 v[232:235], v4, s[12:15], s37 offen sc1
    s_add_u32 s37, s49, 9216
    buffer_load_dwordx4 v[236:239], v4, s[12:15], s37 offen sc1
    ds_read_b64_tr_b16 v[128:129], v176 offset:24576
    ds_read_b64_tr_b16 v[130:131], v176 offset:27648
    s_waitcnt lgkmcnt(2)
    v_mfma_f32_16x16x32_bf16 v[72:75], v[56:59], v[104:107], v[72:75]
    ds_read_b64_tr_b16 v[132:133], v177 offset:24576
    ds_read_b64_tr_b16 v[134:135], v177 offset:27648
    v_mfma_f32_16x16x32_bf16 v[76:79], v[56:59], v[108:111], v[76:79]
    ds_read_b64_tr_b16 v[136:137], v176 offset:24640
    ds_read_b64_tr_b16 v[138:139], v176 offset:27712
    v_mfma_f32_16x16x32_bf16 v[80:83], v[56:59], v[112:115], v[80:83]
    ds_read_b64_tr_b16 v[140:141], v177 offset:24640
    ds_read_b64_tr_b16 v[142:143], v177 offset:27712
    v_mfma_f32_16x16x32_bf16 v[84:87], v[56:59], v[116:119], v[84:87]
    ds_read_b64_tr_b16 v[144:145], v176 offset:24704
    ds_read_b64_tr_b16 v[146:147], v176 offset:27776
    v_mfma_f32_16x16x32_bf16 v[88:91], v[56:59], v[120:123], v[88:91]
    ds_read_b64_tr_b16 v[148:149], v177 offset:24704
    ds_read_b64_tr_b16 v[150:151], v177 offset:27776
    v_mfma_f32_16x16x32_bf16 v[92:95], v[56:59], v[124:127], v[92:95]
    s_waitcnt vmcnt(16)
    s_barrier
    s_add_u32 s37, s49, 10240
    buffer_load_dwordx4 v[240:243], v4, s[12:15], s37 offen sc1
    s_add_u32 s37, s49, 11264
    buffer_load_dwordx4 v[244:247], v4, s[12:15], s37 offen sc1
    ds_read_b64_tr_b16 v[104:105], v176 offset:30720
    ds_read_b64_tr_b16 v[106:107], v176 offset:33792
    s_waitcnt lgkmcnt(2)
    v_mfma_f32_16x16x32_bf16 v[72:75], v[60:63], v[128:131], v[72:75]
    ds_read_b64_tr_b16 v[108:109], v177 offset:30720
    ds_read_b64_tr_b16 v[110:111], v177 offset:33792
    v_mfma_f32_16x16x32_bf16 v[76:79], v[60:63], v[132:135], v[76:79]
    ds_read_b64_tr_b16 v[112:113], v176 offset:30784
    ds_read_b64_tr_b16 v[114:115], v176 offset:33856
    v_mfma_f32_16x16x32_bf16 v[80:83], v[60:63], v[136:139], v[80:83]
    ds_read_b64_tr_b16 v[116:117], v177 offset:30784
    ds_read_b64_tr_b16 v[118:119], v177 offset:33856
    v_mfma_f32_16x16x32_bf16 v[84:87], v[60:63], v[140:143], v[84:87]
    ds_read_b64_tr_b16 v[120:121], v176 offset:30848
    ds_read_b64_tr_b16 v[122:123], v176 offset:33920
    v_mfma_f32_16x16x32_bf16 v[88:91], v[60:63], v[144:147], v[88:91]
    ds_read_b64_tr_b16 v[124:125], v177 offset:30848
    ds_read_b64_tr_b16 v[126:127], v177 offset:33920
    v_mfma_f32_16x16x32_bf16 v[92:95], v[60:63], v[148:151], v[92:95]
    s_add_u32 s37, s49, 12288
    buffer_load_dwordx4 v[248:251], v4, s[12:15], s37 offen sc1
    s_add_u32 s37, s49, 13312
    buffer_load_dwordx4 v[252:255], v4, s[12:15], s37 offen sc1
    ds_read_b64_tr_b16 v[128:129], v176 offset:36864
    ds_read_b64_tr_b16 v[130:131], v176 offset:39936
    s_waitcnt lgkmcnt(2)
    v_mfma_f32_16x16x32_bf16 v[72:75], v[64:67], v[104:107], v[72:75]
    ds_read_b64_tr_b16 v[132:133], v177 offset:36864
    ds_read_b64_tr_b16 v[134:135], v177 offset:39936
    v_mfma_f32_16x16x32_bf16 v[76:79], v[64:67], v[108:111], v[76:79]
    ds_read_b64_tr_b16 v[136:137], v176 offset:36928
    ds_read_b64_tr_b16 v[138:139], v176 offset:40000
    v_mfma_f32_16x16x32_bf16 v[80:83], v[64:67], v[112:115], v[80:83]
    ds_read_b64_tr_b16 v[140:141], v177 offset:36928
    ds_read_b64_tr_b16 v[142:143], v177 offset:40000
    v_mfma_f32_16x16x32_bf16 v[84:87], v[64:67], v[116:119], v[84:87]
    ds_read_b64_tr_b16 v[144:145], v176 offset:36992
    ds_read_b64_tr_b16 v[146:147], v176 offset:40064
    v_mfma_f32_16x16x32_bf16 v[88:91], v[64:67], v[120:123], v[88:91]
    ds_read_b64_tr_b16 v[148:149], v177 offset:36992
    ds_read_b64_tr_b16 v[150:151], v177 offset:40064
    v_mfma_f32_16x16x32_bf16 v[92:95], v[64:67], v[124:127], v[92:95]
    s_waitcnt lgkmcnt(0)
    v_mfma_f32_16x16x32_bf16 v[72:75], v[68:71], v[128:131], v[72:75]
    v_mfma_f32_16x16x32_bf16 v[76:79], v[68:71], v[132:135], v[76:79]
    v_mfma_f32_16x16x32_bf16 v[80:83], v[68:71], v[136:139], v[80:83]
    v_mfma_f32_16x16x32_bf16 v[84:87], v[68:71], v[140:143], v[84:87]
    v_mfma_f32_16x16x32_bf16 v[88:91], v[68:71], v[144:147], v[88:91]
    v_mfma_f32_16x16x32_bf16 v[92:95], v[68:71], v[148:151], v[92:95]
    s_waitcnt vmcnt(14)
    s_barrier
    s_lshl_b32 s37, s25, 8
    s_add_u32 s8, s76, s37
    s_addc_u32 s9, s77, 0
    s_sub_u32 s10, 0x188000, s37
    s_mov_b32 s11, 0x00020000
    s_lshl_b32 s42, s24, 3
    s_add_u32 s42, s42, s3
    s_mul_i32 s43, s42, 43008
    s_mul_i32 s40, s25, 3072
    s_add_u32 s43, s43, s40
    v_cvt_pk_bf16_f32 v104, v72, v73
    v_cvt_pk_bf16_f32 v105, v74, v75
    v_cvt_pk_bf16_f32 v106, v76, v77
    v_cvt_pk_bf16_f32 v107, v78, v79
    s_nop 1
    v_permlane32_swap_b32 v104, v106
    v_permlane32_swap_b32 v105, v107
    s_nop 1
    v_permlane16_swap_b32 v104, v106
    v_permlane16_swap_b32 v105, v107
    buffer_store_dwordx4 v[104:107], v4, s[12:15], s43 offen offset:0 sc1
    v_cvt_pk_bf16_f32 v108, v80, v81
    v_cvt_pk_bf16_f32 v109, v82, v83
    v_cvt_pk_bf16_f32 v110, v84, v85
    v_cvt_pk_bf16_f32 v111, v86, v87
    s_nop 1
    v_permlane32_swap_b32 v108, v110
    v_permlane32_swap_b32 v109, v111
    s_nop 1
    v_permlane16_swap_b32 v108, v110
    v_permlane16_swap_b32 v109, v111
    buffer_store_dwordx4 v[108:111], v4, s[12:15], s43 offen offset:1024 sc1
    v_cvt_pk_bf16_f32 v112, v88, v89
    v_cvt_pk_bf16_f32 v113, v90, v91
    v_cvt_pk_bf16_f32 v114, v92, v93
    v_cvt_pk_bf16_f32 v115, v94, v95
    s_nop 1
    v_permlane32_swap_b32 v112, v114
    v_permlane32_swap_b32 v113, v115
    s_nop 1
    v_permlane16_swap_b32 v112, v114
    v_permlane16_swap_b32 v113, v115
    buffer_store_dwordx4 v[112:115], v4, s[12:15], s43 offen offset:2048 sc1
Lp1bend_5:
    s_and_b32 s40, s3, 3
    s_lshr_b32 s41, s3, 2
    s_lshl_b32 s43, s40, 10
    s_add_u32 s43, s43, 0
    v_add_u32 v168, s43, v4
    v_lshrrev_b32 v6, 2, v2
    v_lshl_add_u32 v6, v3, 2, v6
    v_bfe_u32 v7, v6, 1, 2
    v_lshlrev_b32 v7, 1, v7
    v_bfe_u32 v8, v2, 1, 1
    s_lshl_b32 s43, s41, 2
    v_add_u32 v9, s43, v8
    v_xor_b32 v9, v9, v7
    v_lshlrev_b32 v9, 4, v9
    v_lshl_add_u32 v195, v6, 7, v9
    v_and_b32 v9, 1, v2
    v_lshl_add_u32 v195, v9, 3, v195
    v_add_u32 v9, s43, v8
    v_add_u32 v9, 2, v9
    v_xor_b32 v9, v9, v7
    v_lshlrev_b32 v9, 4, v9
    v_lshl_add_u32 v196, v6, 7, v9
    v_and_b32 v9, 1, v2
    v_lshl_add_u32 v196, v9, 3, v196
    v_mul_u32_u24 v169, 896, v193
    v_lshl_add_u32 v169, v3, 3, v169
    s_lshl_b32 s45, s27, 7
    s_lshl_b32 s44, s41, 6
    s_add_u32 s45, s45, s44
    buffer_load_dwordx2 v[176:177], v169, s[4:7], s45 offen
    buffer_load_dwordx2 v[178:179], v169, s[4:7], s45 offen offset:32
    ds_read_b64_tr_b16 v[120:121], v195 offset:0
    ds_read_b64_tr_b16 v[122:123], v195 offset:2048
    ds_read_b64_tr_b16 v[124:125], v196 offset:0
    ds_read_b64_tr_b16 v[126:127], v196 offset:2048
    ds_read_b64_tr_b16 v[128:129], v195 offset:4096
    ds_read_b64_tr_b16 v[130:131], v195 offset:6144
    s_waitcnt vmcnt(18)
    s_waitcnt lgkmcnt(2)
    v_mfma_f32_16x16x32_bf16 v[72:75], v[120:123], v[200:203], 0
    ds_read_b64_tr_b16 v[132:133], v196 offset:4096
    ds_read_b64_tr_b16 v[134:135], v196 offset:6144
    v_mfma_f32_16x16x32_bf16 v[76:79], v[124:127], v[200:203], 0
    ds_read_b64_tr_b16 v[120:121], v195 offset:8192
    ds_read_b64_tr_b16 v[122:123], v195 offset:10240
    s_waitcnt vmcnt(17)
    s_waitcnt lgkmcnt(2)
    v_mfma_f32_16x16x32_bf16 v[72:75], v[128:131], v[204:207], v[72:75]
    ds_read_b64_tr_b16 v[124:125], v196 offset:8192
    ds_read_b64_tr_b16 v[126:127], v196 offset:10240
    v_mfma_f32_16x16x32_bf16 v[76:79], v[132:135], v[204:207], v[76:79]
    ds_read_b64_tr_b16 v[128:129], v195 offset:12288
    ds_read_b64_tr_b16 v[130:131], v195 offset:14336
    s_waitcnt vmcnt(16)
    s_waitcnt lgkmcnt(2)
    v_mfma_f32_16x16x32_bf16 v[72:75], v[120:123], v[208:211], v[72:75]
    ds_read_b64_tr_b16 v[132:133], v196 offset:12288
    ds_read_b64_tr_b16 v[134:135], v196 offset:14336
    v_mfma_f32_16x16x32_bf16 v[76:79], v[124:127], v[208:211], v[76:79]
    ds_read_b64_tr_b16 v[120:121], v195 offset:16384
    ds_read_b64_tr_b16 v[122:123], v195 offset:18432
    s_waitcnt vmcnt(15)
    s_waitcnt lgkmcnt(2)
    v_mfma_f32_16x16x32_bf16 v[72:75], v[128:131], v[212:215], v[72:75]
    ds_read_b64_tr_b16 v[124:125], v196 offset:16384
    ds_read_b64_tr_b16 v[126:127], v196 offset:18432
    v_mfma_f32_16x16x32_bf16 v[76:79], v[132:135], v[212:215], v[76:79]
    ds_read_b64_tr_b16 v[128:129], v195 offset:20480
    ds_read_b64_tr_b16 v[130:131], v195 offset:22528
    s_waitcnt vmcnt(14)
    s_waitcnt lgkmcnt(2)
    v_mfma_f32_16x16x32_bf16 v[72:75], v[120:123], v[216:219], v[72:75]
    ds_read_b64_tr_b16 v[132:133], v196 offset:20480
    ds_read_b64_tr_b16 v[134:135], v196 offset:22528
    v_mfma_f32_16x16x32_bf16 v[76:79], v[124:127], v[216:219], v[76:79]
    ds_read_b64_tr_b16 v[120:121], v195 offset:24576
    ds_read_b64_tr_b16 v[122:123], v195 offset:26624
    s_waitcnt vmcnt(13)
    s_waitcnt lgkmcnt(2)
    v_mfma_f32_16x16x32_bf16 v[72:75], v[128:131], v[220:223], v[72:75]
    ds_read_b64_tr_b16 v[124:125], v196 offset:24576
    ds_read_b64_tr_b16 v[126:127], v196 offset:26624
    v_mfma_f32_16x16x32_bf16 v[76:79], v[132:135], v[220:223], v[76:79]
    ds_read_b64_tr_b16 v[128:129], v195 offset:28672
    ds_read_b64_tr_b16 v[130:131], v195 offset:30720
    s_waitcnt vmcnt(12)
    s_waitcnt lgkmcnt(2)
    v_mfma_f32_16x16x32_bf16 v[72:75], v[120:123], v[224:227], v[72:75]
    ds_read_b64_tr_b16 v[132:133], v196 offset:28672
    ds_read_b64_tr_b16 v[134:135], v196 offset:30720
    v_mfma_f32_16x16x32_bf16 v[76:79], v[124:127], v[224:227], v[76:79]
    ds_read_b64_tr_b16 v[120:121], v195 offset:32768
    ds_read_b64_tr_b16 v[122:123], v195 offset:34816
    s_waitcnt vmcnt(11)
    s_waitcnt lgkmcnt(2)
    v_mfma_f32_16x16x32_bf16 v[72:75], v[128:131], v[228:231], v[72:75]
    ds_read_b64_tr_b16 v[124:125], v196 offset:32768
    ds_read_b64_tr_b16 v[126:127], v196 offset:34816
    v_mfma_f32_16x16x32_bf16 v[76:79], v[132:135], v[228:231], v[76:79]
    ds_read_b64_tr_b16 v[128:129], v195 offset:36864
    ds_read_b64_tr_b16 v[130:131], v195 offset:38912
    s_waitcnt vmcnt(10)
    s_waitcnt lgkmcnt(2)
    v_mfma_f32_16x16x32_bf16 v[72:75], v[120:123], v[232:235], v[72:75]
    ds_read_b64_tr_b16 v[132:133], v196 offset:36864
    ds_read_b64_tr_b16 v[134:135], v196 offset:38912
    v_mfma_f32_16x16x32_bf16 v[76:79], v[124:127], v[232:235], v[76:79]
    ds_read_b64_tr_b16 v[120:121], v195 offset:40960
    ds_read_b64_tr_b16 v[122:123], v195 offset:43008
    s_waitcnt vmcnt(9)
    s_waitcnt lgkmcnt(2)
    v_mfma_f32_16x16x32_bf16 v[72:75], v[128:131], v[236:239], v[72:75]
    ds_read_b64_tr_b16 v[124:125], v196 offset:40960
    ds_read_b64_tr_b16 v[126:127], v196 offset:43008
    v_mfma_f32_16x16x32_bf16 v[76:79], v[132:135], v[236:239], v[76:79]
    ds_read_b64_tr_b16 v[128:129], v195 offset:45056
    ds_read_b64_tr_b16 v[130:131], v195 offset:47104
    s_waitcnt vmcnt(8)
    s_waitcnt lgkmcnt(2)
    v_mfma_f32_16x16x32_bf16 v[72:75], v[120:123], v[240:243], v[72:75]
    ds_read_b64_tr_b16 v[132:133], v196 offset:45056
    ds_read_b64_tr_b16 v[134:135], v196 offset:47104
    v_mfma_f32_16x16x32_bf16 v[76:79], v[124:127], v[240:243], v[76:79]
    ds_read_b64_tr_b16 v[120:121], v195 offset:49152
    ds_read_b64_tr_b16 v[122:123], v195 offset:51200
    s_waitcnt vmcnt(7)
    s_waitcnt lgkmcnt(2)
    v_mfma_f32_16x16x32_bf16 v[72:75], v[128:131], v[244:247], v[72:75]
    ds_read_b64_tr_b16 v[124:125], v196 offset:49152
    ds_read_b64_tr_b16 v[126:127], v196 offset:51200
    v_mfma_f32_16x16x32_bf16 v[76:79], v[132:135], v[244:247], v[76:79]
    ds_read_b64_tr_b16 v[128:129], v195 offset:53248
    ds_read_b64_tr_b16 v[130:131], v195 offset:55296
    s_waitcnt vmcnt(6)
    s_waitcnt lgkmcnt(2)
    v_mfma_f32_16x16x32_bf16 v[72:75], v[120:123], v[248:251], v[72:75]
    ds_read_b64_tr_b16 v[132:133], v196 offset:53248
    ds_read_b64_tr_b16 v[134:135], v196 offset:55296
    v_mfma_f32_16x16x32_bf16 v[76:79], v[124:127], v[248:251], v[76:79]
    s_waitcnt vmcnt(5)
    s_waitcnt lgkmcnt(0)
    v_mfma_f32_16x16x32_bf16 v[72:75], v[128:131], v[252:255], v[72:75]
    v_mfma_f32_16x16x32_bf16 v[76:79], v[132:135], v[252:255], v[76:79]
    s_sub_u32 s37, s24, 2
    v_add_u32 v6, s37, v3
    v_max_i32 v6, 0, v6
    v_lshlrev_b32 v6, 7, v6
    v_lshl_add_u32 v6, v2, 2, v6
    v_add_u32 v197, 0x1481000, v6
    s_waitcnt vmcnt(2)
    s_barrier
    s_lshl_b32 s37, s24, 7
    s_lshl_b32 s38, s25, 2
    s_add_u32 s37, s37, s38
    s_add_u32 s37, s37, 0x1481000
    s_cmp_lg_u32 s3, 0
    s_cbranch_scc1 Lpub_30
    v_mov_b32 v6, s29
    v_mov_b32 v7, 0
    s_mov_b64 exec, 1
    buffer_store_dword v6, v7, s[12:15], s37 offen sc1
    s_mov_b64 exec, -1
Lpub_30:
    s_waitcnt vmcnt(0)
    v_lshlrev_b32 v6, 16, v176
    v_and_b32 v7, 0xffff0000, v176
    v_pk_add_f32 v[72:73], v[72:73], v[6:7]
    v_cvt_pk_bf16_f32 v152, v72, v73
    v_pk_mul_f32 v[182:183], v[72:73], v[72:73]
    v_mov_b32 v180, v72
    v_mov_b32 v181, v73
    v_lshlrev_b32 v6, 16, v177
    v_and_b32 v7, 0xffff0000, v177
    v_pk_add_f32 v[74:75], v[74:75], v[6:7]
    v_cvt_pk_bf16_f32 v153, v74, v75
    v_pk_fma_f32 v[182:183], v[74:75], v[74:75], v[182:183]
    v_pk_add_f32 v[180:181], v[180:181], v[74:75]
    v_lshlrev_b32 v6, 16, v178
    v_and_b32 v7, 0xffff0000, v178
    v_pk_add_f32 v[76:77], v[76:77], v[6:7]
    v_cvt_pk_bf16_f32 v154, v76, v77
    v_pk_fma_f32 v[182:183], v[76:77], v[76:77], v[182:183]
    v_pk_add_f32 v[180:181], v[180:181], v[76:77]
    v_lshlrev_b32 v6, 16, v179
    v_and_b32 v7, 0xffff0000, v179
    v_pk_add_f32 v[78:79], v[78:79], v[6:7]
    v_cvt_pk_bf16_f32 v155, v78, v79
    v_pk_fma_f32 v[182:183], v[78:79], v[78:79], v[182:183]
    v_pk_add_f32 v[180:181], v[180:181], v[78:79]
    s_nop 1
    v_permlane32_swap_b32 v152, v154
    v_permlane32_swap_b32 v153, v155
    s_nop 1
    v_permlane16_swap_b32 v152, v154
    v_permlane16_swap_b32 v153, v155
    s_lshl_b32 s37, s27, 11
    s_add_u32 s37, s37, 0xa00000
    buffer_store_dwordx4 v[152:155], v192, s[12:15], s37 offen sc1
    s_cmp_lg_u32 s3, 0
    s_cbranch_scc1 Lfi_31
    s_mov_b32 exec_lo, 0x3fff3fff
    s_mov_b32 exec_hi, 0x3fff
    buffer_load_dword v198, v197, s[12:15], 0 offen sc1
    s_mov_b64 exec, -1
Lfi_31:
    v_add_f32 v180, v180, v181
    v_add_f32 v181, v182, v183
    v_mov_b32 v6, v180
    s_nop 1
    v_permlane32_swap_b32 v180, v6
    s_nop 1
    v_add_f32 v180, v180, v6
    v_mov_b32 v6, v180
    s_nop 1
    v_permlane16_swap_b32 v180, v6
    s_nop 1
    v_add_f32 v180, v180, v6
    v_mov_b32 v6, v181
    s_nop 1
    v_permlane32_swap_b32 v181, v6
    s_nop 1
    v_add_f32 v181, v181, v6
    v_mov_b32 v6, v181
    s_nop 1
    v_permlane16_swap_b32 v181, v6
    s_nop 1
    v_add_f32 v181, v181, v6
    v_lshlrev_b32 v6, 3, v2
    s_lshl_b32 s37, s26, 2
    s_add_u32 s37, s37, s40
    s_lshl_b32 s37, s37, 11
    s_lshl_b32 s38, s27, 8
    s_add_u32 s37, s37, s38
    s_lshl_b32 s38, s41, 7
    s_add_u32 s37, s37, s38
    s_add_u32 s37, s37, 0x1410000
    s_mov_b64 exec, 0xffff
    buffer_store_dwordx2 v[180:181], v6, s[12:15], s37 offen sc1
    s_mov_b64 exec, -1
    s_lshr_b32 s37, s26, 1
    s_lshl_b32 s48, s37, 7
    s_and_b32 s46, s26, 1
    s_mul_i32 s46, s46, 7
    s_add_u32 s46, s46, s27
    s_lshl_b32 s46, s46, 2
    s_add_u32 s37, s48, s46
    s_add_u32 s46, s37, 0x1482000
    s_add_u32 s37, s47, 49152
    s_mov_b32 m0, s37
    s_add_u32 s38, s101, 0
    s_sub_u32 s37, s38, 14
    s_cmp_ge_u32 s38, 14
    s_cselect_b32 s38, s37, s38
    s_mul_i32 s38, s38, 114688
    buffer_load_dwordx4 v199, s[8:11], s38 offen lds
    s_add_u32 s37, s47, 57344
    s_mov_b32 m0, s37
    s_add_u32 s38, s101, 1
    s_sub_u32 s37, s38, 14
    s_cmp_ge_u32 s38, 14
    s_cselect_b32 s38, s37, s38
    s_mul_i32 s38, s38, 114688
    buffer_load_dwordx4 v199, s[8:11], s38 offen lds
    s_add_u32 s37, s47, 65536
    s_mov_b32 m0, s37
    s_add_u32 s38, s101, 2
    s_sub_u32 s37, s38, 14
    s_cmp_ge_u32 s38, 14
    s_cselect_b32 s38, s37, s38
    s_mul_i32 s38, s38, 114688
    buffer_load_dwordx4 v199, s[8:11], s38 offen lds
    s_add_u32 s37, s47, 73728
    s_mov_b32 m0, s37
    s_add_u32 s38, s101, 3
    s_sub_u32 s37, s38, 14
    s_cmp_ge_u32 s38, 14
    s_cselect_b32 s38, s37, s38
    s_mul_i32 s38, s38, 114688
    buffer_load_dwordx4 v199, s[8:11], s38 offen lds
    s_add_u32 s37, s47, 81920
    s_mov_b32 m0, s37
    s_add_u32 s38, s101, 4
    s_sub_u32 s37, s38, 14
    s_cmp_ge_u32 s38, 14
    s_cselect_b32 s38, s37, s38
    s_mul_i32 s38, s38, 114688
    buffer_load_dwordx4 v199, s[8:11], s38 offen lds
    s_waitcnt vmcnt(5)
    s_barrier
    s_cmp_lg_u32 s3, 0
    s_cbranch_scc1 Lpub_32
    v_mov_b32 v6, s29
    v_mov_b32 v7, 0
    s_mov_b64 exec, 1
    buffer_store_dword v6, v7, s[12:15], s46 offen sc1
    s_mov_b64 exec, -1
Lpub_32:
    v_mov_b32 v189, v197
    s_add_u32 s37, s47, 90112
    s_mov_b32 m0, s37
    s_add_u32 s38, s101, 5
    s_sub_u32 s37, s38, 14
    s_cmp_ge_u32 s38, 14
    s_cselect_b32 s38, s37, s38
    s_mul_i32 s38, s38, 114688
    buffer_load_dwordx4 v199, s[8:11], s38 offen lds
    s_add_u32 s37, s47, 98304
    s_mov_b32 m0, s37
    s_add_u32 s38, s101, 6
    s_sub_u32 s37, s38, 14
    s_cmp_ge_u32 s38, 14
    s_cselect_b32 s38, s37, s38
    s_mul_i32 s38, s38, 114688
    buffer_load_dwordx4 v199, s[8:11], s38 offen lds
    s_add_u32 s37, s47, 106496
    s_mov_b32 m0, s37
    s_add_u32 s38, s101, 7
    s_sub_u32 s37, s38, 14
    s_cmp_ge_u32 s38, 14
    s_cselect_b32 s38, s37, s38
    s_mul_i32 s38, s38, 114688
    buffer_load_dwordx4 v199, s[8:11], s38 offen lds
    s_add_u32 s37, s47, 114688
    s_mov_b32 m0, s37
    s_add_u32 s38, s101, 8
    s_sub_u32 s37, s38, 14
    s_cmp_ge_u32 s38, 14
    s_cselect_b32 s38, s37, s38
    s_mul_i32 s38, s38, 114688
    buffer_load_dwordx4 v199, s[8:11], s38 offen lds
    s_add_u32 s37, s47, 122880
    s_mov_b32 m0, s37
    s_add_u32 s38, s101, 9
    s_sub_u32 s37, s38, 14
    s_cmp_ge_u32 s38, 14
    s_cselect_b32 s38, s37, s38
    s_mul_i32 s38, s38, 114688
    buffer_load_dwordx4 v199, s[8:11], s38 offen lds
    s_add_u32 s37, s47, 131072
    s_mov_b32 m0, s37
    s_add_u32 s38, s101, 10
    s_sub_u32 s37, s38, 14
    s_cmp_ge_u32 s38, 14
    s_cselect_b32 s38, s37, s38
    s_mul_i32 s38, s38, 114688
    buffer_load_dwordx4 v199, s[8:11], s38 offen lds
    s_add_u32 s37, s47, 139264
    s_mov_b32 m0, s37
    s_add_u32 s38, s101, 11
    s_sub_u32 s37, s38, 14
    s_cmp_ge_u32 s38, 14
    s_cselect_b32 s38, s37, s38
    s_mul_i32 s38, s38, 114688
    buffer_load_dwordx4 v199, s[8:11], s38 offen lds
    s_add_u32 s37, s47, 147456
    s_mov_b32 m0, s37
    s_add_u32 s38, s101, 12
    s_sub_u32 s37, s38, 14
    s_cmp_ge_u32 s38, 14
    s_cselect_b32 s38, s37, s38
    s_mul_i32 s38, s38, 114688
    buffer_load_dwordx4 v199, s[8:11], s38 offen lds
    s_add_u32 s37, s47, 155648
    s_mov_b32 m0, s37
    s_add_u32 s38, s101, 13
    s_sub_u32 s37, s38, 14
    s_cmp_ge_u32 s38, 14
    s_cselect_b32 s38, s37, s38
    s_mul_i32 s38, s38, 114688
    buffer_load_dwordx4 v199, s[8:11], s38 offen lds
    s_lshl_b32 s37, s24, 7
    s_add_u32 s37, s37, 0x1482000
    v_lshl_add_u32 v6, v1, 2, s37
    v_lshlrev_b32 v7, 2, v1
    v_add_u32 v7, 0x1484f80, v7
    v_cmp_gt_u32 vcc, 32, v1
    s_nop 1
    v_cndmask_b32 v197, v7, v6, vcc
    s_and_b32 s44, s3, 3
    s_lshl_b32 s44, s44, 10
    v_add_u32 v168, s44, v4
    v_add_u32 v169, 0x10000, v168
    v_add_u32 v170, 0x20000, v168
    v_add_u32 v171, 0x2000, v195
    v_add_u32 v172, 0x2000, v196
    v_add_u32 v173, 0x12000, v195
    v_add_u32 v174, 0x12000, v196
    v_add_u32 v175, 0x22000, v195
    v_add_u32 v176, 0x22000, v196
    s_lshr_b32 s45, s3, 2
    s_lshl_b32 s42, s26, 2
    s_and_b32 s44, s3, 3
    s_add_u32 s42, s42, s44
    s_mul_i32 s43, s42, 57344
    s_lshl_b32 s44, s45, 10
    s_add_u32 s43, s43, s44
    v_add_u32 v177, s43, v4
    v_mul_u32_u24 v178, 896, v193
    v_lshl_add_u32 v178, v3, 3, v178
    s_lshl_b32 s49, s45, 6
    s_lshl_b32 s44, s27, 7
    s_add_u32 s49, s49, s44
    s_add_u32 s4, s68, s44
    s_addc_u32 s5, s69, 0
    s_sub_u32 s6, 0x62000, s44
    s_mov_b32 s7, 0x00020000
    s_add_u32 s20, s78, s44
    s_addc_u32 s21, s79, 0
    s_sub_u32 s22, 0x188000, s44
    s_mov_b32 s23, 0x00020000
    s_mul_i32 s54, s42, 14336
    s_lshl_b32 s44, s27, 11
    s_add_u32 s54, s54, s44
    s_lshl_b32 s44, s45, 10
    s_add_u32 s54, s54, s44
    s_add_u32 s54, s54, 0xa00000
    s_lshl_b32 s40, s24, 3
    s_add_u32 s40, s40, s3
    s_mul_i32 s55, s40, 14336
    s_add_u32 s55, s55, 0xa00000
    s_cmp_lg_u32 s3, 0
    s_cbranch_scc1 Lps_33
    s_mov_b32 exec_lo, 0x3fff
    s_mov_b32 exec_hi, 0xffffffff
    s_mov_b32 s63, 0
Lpl_34:
    buffer_load_dword v6, v197, s[12:15], 0 offen sc1
    s_waitcnt vmcnt(0)
    v_cmp_ne_u32 vcc, s29, v6
    s_nop 1
    s_cbranch_vccz Lpd_35
    s_sleep 4
    s_add_u32 s63, s63, 1
    s_cmp_lt_u32 s63, 200000
    s_cbranch_scc1 Lpl_34
    v_mov_b32 v6, 3
    v_mov_b32 v7, 4
    buffer_store_dword v6, v7, s[16:19], 0 offen
Lpd_35:
    s_mov_b64 exec, -1
Lps_33:
    s_barrier
    s_add_u32 s38, s101, 0
    s_sub_u32 s37, s38, 14
    s_cmp_ge_u32 s38, 14
    s_cselect_b32 s38, s37, s38
    s_lshl_b32 s38, s38, 10
    s_add_u32 s37, s55, s38
    buffer_load_dwordx4 v[200:203], v4, s[12:15], s37 offen sc1
    s_add_u32 s38, s101, 1
    s_sub_u32 s37, s38, 14
    s_cmp_ge_u32 s38, 14
    s_cselect_b32 s38, s37, s38
    s_lshl_b32 s38, s38, 10
    s_add_u32 s37, s55, s38
    buffer_load_dwordx4 v[204:207], v4, s[12:15], s37 offen sc1
    s_add_u32 s38, s101, 2
    s_sub_u32 s37, s38, 14
    s_cmp_ge_u32 s38, 14
    s_cselect_b32 s38, s37, s38
    s_lshl_b32 s38, s38, 10
    s_add_u32 s37, s55, s38
    buffer_load_dwordx4 v[208:211], v4, s[12:15], s37 offen sc1
    s_add_u32 s38, s101, 3
    s_sub_u32 s37, s38, 14
    s_cmp_ge_u32 s38, 14
    s_cselect_b32 s38, s37, s38
    s_lshl_b32 s38, s38, 10
    s_add_u32 s37, s55, s38
    buffer_load_dwordx4 v[212:215], v4, s[12:15], s37 offen sc1
    s_add_u32 s38, s101, 4
    s_sub_u32 s37, s38, 14
    s_cmp_ge_u32 s38, 14
    s_cselect_b32 s38, s37, s38
    s_lshl_b32 s38, s38, 10
    s_add_u32 s37, s55, s38
    buffer_load_dwordx4 v[216:219], v4, s[12:15], s37 offen sc1
    s_mov_b32 s61, s40
    v_lshrrev_b32 v6, 2, v2
    v_lshl_add_u32 v6, v3, 2, v6
    v_and_b32 v7, 7, v6
    v_and_b32 v8, 3, v2
    v_lshlrev_b32 v8, 3, v8
    v_lshl_add_u32 v8, v6, 8, v8
    v_add_u32 v8, 49152, v8
    v_xor_b32 v9, 0, v7
    v_lshl_add_u32 v56, v9, 5, v8
    v_add_u32 v64, 57344, v56
    v_xor_b32 v9, 1, v7
    v_lshl_add_u32 v57, v9, 5, v8
    v_add_u32 v65, 57344, v57
    v_xor_b32 v9, 2, v7
    v_lshl_add_u32 v58, v9, 5, v8
    v_add_u32 v66, 57344, v58
    v_xor_b32 v9, 3, v7
    v_lshl_add_u32 v59, v9, 5, v8
    v_add_u32 v67, 57344, v59
    v_xor_b32 v9, 4, v7
    v_lshl_add_u32 v60, v9, 5, v8
    v_add_u32 v68, 57344, v60
    v_xor_b32 v9, 5, v7
    v_lshl_add_u32 v61, v9, 5, v8
    v_add_u32 v69, 57344, v61
    v_xor_b32 v9, 6, v7
    v_lshl_add_u32 v62, v9, 5, v8
    v_add_u32 v70, 57344, v62
    v_xor_b32 v9, 7, v7
    v_lshl_add_u32 v63, v9, 5, v8
    v_add_u32 v71, 57344, v63
    s_add_u32 s38, s48, 0x1484000
    v_lshl_add_u32 v197, v1, 2, s38
    s_waitcnt vmcnt(14)
    s_barrier
    s_add_u32 s38, s101, 5
    s_sub_u32 s37, s38, 14
    s_cmp_ge_u32 s38, 14
    s_cselect_b32 s38, s37, s38
    s_lshl_b32 s38, s38, 10
    s_add_u32 s37, s55, s38
    buffer_load_dwordx4 v[220:223], v4, s[12:15], s37 offen sc1
    ds_read_b64_tr_b16 v[104:105], v56 offset:0
    ds_read_b64_tr_b16 v[106:107], v56 offset:4096
    ds_read_b64_tr_b16 v[108:109], v57 offset:0
    ds_read_b64_tr_b16 v[110:111], v57 offset:4096
    ds_read_b64_tr_b16 v[112:113], v58 offset:0
    ds_read_b64_tr_b16 v[114:115], v58 offset:4096
    ds_read_b64_tr_b16 v[116:117], v59 offset:0
    ds_read_b64_tr_b16 v[118:119], v59 offset:4096
    ds_read_b64_tr_b16 v[120:121], v60 offset:0
    ds_read_b64_tr_b16 v[122:123], v60 offset:4096
    ds_read_b64_tr_b16 v[124:125], v61 offset:0
    ds_read_b64_tr_b16 v[126:127], v61 offset:4096
    ds_read_b64_tr_b16 v[128:129], v62 offset:0
    ds_read_b64_tr_b16 v[130:131], v62 offset:4096
    ds_read_b64_tr_b16 v[132:133], v63 offset:0
    ds_read_b64_tr_b16 v[134:135], v63 offset:4096
    s_add_u32 s38, s101, 6
    s_sub_u32 s37, s38, 14
    s_cmp_ge_u32 s38, 14
    s_cselect_b32 s38, s37, s38
    s_lshl_b32 s38, s38, 10
    s_add_u32 s37, s55, s38
    buffer_load_dwordx4 v[224:227], v4, s[12:15], s37 offen sc1
    ds_read_b64_tr_b16 v[136:137], v56 offset:8192
    ds_read_b64_tr_b16 v[138:139], v56 offset:12288
    s_waitcnt vmcnt(6)
    s_waitcnt lgkmcnt(2)
    v_mfma_f32_16x16x32_bf16 v[72:75], v[104:107], v[200:203], 0
    ds_read_b64_tr_b16 v[140:141], v57 offset:8192
    ds_read_b64_tr_b16 v[142:143], v57 offset:12288
    v_mfma_f32_16x16x32_bf16 v[76:79], v[108:111], v[200:203], 0
    ds_read_b64_tr_b16 v[144:145], v58 offset:8192
    ds_read_b64_tr_b16 v[146:147], v58 offset:12288
    v_mfma_f32_16x16x32_bf16 v[80:83], v[112:115], v[200:203], 0
    ds_read_b64_tr_b16 v[148:149], v59 offset:8192
    ds_read_b64_tr_b16 v[150:151], v59 offset:12288
    v_mfma_f32_16x16x32_bf16 v[84:87], v[116:119], v[200:203], 0
    ds_read_b64_tr_b16 v[152:153], v60 offset:8192
    ds_read_b64_tr_b16 v[154:155], v60 offset:12288
    v_mfma_f32_16x16x32_bf16 v[88:91], v[120:123], v[200:203], 0
    ds_read_b64_tr_b16 v[156:157], v61 offset:8192
    ds_read_b64_tr_b16 v[158:159], v61 offset:12288
    v_mfma_f32_16x16x32_bf16 v[92:95], v[124:127], v[200:203], 0
    ds_read_b64_tr_b16 v[160:161], v62 offset:8192
    ds_read_b64_tr_b16 v[162:163], v62 offset:12288
    v_mfma_f32_16x16x32_bf16 v[96:99], v[128:131], v[200:203], 0
    ds_read_b64_tr_b16 v[164:165], v63 offset:8192
    ds_read_b64_tr_b16 v[166:167], v63 offset:12288
    v_mfma_f32_16x16x32_bf16 v[100:103], v[132:135], v[200:203], 0
    s_add_u32 s38, s101, 7
    s_sub_u32 s37, s38, 14
    s_cmp_ge_u32 s38, 14
    s_cselect_b32 s38, s37, s38
    s_lshl_b32 s38, s38, 10
    s_add_u32 s37, s55, s38
    buffer_load_dwordx4 v[228:231], v4, s[12:15], s37 offen sc1
    s_cmp_lg_u32 s3, 0
    s_cbranch_scc1 Lfi_36
    s_mov_b32 exec_lo, 0x3fff3fff
    s_mov_b32 exec_hi, 0x3fff
    buffer_load_dword v191, v189, s[12:15], 0 offen sc1
    s_mov_b64 exec, -1
Lfi_36:
    ds_read_b64_tr_b16 v[104:105], v56 offset:16384
    ds_read_b64_tr_b16 v[106:107], v56 offset:20480
    s_waitcnt vmcnt(6)
    s_waitcnt lgkmcnt(2)
    v_mfma_f32_16x16x32_bf16 v[72:75], v[136:139], v[204:207], v[72:75]
    ds_read_b64_tr_b16 v[108:109], v57 offset:16384
    ds_read_b64_tr_b16 v[110:111], v57 offset:20480
    v_mfma_f32_16x16x32_bf16 v[76:79], v[140:143], v[204:207], v[76:79]
    ds_read_b64_tr_b16 v[112:113], v58 offset:16384
    ds_read_b64_tr_b16 v[114:115], v58 offset:20480
    v_mfma_f32_16x16x32_bf16 v[80:83], v[144:147], v[204:207], v[80:83]
    ds_read_b64_tr_b16 v[116:117], v59 offset:16384
    ds_read_b64_tr_b16 v[118:119], v59 offset:20480
    v_mfma_f32_16x16x32_bf16 v[84:87], v[148:151], v[204:207], v[84:87]
    ds_read_b64_tr_b16 v[120:121], v60 offset:16384
    ds_read_b64_tr_b16 v[122:123], v60 offset:20480
    v_mfma_f32_16x16x32_bf16 v[88:91], v[152:155], v[204:207], v[88:91]
    ds_read_b64_tr_b16 v[124:125], v61 offset:16384
    ds_read_b64_tr_b16 v[126:127], v61 offset:20480
    v_mfma_f32_16x16x32_bf16 v[92:95], v[156:159], v[204:207], v[92:95]
    ds_read_b64_tr_b16 v[128:129], v62 offset:16384
    ds_read_b64_tr_b16 v[130:131], v62 offset:20480
    v_mfma_f32_16x16x32_bf16 v[96:99], v[160:163], v[204:207], v[96:99]
    ds_read_b64_tr_b16 v[132:133], v63 offset:16384
    ds_read_b64_tr_b16 v[134:135], v63 offset:20480
    v_mfma_f32_16x16x32_bf16 v[100:103], v[164:167], v[204:207], v[100:103]
    s_add_u32 s38, s101, 8
    s_sub_u32 s37, s38, 14
    s_cmp_ge_u32 s38, 14
    s_cselect_b32 s38, s37, s38
    s_lshl_b32 s38, s38, 10
    s_add_u32 s37, s55, s38
    buffer_load_dwordx4 v[232:235], v4, s[12:15], s37 offen sc1
    ds_read_b64_tr_b16 v[136:137], v56 offset:24576
    ds_read_b64_tr_b16 v[138:139], v56 offset:28672
    s_waitcnt vmcnt(6)
    s_waitcnt lgkmcnt(2)
    v_mfma_f32_16x16x32_bf16 v[72:75], v[104:107], v[208:211], v[72:75]
    ds_read_b64_tr_b16 v[140:141], v57 offset:24576
    ds_read_b64_tr_b16 v[142:143], v57 offset:28672
    v_mfma_f32_16x16x32_bf16 v[76:79], v[108:111], v[208:211], v[76:79]
    ds_read_b64_tr_b16 v[144:145], v58 offset:24576
    ds_read_b64_tr_b16 v[146:147], v58 offset:28672
    v_mfma_f32_16x16x32_bf16 v[80:83], v[112:115], v[208:211], v[80:83]
    ds_read_b64_tr_b16 v[148:149], v59 offset:24576
    ds_read_b64_tr_b16 v[150:151], v59 offset:28672
    v_mfma_f32_16x16x32_bf16 v[84:87], v[116:119], v[208:211], v[84:87]
    ds_read_b64_tr_b16 v[152:153], v60 offset:24576
    ds_read_b64_tr_b16 v[154:155], v60 offset:28672
    v_mfma_f32_16x16x32_bf16 v[88:91], v[120:123], v[208:211], v[88:91]
    ds_read_b64_tr_b16 v[156:157], v61 offset:24576
    ds_read_b64_tr_b16 v[158:159], v61 offset:28672
    v_mfma_f32_16x16x32_bf16 v[92:95], v[124:127], v[208:211], v[92:95]
    ds_read_b64_tr_b16 v[160:161], v62 offset:24576
    ds_read_b64_tr_b16 v[162:163], v62 offset:28672
    v_mfma_f32_16x16x32_bf16 v[96:99], v[128:131], v[208:211], v[96:99]
    ds_read_b64_tr_b16 v[164:165], v63 offset:24576
    ds_read_b64_tr_b16 v[166:167], v63 offset:28672
    v_mfma_f32_16x16x32_bf16 v[100:103], v[132:135], v[208:211], v[100:103]
    s_add_u32 s38, s101, 9
    s_sub_u32 s37, s38, 14
    s_cmp_ge_u32 s38, 14
    s_cselect_b32 s38, s37, s38
    s_lshl_b32 s38, s38, 10
    s_add_u32 s37, s55, s38
    buffer_load_dwordx4 v[236:239], v4, s[12:15], s37 offen sc1
    ds_read_b64_tr_b16 v[104:105], v56 offset:32768
    ds_read_b64_tr_b16 v[106:107], v56 offset:36864
    s_waitcnt vmcnt(6)
    s_waitcnt lgkmcnt(2)
    v_mfma_f32_16x16x32_bf16 v[72:75], v[136:139], v[212:215], v[72:75]
    ds_read_b64_tr_b16 v[108:109], v57 offset:32768
    ds_read_b64_tr_b16 v[110:111], v57 offset:36864
    v_mfma_f32_16x16x32_bf16 v[76:79], v[140:143], v[212:215], v[76:79]
    ds_read_b64_tr_b16 v[112:113], v58 offset:32768
    ds_read_b64_tr_b16 v[114:115], v58 offset:36864
    v_mfma_f32_16x16x32_bf16 v[80:83], v[144:147], v[212:215], v[80:83]
    ds_read_b64_tr_b16 v[116:117], v59 offset:32768
    ds_read_b64_tr_b16 v[118:119], v59 offset:36864
    v_mfma_f32_16x16x32_bf16 v[84:87], v[148:151], v[212:215], v[84:87]
    ds_read_b64_tr_b16 v[120:121], v60 offset:32768
    ds_read_b64_tr_b16 v[122:123], v60 offset:36864
    v_mfma_f32_16x16x32_bf16 v[88:91], v[152:155], v[212:215], v[88:91]
    ds_read_b64_tr_b16 v[124:125], v61 offset:32768
    ds_read_b64_tr_b16 v[126:127], v61 offset:36864
    v_mfma_f32_16x16x32_bf16 v[92:95], v[156:159], v[212:215], v[92:95]
    ds_read_b64_tr_b16 v[128:129], v62 offset:32768
    ds_read_b64_tr_b16 v[130:131], v62 offset:36864
    v_mfma_f32_16x16x32_bf16 v[96:99], v[160:163], v[212:215], v[96:99]
    ds_read_b64_tr_b16 v[132:133], v63 offset:32768
    ds_read_b64_tr_b16 v[134:135], v63 offset:36864
    v_mfma_f32_16x16x32_bf16 v[100:103], v[164:167], v[212:215], v[100:103]
    s_add_u32 s38, s101, 10
    s_sub_u32 s37, s38, 14
    s_cmp_ge_u32 s38, 14
    s_cselect_b32 s38, s37, s38
    s_lshl_b32 s38, s38, 10
    s_add_u32 s37, s55, s38
    buffer_load_dwordx4 v[240:243], v4, s[12:15], s37 offen sc1
    s_cmp_lg_u32 s3, 0
    s_cbranch_scc1 Lfc_37
    s_mov_b32 exec_lo, 0x3fff3fff
    s_mov_b32 exec_hi, 0x3fff
    s_mov_b32 s63, 0
    s_waitcnt vmcnt(3)
Lfl_38:
    v_cmp_ne_u32 vcc, s29, v191
    s_nop 1
    s_cbranch_vccz Lfd_39
    s_sleep 4
    buffer_load_dword v191, v189, s[12:15], 0 offen sc1
    s_waitcnt vmcnt(0)
    s_add_u32 s63, s63, 1
    s_cmp_lt_u32 s63, 200000
    s_cbranch_scc1 Lfl_38
    v_mov_b32 v6, 2
    v_mov_b32 v7, 4
    buffer_store_dword v6, v7, s[16:19], 0 offen
Lfd_39:
    s_mov_b64 exec, -1
Lfc_37:
    s_waitcnt vmcnt(11)
    s_barrier
    ds_read_b64_tr_b16 v[136:137], v56 offset:40960
    ds_read_b64_tr_b16 v[138:139], v56 offset:45056
    s_waitcnt vmcnt(6)
    s_waitcnt lgkmcnt(2)
    v_mfma_f32_16x16x32_bf16 v[72:75], v[104:107], v[216:219], v[72:75]
    ds_read_b64_tr_b16 v[140:141], v57 offset:40960
    ds_read_b64_tr_b16 v[142:143], v57 offset:45056
    v_mfma_f32_16x16x32_bf16 v[76:79], v[108:111], v[216:219], v[76:79]
    ds_read_b64_tr_b16 v[144:145], v58 offset:40960
    ds_read_b64_tr_b16 v[146:147], v58 offset:45056
    v_mfma_f32_16x16x32_bf16 v[80:83], v[112:115], v[216:219], v[80:83]
    ds_read_b64_tr_b16 v[148:149], v59 offset:40960
    ds_read_b64_tr_b16 v[150:151], v59 offset:45056
    v_mfma_f32_16x16x32_bf16 v[84:87], v[116:119], v[216:219], v[84:87]
    ds_read_b64_tr_b16 v[152:153], v60 offset:40960
    ds_read_b64_tr_b16 v[154:155], v60 offset:45056
    v_mfma_f32_16x16x32_bf16 v[88:91], v[120:123], v[216:219], v[88:91]
    ds_read_b64_tr_b16 v[156:157], v61 offset:40960
    ds_read_b64_tr_b16 v[158:159], v61 offset:45056
    v_mfma_f32_16x16x32_bf16 v[92:95], v[124:127], v[216:219], v[92:95]
    ds_read_b64_tr_b16 v[160:161], v62 offset:40960
    ds_read_b64_tr_b16 v[162:163], v62 offset:45056
    v_mfma_f32_16x16x32_bf16 v[96:99], v[128:131], v[216:219], v[96:99]
    ds_read_b64_tr_b16 v[164:165], v63 offset:40960
    ds_read_b64_tr_b16 v[166:167], v63 offset:45056
    v_mfma_f32_16x16x32_bf16 v[100:103], v[132:135], v[216:219], v[100:103]
    s_add_u32 s38, s101, 11
    s_sub_u32 s37, s38, 14
    s_cmp_ge_u32 s38, 14
    s_cselect_b32 s38, s37, s38
    s_lshl_b32 s38, s38, 10
    s_add_u32 s37, s55, s38
    buffer_load_dwordx4 v[244:247], v4, s[12:15], s37 offen sc1
    s_mul_i32 s38, s28, 7
    s_lshr_b32 s38, s38, 1
    v_add_u32 v6, s38, v3
    v_lshlrev_b32 v6, 8, v6
    v_lshl_add_u32 v6, v2, 4, v6
    s_mul_i32 s38, s28, 28
    s_add_u32 s38, s38, 896
    v_lshrrev_b32 v7, 1, v3
    v_lshl_add_u32 v7, v7, 4, v2
    v_add_u32 v7, s38, v7
    v_lshrrev_b32 v8, 4, v7
    v_lshlrev_b32 v8, 9, v8
    v_and_b32 v7, 15, v7
    v_lshl_add_u32 v8, v7, 4, v8
    v_and_b32 v7, 1, v3
    v_lshl_add_u32 v8, v7, 8, v8
    s_lshl_b32 s39, s24, 3
    s_sub_u32 s39, s39, 16
    s_add_u32 s39, s39, s3
    s_add_i32 s40, s39, 0
    s_max_i32 s40, s40, 0
    s_mul_i32 s42, s40, 43008
    s_add_u32 s41, s42, 14336
    s_add_u32 s43, s47, 0
    s_mov_b32 m0, s43
    s_add_u32 s43, s47, 24576
    buffer_load_dwordx4 v6, s[12:15], s41 offen sc1 lds
    s_mov_b32 m0, s43
    s_nop 0
    buffer_load_dwordx4 v8, s[12:15], s42 offen sc1 lds
    s_add_i32 s40, s39, 8
    s_max_i32 s40, s40, 0
    s_mul_i32 s42, s40, 43008
    s_add_u32 s41, s42, 14336
    s_add_u32 s43, s47, 8192
    s_mov_b32 m0, s43
    s_add_u32 s43, s47, 32768
    buffer_load_dwordx4 v6, s[12:15], s41 offen sc1 lds
    s_mov_b32 m0, s43
    s_nop 0
    buffer_load_dwordx4 v8, s[12:15], s42 offen sc1 lds
    s_add_i32 s40, s39, 16
    s_max_i32 s40, s40, 0
    s_mul_i32 s42, s40, 43008
    s_add_u32 s41, s42, 14336
    s_add_u32 s43, s47, 16384
    s_mov_b32 m0, s43
    s_add_u32 s43, s47, 40960
    buffer_load_dwordx4 v6, s[12:15], s41 offen sc1 lds
    s_mov_b32 m0, s43
    s_nop 0
    buffer_load_dwordx4 v8, s[12:15], s42 offen sc1 lds
    s_lshl_b32 s40, s24, 3
    s_add_u32 s40, s40, s3
    s_mul_i32 s41, s40, 43008
    buffer_load_dwordx4 v[184:187], v6, s[12:15], s41 offen sc1
    ds_read_b64_tr_b16 v[104:105], v56 offset:49152
    ds_read_b64_tr_b16 v[106:107], v56 offset:53248
    s_waitcnt vmcnt(13)
    s_waitcnt lgkmcnt(2)
    v_mfma_f32_16x16x32_bf16 v[72:75], v[136:139], v[220:223], v[72:75]
    ds_read_b64_tr_b16 v[108:109], v57 offset:49152
    ds_read_b64_tr_b16 v[110:111], v57 offset:53248
    v_mfma_f32_16x16x32_bf16 v[76:79], v[140:143], v[220:223], v[76:79]
    ds_read_b64_tr_b16 v[112:113], v58 offset:49152
    ds_read_b64_tr_b16 v[114:115], v58 offset:53248
    v_mfma_f32_16x16x32_bf16 v[80:83], v[144:147], v[220:223], v[80:83]
    ds_read_b64_tr_b16 v[116:117], v59 offset:49152
    ds_read_b64_tr_b16 v[118:119], v59 offset:53248
    v_mfma_f32_16x16x32_bf16 v[84:87], v[148:151], v[220:223], v[84:87]
    ds_read_b64_tr_b16 v[120:121], v60 offset:49152
    ds_read_b64_tr_b16 v[122:123], v60 offset:53248
    v_mfma_f32_16x16x32_bf16 v[88:91], v[152:155], v[220:223], v[88:91]
    ds_read_b64_tr_b16 v[124:125], v61 offset:49152
    ds_read_b64_tr_b16 v[126:127], v61 offset:53248
    v_mfma_f32_16x16x32_bf16 v[92:95], v[156:159], v[220:223], v[92:95]
    ds_read_b64_tr_b16 v[128:129], v62 offset:49152
    ds_read_b64_tr_b16 v[130:131], v62 offset:53248
    v_mfma_f32_16x16x32_bf16 v[96:99], v[160:163], v[220:223], v[96:99]
    ds_read_b64_tr_b16 v[132:133], v63 offset:49152
    ds_read_b64_tr_b16 v[134:135], v63 offset:53248
    v_mfma_f32_16x16x32_bf16 v[100:103], v[164:167], v[220:223], v[100:103]
    s_add_u32 s38, s101, 12
    s_sub_u32 s37, s38, 14
    s_cmp_ge_u32 s38, 14
    s_cselect_b32 s38, s37, s38
    s_lshl_b32 s38, s38, 10
    s_add_u32 s37, s55, s38
    buffer_load_dwordx4 v[248:251], v4, s[12:15], s37 offen sc1
    ds_read_b64_tr_b16 v[136:137], v64 offset:0
    ds_read_b64_tr_b16 v[138:139], v64 offset:4096
    s_waitcnt vmcnt(13)
    s_waitcnt lgkmcnt(2)
    v_mfma_f32_16x16x32_bf16 v[72:75], v[104:107], v[224:227], v[72:75]
    ds_read_b64_tr_b16 v[140:141], v65 offset:0
    ds_read_b64_tr_b16 v[142:143], v65 offset:4096
    v_mfma_f32_16x16x32_bf16 v[76:79], v[108:111], v[224:227], v[76:79]
    ds_read_b64_tr_b16 v[144:145], v66 offset:0
    ds_read_b64_tr_b16 v[146:147], v66 offset:4096
    v_mfma_f32_16x16x32_bf16 v[80:83], v[112:115], v[224:227], v[80:83]
    ds_read_b64_tr_b16 v[148:149], v67 offset:0
    ds_read_b64_tr_b16 v[150:151], v67 offset:4096
    v_mfma_f32_16x16x32_bf16 v[84:87], v[116:119], v[224:227], v[84:87]
    ds_read_b64_tr_b16 v[152:153], v68 offset:0
    ds_read_b64_tr_b16 v[154:155], v68 offset:4096
    v_mfma_f32_16x16x32_bf16 v[88:91], v[120:123], v[224:227], v[88:91]
    ds_read_b64_tr_b16 v[156:157], v69 offset:0
    ds_read_b64_tr_b16 v[158:159], v69 offset:4096
    v_mfma_f32_16x16x32_bf16 v[92:95], v[124:127], v[224:227], v[92:95]
    ds_read_b64_tr_b16 v[160:161], v70 offset:0
    ds_read_b64_tr_b16 v[162:163], v70 offset:4096
    v_mfma_f32_16x16x32_bf16 v[96:99], v[128:131], v[224:227], v[96:99]
    ds_read_b64_tr_b16 v[164:165], v71 offset:0
    ds_read_b64_tr_b16 v[166:167], v71 offset:4096
    v_mfma_f32_16x16x32_bf16 v[100:103], v[132:135], v[224:227], v[100:103]
    s_add_u32 s38, s101, 13
    s_sub_u32 s37, s38, 14
    s_cmp_ge_u32 s38, 14
    s_cselect_b32 s38, s37, s38
    s_lshl_b32 s38, s38, 10
    s_add_u32 s37, s55, s38
    buffer_load_dwordx4 v[252:255], v4, s[12:15], s37 offen sc1
    ds_read_b64_tr_b16 v[104:105], v64 offset:8192
    ds_read_b64_tr_b16 v[106:107], v64 offset:12288
    s_waitcnt vmcnt(13)
    s_waitcnt lgkmcnt(2)
    v_mfma_f32_16x16x32_bf16 v[72:75], v[136:139], v[228:231], v[72:75]
    ds_read_b64_tr_b16 v[108:109], v65 offset:8192
    ds_read_b64_tr_b16 v[110:111], v65 offset:12288
    v_mfma_f32_16x16x32_bf16 v[76:79], v[140:143], v[228:231], v[76:79]
    ds_read_b64_tr_b16 v[112:113], v66 offset:8192
    ds_read_b64_tr_b16 v[114:115], v66 offset:12288
    v_mfma_f32_16x16x32_bf16 v[80:83], v[144:147], v[228:231], v[80:83]
    ds_read_b64_tr_b16 v[116:117], v67 offset:8192
    ds_read_b64_tr_b16 v[118:119], v67 offset:12288
    v_mfma_f32_16x16x32_bf16 v[84:87], v[148:151], v[228:231], v[84:87]
    ds_read_b64_tr_b16 v[120:121], v68 offset:8192
    ds_read_b64_tr_b16 v[122:123], v68 offset:12288
    v_mfma_f32_16x16x32_bf16 v[88:91], v[152:155], v[228:231], v[88:91]
    ds_read_b64_tr_b16 v[124:125], v69 offset:8192
    ds_read_b64_tr_b16 v[126:127], v69 offset:12288
    v_mfma_f32_16x16x32_bf16 v[92:95], v[156:159], v[228:231], v[92:95]
    ds_read_b64_tr_b16 v[128:129], v70 offset:8192
    ds_read_b64_tr_b16 v[130:131], v70 offset:12288
    v_mfma_f32_16x16x32_bf16 v[96:99], v[160:163], v[228:231], v[96:99]
    ds_read_b64_tr_b16 v[132:133], v71 offset:8192
    ds_read_b64_tr_b16 v[134:135], v71 offset:12288
    v_mfma_f32_16x16x32_bf16 v[100:103], v[164:167], v[228:231], v[100:103]
    s_barrier
    s_add_u32 s44, s47, 57344
    s_mov_b32 m0, s44
    s_mov_b32 s45, 0
    buffer_load_dwordx4 v194, s[20:23], s45 offen lds
    s_add_u32 s44, s47, 73728
    s_mov_b32 m0, s44
    s_mov_b32 s45, 57344
    buffer_load_dwordx4 v194, s[20:23], s45 offen lds
    s_cmp_lg_u32 s3, 0
    s_cbranch_scc1 Lcsd_40
    s_mov_b32 m0, 49152
    s_lshl_b32 s37, s25, 9
    s_add_u32 s37, s37, 0x1404000
    s_mov_b32 exec_hi, 0
    buffer_load_dwordx4 v4, s[12:15], s37 offen sc1 lds
    s_mov_b64 exec, -1
Lcsd_40:
    ds_read_b64_tr_b16 v[136:137], v64 offset:16384
    ds_read_b64_tr_b16 v[138:139], v64 offset:20480
    s_waitcnt vmcnt(14)
    s_waitcnt lgkmcnt(2)
    v_mfma_f32_16x16x32_bf16 v[72:75], v[104:107], v[232:235], v[72:75]
    ds_read_b64_tr_b16 v[140:141], v65 offset:16384
    ds_read_b64_tr_b16 v[142:143], v65 offset:20480
    v_mfma_f32_16x16x32_bf16 v[76:79], v[108:111], v[232:235], v[76:79]
    ds_read_b64_tr_b16 v[144:145], v66 offset:16384
    ds_read_b64_tr_b16 v[146:147], v66 offset:20480
    v_mfma_f32_16x16x32_bf16 v[80:83], v[112:115], v[232:235], v[80:83]
    ds_read_b64_tr_b16 v[148:149], v67 offset:16384
    ds_read_b64_tr_b16 v[150:151], v67 offset:20480
    v_mfma_f32_16x16x32_bf16 v[84:87], v[116:119], v[232:235], v[84:87]
    ds_read_b64_tr_b16 v[152:153], v68 offset:16384
    ds_read_b64_tr_b16 v[154:155], v68 offset:20480
    v_mfma_f32_16x16x32_bf16 v[88:91], v[120:123], v[232:235], v[88:91]
    ds_read_b64_tr_b16 v[156:157], v69 offset:16384
    ds_read_b64_tr_b16 v[158:159], v69 offset:20480
    v_mfma_f32_16x16x32_bf16 v[92:95], v[124:127], v[232:235], v[92:95]
    ds_read_b64_tr_b16 v[160:161], v70 offset:16384
    ds_read_b64_tr_b16 v[162:163], v70 offset:20480
    v_mfma_f32_16x16x32_bf16 v[96:99], v[128:131], v[232:235], v[96:99]
    ds_read_b64_tr_b16 v[164:165], v71 offset:16384
    ds_read_b64_tr_b16 v[166:167], v71 offset:20480
    v_mfma_f32_16x16x32_bf16 v[100:103], v[132:135], v[232:235], v[100:103]
    s_add_u32 s44, s47, 90112
    s_mov_b32 m0, s44
    s_mov_b32 s45, 114688
    buffer_load_dwordx4 v194, s[20:23], s45 offen lds
    ds_read_b64_tr_b16 v[104:105], v64 offset:24576
    ds_read_b64_tr_b16 v[106:107], v64 offset:28672
    s_waitcnt vmcnt(14)
    s_waitcnt lgkmcnt(2)
    v_mfma_f32_16x16x32_bf16 v[72:75], v[136:139], v[236:239], v[72:75]
    ds_read_b64_tr_b16 v[108:109], v65 offset:24576
    ds_read_b64_tr_b16 v[110:111], v65 offset:28672
    v_mfma_f32_16x16x32_bf16 v[76:79], v[140:143], v[236:239], v[76:79]
    ds_read_b64_tr_b16 v[112:113], v66 offset:24576
    ds_read_b64_tr_b16 v[114:115], v66 offset:28672
    v_mfma_f32_16x16x32_bf16 v[80:83], v[144:147], v[236:239], v[80:83]
    ds_read_b64_tr_b16 v[116:117], v67 offset:24576
    ds_read_b64_tr_b16 v[118:119], v67 offset:28672
    v_mfma_f32_16x16x32_bf16 v[84:87], v[148:151], v[236:239], v[84:87]
    ds_read_b64_tr_b16 v[120:121], v68 offset:24576
    ds_read_b64_tr_b16 v[122:123], v68 offset:28672
    v_mfma_f32_16x16x32_bf16 v[88:91], v[152:155], v[236:239], v[88:91]
    ds_read_b64_tr_b16 v[124:125], v69 offset:24576
    ds_read_b64_tr_b16 v[126:127], v69 offset:28672
    v_mfma_f32_16x16x32_bf16 v[92:95], v[156:159], v[236:239], v[92:95]
    ds_read_b64_tr_b16 v[128:129], v70 offset:24576
    ds_read_b64_tr_b16 v[130:131], v70 offset:28672
    v_mfma_f32_16x16x32_bf16 v[96:99], v[160:163], v[236:239], v[96:99]
    ds_read_b64_tr_b16 v[132:133], v71 offset:24576
    ds_read_b64_tr_b16 v[134:135], v71 offset:28672
    v_mfma_f32_16x16x32_bf16 v[100:103], v[164:167], v[236:239], v[100:103]
    s_add_u32 s44, s47, 106496
    s_mov_b32 m0, s44
    s_mov_b32 s45, 172032
    buffer_load_dwordx4 v194, s[20:23], s45 offen lds
    ds_read_b64_tr_b16 v[136:137], v64 offset:32768
    ds_read_b64_tr_b16 v[138:139], v64 offset:36864
    s_waitcnt vmcnt(14)
    s_waitcnt lgkmcnt(2)
    v_mfma_f32_16x16x32_bf16 v[72:75], v[104:107], v[240:243], v[72:75]
    ds_read_b64_tr_b16 v[140:141], v65 offset:32768
    ds_read_b64_tr_b16 v[142:143], v65 offset:36864
    v_mfma_f32_16x16x32_bf16 v[76:79], v[108:111], v[240:243], v[76:79]
    ds_read_b64_tr_b16 v[144:145], v66 offset:32768
    ds_read_b64_tr_b16 v[146:147], v66 offset:36864
    v_mfma_f32_16x16x32_bf16 v[80:83], v[112:115], v[240:243], v[80:83]
    ds_read_b64_tr_b16 v[148:149], v67 offset:32768
    ds_read_b64_tr_b16 v[150:151], v67 offset:36864
    v_mfma_f32_16x16x32_bf16 v[84:87], v[116:119], v[240:243], v[84:87]
    ds_read_b64_tr_b16 v[152:153], v68 offset:32768
    ds_read_b64_tr_b16 v[154:155], v68 offset:36864
    v_mfma_f32_16x16x32_bf16 v[88:91], v[120:123], v[240:243], v[88:91]
    ds_read_b64_tr_b16 v[156:157], v69 offset:32768
    ds_read_b64_tr_b16 v[158:159], v69 offset:36864
    v_mfma_f32_16x16x32_bf16 v[92:95], v[124:127], v[240:243], v[92:95]
    ds_read_b64_tr_b16 v[160:161], v70 offset:32768
    ds_read_b64_tr_b16 v[162:163], v70 offset:36864
    v_mfma_f32_16x16x32_bf16 v[96:99], v[128:131], v[240:243], v[96:99]
    ds_read_b64_tr_b16 v[164:165], v71 offset:32768
    ds_read_b64_tr_b16 v[166:167], v71 offset:36864
    v_mfma_f32_16x16x32_bf16 v[100:103], v[132:135], v[240:243], v[100:103]
    v_lshlrev_b32 v6, 3, v1
    s_lshl_b32 s37, s61, 11
    s_add_u32 s37, s37, 0x1410000
    buffer_load_dwordx2 v[48:49], v6, s[12:15], s37 offen offset:0 sc1
    buffer_load_dwordx2 v[50:51], v6, s[12:15], s37 offen offset:512 sc1
    buffer_load_dwordx2 v[52:53], v6, s[12:15], s37 offen offset:1024 sc1
    buffer_load_dwordx2 v[54:55], v6, s[12:15], s37 offen offset:1536 sc1
    v_lshrrev_b32 v6, 1, v3
    v_lshlrev_b32 v6, 8, v6
    v_lshl_add_u32 v6, v2, 4, v6
    v_and_b32 v7, 1, v3
    v_lshl_add_u32 v6, v7, 3, v6
    buffer_load_dwordx2 v[180:181], v6, s[12:15], s54 offen sc1
    buffer_load_dwordx2 v[182:183], v6, s[12:15], s54 offen offset:512 sc1
    v_lshlrev_b32 v7, 2, v193
    s_mov_b32 s43, 0x1400000
    buffer_load_dword v179, v7, s[12:15], s43 offen sc1
    ds_read_b64_tr_b16 v[104:105], v64 offset:40960
    ds_read_b64_tr_b16 v[106:107], v64 offset:45056
    s_waitcnt vmcnt(20)
    s_waitcnt lgkmcnt(2)
    v_mfma_f32_16x16x32_bf16 v[72:75], v[136:139], v[244:247], v[72:75]
    ds_read_b64_tr_b16 v[108:109], v65 offset:40960
    ds_read_b64_tr_b16 v[110:111], v65 offset:45056
    v_mfma_f32_16x16x32_bf16 v[76:79], v[140:143], v[244:247], v[76:79]
    ds_read_b64_tr_b16 v[112:113], v66 offset:40960
    ds_read_b64_tr_b16 v[114:115], v66 offset:45056
    v_mfma_f32_16x16x32_bf16 v[80:83], v[144:147], v[244:247], v[80:83]
    ds_read_b64_tr_b16 v[116:117], v67 offset:40960
    ds_read_b64_tr_b16 v[118:119], v67 offset:45056
    v_mfma_f32_16x16x32_bf16 v[84:87], v[148:151], v[244:247], v[84:87]
    ds_read_b64_tr_b16 v[120:121], v68 offset:40960
    ds_read_b64_tr_b16 v[122:123], v68 offset:45056
    v_mfma_f32_16x16x32_bf16 v[88:91], v[152:155], v[244:247], v[88:91]
    ds_read_b64_tr_b16 v[124:125], v69 offset:40960
    ds_read_b64_tr_b16 v[126:127], v69 offset:45056
    v_mfma_f32_16x16x32_bf16 v[92:95], v[156:159], v[244:247], v[92:95]
    ds_read_b64_tr_b16 v[128:129], v70 offset:40960
    ds_read_b64_tr_b16 v[130:131], v70 offset:45056
    v_mfma_f32_16x16x32_bf16 v[96:99], v[160:163], v[244:247], v[96:99]
    ds_read_b64_tr_b16 v[132:133], v71 offset:40960
    ds_read_b64_tr_b16 v[134:135], v71 offset:45056
    v_mfma_f32_16x16x32_bf16 v[100:103], v[164:167], v[244:247], v[100:103]
    s_waitcnt vmcnt(9)
    s_barrier
    s_add_u32 s44, s47, 122880
    s_mov_b32 m0, s44
    s_mov_b32 s45, 229376
    buffer_load_dwordx4 v194, s[20:23], s45 offen lds
    ds_read_b64_tr_b16 v[136:137], v64 offset:49152
    ds_read_b64_tr_b16 v[138:139], v64 offset:53248
    s_waitcnt vmcnt(13)
    s_waitcnt lgkmcnt(2)
    v_mfma_f32_16x16x32_bf16 v[72:75], v[104:107], v[248:251], v[72:75]
    ds_read_b64_tr_b16 v[140:141], v65 offset:49152
    ds_read_b64_tr_b16 v[142:143], v65 offset:53248
    v_mfma_f32_16x16x32_bf16 v[76:79], v[108:111], v[248:251], v[76:79]
    ds_read_b64_tr_b16 v[144:145], v66 offset:49152
    ds_read_b64_tr_b16 v[146:147], v66 offset:53248
    v_mfma_f32_16x16x32_bf16 v[80:83], v[112:115], v[248:251], v[80:83]
    ds_read_b64_tr_b16 v[148:149], v67 offset:49152
    ds_read_b64_tr_b16 v[150:151], v67 offset:53248
    v_mfma_f32_16x16x32_bf16 v[84:87], v[116:119], v[248:251], v[84:87]
    ds_read_b64_tr_b16 v[152:153], v68 offset:49152
    ds_read_b64_tr_b16 v[154:155], v68 offset:53248
    v_mfma_f32_16x16x32_bf16 v[88:91], v[120:123], v[248:251], v[88:91]
    ds_read_b64_tr_b16 v[156:157], v69 offset:49152
    ds_read_b64_tr_b16 v[158:159], v69 offset:53248
    v_mfma_f32_16x16x32_bf16 v[92:95], v[124:127], v[248:251], v[92:95]
    ds_read_b64_tr_b16 v[160:161], v70 offset:49152
    ds_read_b64_tr_b16 v[162:163], v70 offset:53248
    v_mfma_f32_16x16x32_bf16 v[96:99], v[128:131], v[248:251], v[96:99]
    ds_read_b64_tr_b16 v[164:165], v71 offset:49152
    ds_read_b64_tr_b16 v[166:167], v71 offset:53248
    v_mfma_f32_16x16x32_bf16 v[100:103], v[132:135], v[248:251], v[100:103]
    s_add_u32 s44, s47, 139264
    s_mov_b32 m0, s44
    s_mov_b32 s45, 286720
    buffer_load_dwordx4 v194, s[20:23], s45 offen lds
    s_waitcnt vmcnt(13)
    s_waitcnt lgkmcnt(0)
    v_mfma_f32_16x16x32_bf16 v[72:75], v[136:139], v[252:255], v[72:75]
    v_mfma_f32_16x16x32_bf16 v[76:79], v[140:143], v[252:255], v[76:79]
    v_mfma_f32_16x16x32_bf16 v[80:83], v[144:147], v[252:255], v[80:83]
    v_mfma_f32_16x16x32_bf16 v[84:87], v[148:151], v[252:255], v[84:87]
    v_mfma_f32_16x16x32_bf16 v[88:91], v[152:155], v[252:255], v[88:91]
    v_mfma_f32_16x16x32_bf16 v[92:95], v[156:159], v[252:255], v[92:95]
    v_mfma_f32_16x16x32_bf16 v[96:99], v[160:163], v[252:255], v[96:99]
    v_mfma_f32_16x16x32_bf16 v[100:103], v[164:167], v[252:255], v[100:103]
    v_lshlrev_b32 v7, 4, v3
    ds_read_b128 v[16:19], v7 offset:49152
    ds_read_b128 v[20:23], v7 offset:49216
    ds_read_b128 v[24:27], v7 offset:49280
    ds_read_b128 v[28:31], v7 offset:49344
    ds_read_b128 v[32:35], v7 offset:49408
    ds_read_b128 v[36:39], v7 offset:49472
    ds_read_b128 v[40:43], v7 offset:49536
    ds_read_b128 v[44:47], v7 offset:49600
    s_waitcnt vmcnt(5)
    s_mov_b32 s52, 0xbdd2d3e8
    s_mov_b32 s53, 0xbdd2d3e8
    s_mov_b32 s54, 1.0
    s_mov_b32 s55, 1.0
    v_mov_b32 v120, 0xc0135761
    v_mov_b32 v121, 0xc0135761
    v_cmp_gt_u32 vcc, 2, v3
    s_nop 1
    v_cndmask_b32 v54, 0, v54, vcc
    v_cndmask_b32 v55, 0, v55, vcc
    v_pk_add_f32 v[48:49], v[48:49], v[50:51]
    v_pk_add_f32 v[52:53], v[52:53], v[54:55]
    v_pk_add_f32 v[48:49], v[48:49], v[52:53]
    v_mov_b32 v6, v48
    s_nop 1
    v_permlane32_swap_b32 v48, v6
    s_nop 1
    v_add_f32 v48, v48, v6
    v_mov_b32 v6, v48
    s_nop 1
    v_permlane16_swap_b32 v48, v6
    s_nop 1
    v_add_f32 v48, v48, v6
    v_mov_b32 v6, v49
    s_nop 1
    v_permlane32_swap_b32 v49, v6
    s_nop 1
    v_add_f32 v49, v49, v6
    v_mov_b32 v6, v49
    s_nop 1
    v_permlane16_swap_b32 v49, v6
    s_nop 1
    v_add_f32 v49, v49, v6
    v_mul_f32 v48, 0x3b124925, v48
    v_mul_f32 v49, 0x3b124925, v49
    v_fma_f32 v49, -v48, v48, v49
    v_max_f32 v49, 0, v49
    v_add_f32 v49, 0x3727c5ac, v49
    v_rsq_f32 v188, v49
    s_nop 0
    v_mul_f32 v190, v48, v188
    v_sub_f32 v190, 0, v190
    s_waitcnt lgkmcnt(0)
    s_waitcnt vmcnt(15)
    s_barrier
    s_lshl_b32 s37, s24, 3
    s_add_u32 s37, s37, s3
    s_mul_i32 s37, s37, 57344
    s_lshl_b32 s38, s25, 12
    s_add_u32 s37, s37, s38
    s_add_u32 s37, s37, 0xc00000
    s_add_u32 s44, s47, 155648
    s_mov_b32 m0, s44
    s_mov_b32 s45, 344064
    buffer_load_dwordx4 v194, s[20:23], s45 offen lds
    v_pk_mul_f32 v[16:17], v[16:17], v[190:191] op_sel_hi:[1,0]
    v_pk_fma_f32 v[72:73], v[72:73], v[188:189], v[16:17] op_sel_hi:[1,0,1]
    v_pk_mul_f32 v[18:19], v[18:19], v[190:191] op_sel_hi:[1,0]
    v_pk_fma_f32 v[74:75], v[74:75], v[188:189], v[18:19] op_sel_hi:[1,0,1]
    v_pk_mul_f32 v[20:21], v[20:21], v[190:191] op_sel_hi:[1,0]
    v_pk_fma_f32 v[76:77], v[76:77], v[188:189], v[20:21] op_sel_hi:[1,0,1]
    v_pk_mul_f32 v[22:23], v[22:23], v[190:191] op_sel_hi:[1,0]
    v_pk_fma_f32 v[78:79], v[78:79], v[188:189], v[22:23] op_sel_hi:[1,0,1]
    v_pk_mul_f32 v[10:11], v[72:73], v[72:73]
    v_pk_fma_f32 v[10:11], v[10:11], s[52:53], v[120:121]
    v_pk_mul_f32 v[10:11], v[10:11], v[72:73]
    v_exp_f32 v10, v10
    v_exp_f32 v11, v11
    s_nop 0
    v_pk_add_f32 v[10:11], v[10:11], s[54:55]
    v_rcp_f32 v10, v10
    v_rcp_f32 v11, v11
    s_nop 0
    v_pk_mul_f32 v[72:73], v[72:73], v[10:11]
    v_cvt_pk_bf16_f32 v104, v72, v73
    v_pk_mul_f32 v[12:13], v[74:75], v[74:75]
    v_pk_fma_f32 v[12:13], v[12:13], s[52:53], v[120:121]
    v_pk_mul_f32 v[12:13], v[12:13], v[74:75]
    v_exp_f32 v12, v12
    v_exp_f32 v13, v13
    s_nop 0
    v_pk_add_f32 v[12:13], v[12:13], s[54:55]
    v_rcp_f32 v12, v12
    v_rcp_f32 v13, v13
    s_nop 0
    v_pk_mul_f32 v[74:75], v[74:75], v[12:13]
    v_cvt_pk_bf16_f32 v105, v74, v75
    v_pk_mul_f32 v[10:11], v[76:77], v[76:77]
    v_pk_fma_f32 v[10:11], v[10:11], s[52:53], v[120:121]
    v_pk_mul_f32 v[10:11], v[10:11], v[76:77]
    v_exp_f32 v10, v10
    v_exp_f32 v11, v11
    s_nop 0
    v_pk_add_f32 v[10:11], v[10:11], s[54:55]
    v_rcp_f32 v10, v10
    v_rcp_f32 v11, v11
    s_nop 0
    v_pk_mul_f32 v[76:77], v[76:77], v[10:11]
    v_cvt_pk_bf16_f32 v106, v76, v77
    v_pk_mul_f32 v[12:13], v[78:79], v[78:79]
    v_pk_fma_f32 v[12:13], v[12:13], s[52:53], v[120:121]
    v_pk_mul_f32 v[12:13], v[12:13], v[78:79]
    v_exp_f32 v12, v12
    v_exp_f32 v13, v13
    s_nop 0
    v_pk_add_f32 v[12:13], v[12:13], s[54:55]
    v_rcp_f32 v12, v12
    v_rcp_f32 v13, v13
    s_nop 0
    v_pk_mul_f32 v[78:79], v[78:79], v[12:13]
    v_cvt_pk_bf16_f32 v107, v78, v79
    s_nop 1
    v_permlane32_swap_b32 v104, v106
    v_permlane32_swap_b32 v105, v107
    s_nop 1
    v_permlane16_swap_b32 v104, v106
    v_permlane16_swap_b32 v105, v107
    buffer_store_dwordx4 v[104:107], v4, s[12:15], s37 offen offset:0 sc1
    v_pk_mul_f32 v[24:25], v[24:25], v[190:191] op_sel_hi:[1,0]
    v_pk_fma_f32 v[80:81], v[80:81], v[188:189], v[24:25] op_sel_hi:[1,0,1]
    v_pk_mul_f32 v[26:27], v[26:27], v[190:191] op_sel_hi:[1,0]
    v_pk_fma_f32 v[82:83], v[82:83], v[188:189], v[26:27] op_sel_hi:[1,0,1]
    v_pk_mul_f32 v[28:29], v[28:29], v[190:191] op_sel_hi:[1,0]
    v_pk_fma_f32 v[84:85], v[84:85], v[188:189], v[28:29] op_sel_hi:[1,0,1]
    v_pk_mul_f32 v[30:31], v[30:31], v[190:191] op_sel_hi:[1,0]
    v_pk_fma_f32 v[86:87], v[86:87], v[188:189], v[30:31] op_sel_hi:[1,0,1]
    v_pk_mul_f32 v[10:11], v[80:81], v[80:81]
    v_pk_fma_f32 v[10:11], v[10:11], s[52:53], v[120:121]
    v_pk_mul_f32 v[10:11], v[10:11], v[80:81]
    v_exp_f32 v10, v10
    v_exp_f32 v11, v11
    s_nop 0
    v_pk_add_f32 v[10:11], v[10:11], s[54:55]
    v_rcp_f32 v10, v10
    v_rcp_f32 v11, v11
    s_nop 0
    v_pk_mul_f32 v[80:81], v[80:81], v[10:11]
    v_cvt_pk_bf16_f32 v108, v80, v81
    v_pk_mul_f32 v[12:13], v[82:83], v[82:83]
    v_pk_fma_f32 v[12:13], v[12:13], s[52:53], v[120:121]
    v_pk_mul_f32 v[12:13], v[12:13], v[82:83]
    v_exp_f32 v12, v12
    v_exp_f32 v13, v13
    s_nop 0
    v_pk_add_f32 v[12:13], v[12:13], s[54:55]
    v_rcp_f32 v12, v12
    v_rcp_f32 v13, v13
    s_nop 0
    v_pk_mul_f32 v[82:83], v[82:83], v[12:13]
    v_cvt_pk_bf16_f32 v109, v82, v83
    v_pk_mul_f32 v[10:11], v[84:85], v[84:85]
    v_pk_fma_f32 v[10:11], v[10:11], s[52:53], v[120:121]
    v_pk_mul_f32 v[10:11], v[10:11], v[84:85]
    v_exp_f32 v10, v10
    v_exp_f32 v11, v11
    s_nop 0
    v_pk_add_f32 v[10:11], v[10:11], s[54:55]
    v_rcp_f32 v10, v10
    v_rcp_f32 v11, v11
    s_nop 0
    v_pk_mul_f32 v[84:85], v[84:85], v[10:11]
    v_cvt_pk_bf16_f32 v110, v84, v85
    v_pk_mul_f32 v[12:13], v[86:87], v[86:87]
    v_pk_fma_f32 v[12:13], v[12:13], s[52:53], v[120:121]
    v_pk_mul_f32 v[12:13], v[12:13], v[86:87]
    v_exp_f32 v12, v12
    v_exp_f32 v13, v13
    s_nop 0
    v_pk_add_f32 v[12:13], v[12:13], s[54:55]
    v_rcp_f32 v12, v12
    v_rcp_f32 v13, v13
    s_nop 0
    v_pk_mul_f32 v[86:87], v[86:87], v[12:13]
    v_cvt_pk_bf16_f32 v111, v86, v87
    s_nop 1
    v_permlane32_swap_b32 v108, v110
    v_permlane32_swap_b32 v109, v111
    s_nop 1
    v_permlane16_swap_b32 v108, v110
    v_permlane16_swap_b32 v109, v111
    buffer_store_dwordx4 v[108:111], v4, s[12:15], s37 offen offset:1024 sc1
    v_pk_mul_f32 v[32:33], v[32:33], v[190:191] op_sel_hi:[1,0]
    v_pk_fma_f32 v[88:89], v[88:89], v[188:189], v[32:33] op_sel_hi:[1,0,1]
    v_pk_mul_f32 v[34:35], v[34:35], v[190:191] op_sel_hi:[1,0]
    v_pk_fma_f32 v[90:91], v[90:91], v[188:189], v[34:35] op_sel_hi:[1,0,1]
    v_pk_mul_f32 v[36:37], v[36:37], v[190:191] op_sel_hi:[1,0]
    v_pk_fma_f32 v[92:93], v[92:93], v[188:189], v[36:37] op_sel_hi:[1,0,1]
    v_pk_mul_f32 v[38:39], v[38:39], v[190:191] op_sel_hi:[1,0]
    v_pk_fma_f32 v[94:95], v[94:95], v[188:189], v[38:39] op_sel_hi:[1,0,1]
    v_pk_mul_f32 v[10:11], v[88:89], v[88:89]
    v_pk_fma_f32 v[10:11], v[10:11], s[52:53], v[120:121]
    v_pk_mul_f32 v[10:11], v[10:11], v[88:89]
    v_exp_f32 v10, v10
    v_exp_f32 v11, v11
    s_nop 0
    v_pk_add_f32 v[10:11], v[10:11], s[54:55]
    v_rcp_f32 v10, v10
    v_rcp_f32 v11, v11
    s_nop 0
    v_pk_mul_f32 v[88:89], v[88:89], v[10:11]
    v_cvt_pk_bf16_f32 v112, v88, v89
    v_pk_mul_f32 v[12:13], v[90:91], v[90:91]
    v_pk_fma_f32 v[12:13], v[12:13], s[52:53], v[120:121]
    v_pk_mul_f32 v[12:13], v[12:13], v[90:91]
    v_exp_f32 v12, v12
    v_exp_f32 v13, v13
    s_nop 0
    v_pk_add_f32 v[12:13], v[12:13], s[54:55]
    v_rcp_f32 v12, v12
    v_rcp_f32 v13, v13
    s_nop 0
    v_pk_mul_f32 v[90:91], v[90:91], v[12:13]
    v_cvt_pk_bf16_f32 v113, v90, v91
    v_pk_mul_f32 v[10:11], v[92:93], v[92:93]
    v_pk_fma_f32 v[10:11], v[10:11], s[52:53], v[120:121]
    v_pk_mul_f32 v[10:11], v[10:11], v[92:93]
    v_exp_f32 v10, v10
    v_exp_f32 v11, v11
    s_nop 0
    v_pk_add_f32 v[10:11], v[10:11], s[54:55]
    v_rcp_f32 v10, v10
    v_rcp_f32 v11, v11
    s_nop 0
    v_pk_mul_f32 v[92:93], v[92:93], v[10:11]
    v_cvt_pk_bf16_f32 v114, v92, v93
    v_pk_mul_f32 v[12:13], v[94:95], v[94:95]
    v_pk_fma_f32 v[12:13], v[12:13], s[52:53], v[120:121]
    v_pk_mul_f32 v[12:13], v[12:13], v[94:95]
    v_exp_f32 v12, v12
    v_exp_f32 v13, v13
    s_nop 0
    v_pk_add_f32 v[12:13], v[12:13], s[54:55]
    v_rcp_f32 v12, v12
    v_rcp_f32 v13, v13
    s_nop 0
    v_pk_mul_f32 v[94:95], v[94:95], v[12:13]
    v_cvt_pk_bf16_f32 v115, v94, v95
    s_nop 1
    v_permlane32_swap_b32 v112, v114
    v_permlane32_swap_b32 v113, v115
    s_nop 1
    v_permlane16_swap_b32 v112, v114
    v_permlane16_swap_b32 v113, v115
    buffer_store_dwordx4 v[112:115], v4, s[12:15], s37 offen offset:2048 sc1
    v_pk_mul_f32 v[40:41], v[40:41], v[190:191] op_sel_hi:[1,0]
    v_pk_fma_f32 v[96:97], v[96:97], v[188:189], v[40:41] op_sel_hi:[1,0,1]
    v_pk_mul_f32 v[42:43], v[42:43], v[190:191] op_sel_hi:[1,0]
    v_pk_fma_f32 v[98:99], v[98:99], v[188:189], v[42:43] op_sel_hi:[1,0,1]
    v_pk_mul_f32 v[44:45], v[44:45], v[190:191] op_sel_hi:[1,0]
    v_pk_fma_f32 v[100:101], v[100:101], v[188:189], v[44:45] op_sel_hi:[1,0,1]
    v_pk_mul_f32 v[46:47], v[46:47], v[190:191] op_sel_hi:[1,0]
    v_pk_fma_f32 v[102:103], v[102:103], v[188:189], v[46:47] op_sel_hi:[1,0,1]
    v_pk_mul_f32 v[10:11], v[96:97], v[96:97]
    v_pk_fma_f32 v[10:11], v[10:11], s[52:53], v[120:121]
    v_pk_mul_f32 v[10:11], v[10:11], v[96:97]
    v_exp_f32 v10, v10
    v_exp_f32 v11, v11
    s_nop 0
    v_pk_add_f32 v[10:11], v[10:11], s[54:55]
    v_rcp_f32 v10, v10
    v_rcp_f32 v11, v11
    s_nop 0
    v_pk_mul_f32 v[96:97], v[96:97], v[10:11]
    v_cvt_pk_bf16_f32 v116, v96, v97
    v_pk_mul_f32 v[12:13], v[98:99], v[98:99]
    v_pk_fma_f32 v[12:13], v[12:13], s[52:53], v[120:121]
    v_pk_mul_f32 v[12:13], v[12:13], v[98:99]
    v_exp_f32 v12, v12
    v_exp_f32 v13, v13
    s_nop 0
    v_pk_add_f32 v[12:13], v[12:13], s[54:55]
    v_rcp_f32 v12, v12
    v_rcp_f32 v13, v13
    s_nop 0
    v_pk_mul_f32 v[98:99], v[98:99], v[12:13]
    v_cvt_pk_bf16_f32 v117, v98, v99
    v_pk_mul_f32 v[10:11], v[100:101], v[100:101]
    v_pk_fma_f32 v[10:11], v[10:11], s[52:53], v[120:121]
    v_pk_mul_f32 v[10:11], v[10:11], v[100:101]
    v_exp_f32 v10, v10
    v_exp_f32 v11, v11
    s_nop 0
    v_pk_add_f32 v[10:11], v[10:11], s[54:55]
    v_rcp_f32 v10, v10
    v_rcp_f32 v11, v11
    s_nop 0
    v_pk_mul_f32 v[100:101], v[100:101], v[10:11]
    v_cvt_pk_bf16_f32 v118, v100, v101
    v_pk_mul_f32 v[12:13], v[102:103], v[102:103]
    v_pk_fma_f32 v[12:13], v[12:13], s[52:53], v[120:121]
    v_pk_mul_f32 v[12:13], v[12:13], v[102:103]
    v_exp_f32 v12, v12
    v_exp_f32 v13, v13
    s_nop 0
    v_pk_add_f32 v[12:13], v[12:13], s[54:55]
    v_rcp_f32 v12, v12
    v_rcp_f32 v13, v13
    s_nop 0
    v_pk_mul_f32 v[102:103], v[102:103], v[12:13]
    v_cvt_pk_bf16_f32 v119, v102, v103
    s_nop 1
    v_permlane32_swap_b32 v116, v118
    v_permlane32_swap_b32 v117, v119
    s_nop 1
    v_permlane16_swap_b32 v116, v118
    v_permlane16_swap_b32 v117, v119
    buffer_store_dwordx4 v[116:119], v4, s[12:15], s37 offen offset:3072 sc1
    s_mov_b32 s8, s82
    s_mov_b32 s9, s83
    s_mov_b32 s10, 0x1c0000
    s_mov_b32 s11, 0x00020000
    s_lshl_b32 s58, s24, 3
    s_add_u32 s58, s58, s3
    s_and_b32 s42, s3, 6
    s_and_b32 s43, s3, 1
    s_lshl_b32 s44, s42, 10
    v_add_u32 v240, s44, v4
    ds_read_b128 v[200:203], v240 offset:0
    ds_read_b128 v[204:207], v240 offset:1024
    v_lshrrev_b32 v6, 1, v3
    v_lshlrev_b32 v6, 10, v6
    v_and_b32 v7, 1, v3
    v_lshl_add_u32 v6, v7, 8, v6
    v_lshl_add_u32 v6, v2, 4, v6
    s_add_u32 s44, s44, 24576
    v_add_u32 v241, s44, v6
    s_and_b32 s44, s28, 1
    s_mul_i32 s46, s44, 3
    s_xor_b32 s46, s46, 3
    v_cmp_ne_u32 vcc, s46, v3
    s_cmp_eq_u32 s44, 0
    s_cselect_b64 s[50:51], -1, vcc
    s_cselect_b64 s[52:53], vcc, -1
    v_cndmask_b32 v184, 0, v184, s[50:51]
    v_cndmask_b32 v185, 0, v185, s[50:51]
    v_cndmask_b32 v186, 0, v186, s[52:53]
    v_cndmask_b32 v187, 0, v187, s[52:53]
    v_mov_b32 v232, 0x3f803f80
    v_mov_b32 v233, 0x3f803f80
    v_mov_b32 v234, 0x3f803f80
    v_mov_b32 v235, 0x3f803f80
    s_lshl_b32 s44, s43, 4
    s_add_u32 s44, s44, 256
    v_lshlrev_b32 v6, 2, v3
    v_sub_u32 v242, v2, v6
    v_add_u32 v242, s44, v242
    s_add_u32 s59, s43, 16
    s_sub_i32 s59, s59, s58
    s_max_i32 s59, s59, 0
    v_mov_b32 v243, 0xf149f2ca
    v_subrev_u32 v6, 0, v242
    v_cmp_gt_u32 vcc, 256, v6
    s_nop 1
    v_cndmask_b32 v216, v243, 0, vcc
    v_subrev_u32 v6, 1, v242
    v_cmp_gt_u32 vcc, 256, v6
    s_nop 1
    v_cndmask_b32 v217, v243, 0, vcc
    v_subrev_u32 v6, 2, v242
    v_cmp_gt_u32 vcc, 256, v6
    s_nop 1
    v_cndmask_b32 v218, v243, 0, vcc
    v_subrev_u32 v6, 3, v242
    v_cmp_gt_u32 vcc, 256, v6
    s_nop 1
    v_cndmask_b32 v219, v243, 0, vcc
    v_subrev_u32 v6, 16, v242
    v_cmp_gt_u32 vcc, 256, v6
    s_nop 1
    v_cndmask_b32 v220, v243, 0, vcc
    v_subrev_u32 v6, 17, v242
    v_cmp_gt_u32 vcc, 256, v6
    s_nop 1
    v_cndmask_b32 v221, v243, 0, vcc
    v_subrev_u32 v6, 18, v242
    v_cmp_gt_u32 vcc, 256, v6
    s_nop 1
    v_cndmask_b32 v222, v243, 0, vcc
    v_subrev_u32 v6, 19, v242
    v_cmp_gt_u32 vcc, 256, v6
    s_nop 1
    v_cndmask_b32 v223, v243, 0, vcc
    v_subrev_u32 v6, 256, v242
    v_cmp_gt_u32 vcc, 256, v6
    s_nop 1
    v_cndmask_b32 v224, v243, 0, vcc
    v_subrev_u32 v6, 257, v242
    v_cmp_gt_u32 vcc, 256, v6
    s_nop 1
    v_cndmask_b32 v225, v243, 0, vcc
    v_subrev_u32 v6, 258, v242
    v_cmp_gt_u32 vcc, 256, v6
    s_nop 1
    v_cndmask_b32 v226, v243, 0, vcc
    v_subrev_u32 v6, 259, v242
    v_cmp_gt_u32 vcc, 256, v6
    s_nop 1
    v_cndmask_b32 v227, v243, 0, vcc
    v_subrev_u32 v6, 272, v242
    v_cmp_gt_u32 vcc, 256, v6
    s_nop 1
    v_cndmask_b32 v228, v243, 0, vcc
    v_subrev_u32 v6, 273, v242
    v_cmp_gt_u32 vcc, 256, v6
    s_nop 1
    v_cndmask_b32 v229, v243, 0, vcc
    v_subrev_u32 v6, 274, v242
    v_cmp_gt_u32 vcc, 256, v6
    s_nop 1
    v_cndmask_b32 v230, v243, 0, vcc
    v_subrev_u32 v6, 275, v242
    v_cmp_gt_u32 vcc, 256, v6
    s_nop 1
    v_cndmask_b32 v231, v243, 0, vcc
    s_cmp_gt_i32 s59, 0
    s_cbranch_scc0 Lb_41
    v_mov_b32 v216, v243
    v_mov_b32 v217, v243
    v_mov_b32 v218, v243
    v_mov_b32 v219, v243
Lb_41:
    s_cmp_gt_i32 s59, 1
    s_cbranch_scc0 Lb_42
    v_mov_b32 v220, v243
    v_mov_b32 v221, v243
    v_mov_b32 v222, v243
    v_mov_b32 v223, v243
Lb_42:
    s_nop 1
    ds_read_b128 v[208:211], v240 offset:2048
    s_waitcnt lgkmcnt(2)
    v_mfma_f32_16x16x32_bf16 v[80:83], v[200:203], v[184:187], v[216:219]
    ds_read_b128 v[212:215], v240 offset:3072
    s_waitcnt lgkmcnt(2)
    v_mfma_f32_16x16x32_bf16 v[84:87], v[204:207], v[184:187], v[220:223]
    ds_read_b128 v[200:203], v240 offset:4096
    s_waitcnt lgkmcnt(2)
    v_mfma_f32_16x16x32_bf16 v[88:91], v[208:211], v[184:187], 0
    ds_read_b128 v[204:207], v240 offset:5120
    s_waitcnt lgkmcnt(2)
    v_mfma_f32_16x16x32_bf16 v[92:95], v[212:215], v[184:187], 0
    ds_read_b128 v[208:211], v240 offset:6144
    s_waitcnt lgkmcnt(2)
    v_mfma_f32_16x16x32_bf16 v[96:99], v[200:203], v[184:187], 0
    ds_read_b128 v[212:215], v240 offset:7168
    s_waitcnt lgkmcnt(2)
    v_mfma_f32_16x16x32_bf16 v[100:103], v[204:207], v[184:187], 0
    ds_read_b128 v[200:203], v240 offset:8192
    s_waitcnt lgkmcnt(2)
    v_mfma_f32_16x16x32_bf16 v[104:107], v[208:211], v[184:187], 0
    ds_read_b128 v[204:207], v240 offset:9216
    s_waitcnt lgkmcnt(2)
    v_mfma_f32_16x16x32_bf16 v[108:111], v[212:215], v[184:187], 0
    ds_read_b128 v[208:211], v240 offset:10240
    s_waitcnt lgkmcnt(2)
    v_mfma_f32_16x16x32_bf16 v[112:115], v[200:203], v[184:187], 0
    ds_read_b128 v[212:215], v240 offset:11264
    s_waitcnt lgkmcnt(2)
    v_mfma_f32_16x16x32_bf16 v[116:119], v[204:207], v[184:187], 0
    ds_read_b128 v[200:203], v240 offset:12288
    s_waitcnt lgkmcnt(2)
    v_mfma_f32_16x16x32_bf16 v[120:123], v[208:211], v[184:187], 0
    ds_read_b128 v[204:207], v240 offset:13312
    s_waitcnt lgkmcnt(2)
    v_mfma_f32_16x16x32_bf16 v[124:127], v[212:215], v[184:187], 0
    ds_read_b128 v[208:211], v240 offset:14336
    s_waitcnt lgkmcnt(2)
    v_mfma_f32_16x16x32_bf16 v[128:131], v[200:203], v[184:187], 0
    ds_read_b128 v[212:215], v240 offset:15360
    s_waitcnt lgkmcnt(2)
    v_mfma_f32_16x16x32_bf16 v[132:135], v[204:207], v[184:187], 0
    ds_read_b128 v[200:203], v240 offset:16384
    s_waitcnt lgkmcnt(2)
    v_mfma_f32_16x16x32_bf16 v[136:139], v[208:211], v[184:187], 0
    ds_read_b128 v[204:207], v240 offset:17408
    s_waitcnt lgkmcnt(2)
    v_mfma_f32_16x16x32_bf16 v[140:143], v[212:215], v[184:187], 0
    s_waitcnt lgkmcnt(1)
    v_mfma_f32_16x16x32_bf16 v[144:147], v[200:203], v[184:187], v[224:227]
    s_waitcnt lgkmcnt(0)
    v_mfma_f32_16x16x32_bf16 v[148:151], v[204:207], v[184:187], v[228:231]
    ds_read_b128 v[152:155], v241 offset:0
    ds_read_b128 v[156:159], v241 offset:512
    s_waitcnt vmcnt(0)
    s_barrier
    s_lshl_b32 s37, s24, 7
    s_lshl_b32 s38, s25, 2
    s_add_u32 s37, s37, s38
    s_add_u32 s37, s37, 0x1484000
    s_cmp_lg_u32 s3, 0
    s_cbranch_scc1 Lpub_43
    v_mov_b32 v6, s29
    v_mov_b32 v7, 0
    s_mov_b64 exec, 1
    buffer_store_dword v6, v7, s[12:15], s37 offen sc1
    s_mov_b64 exec, -1
Lpub_43:
    s_cmp_le_i32 s59, 2
    s_cbranch_scc1 Lnofix_44
    s_nop 7
    s_cmp_gt_i32 s59, 2
    s_cbranch_scc0 Lf_45
    v_mov_b32 v88, v243
    v_mov_b32 v89, v243
    v_mov_b32 v90, v243
    v_mov_b32 v91, v243
Lf_45:
    s_cmp_gt_i32 s59, 3
    s_cbranch_scc0 Lf_46
    v_mov_b32 v92, v243
    v_mov_b32 v93, v243
    v_mov_b32 v94, v243
    v_mov_b32 v95, v243
Lf_46:
    s_cmp_gt_i32 s59, 4
    s_cbranch_scc0 Lf_47
    v_mov_b32 v96, v243
    v_mov_b32 v97, v243
    v_mov_b32 v98, v243
    v_mov_b32 v99, v243
Lf_47:
    s_cmp_gt_i32 s59, 5
    s_cbranch_scc0 Lf_48
    v_mov_b32 v100, v243
    v_mov_b32 v101, v243
    v_mov_b32 v102, v243
    v_mov_b32 v103, v243
Lf_48:
    s_cmp_gt_i32 s59, 6
    s_cbranch_scc0 Lf_49
    v_mov_b32 v104, v243
    v_mov_b32 v105, v243
    v_mov_b32 v106, v243
    v_mov_b32 v107, v243
Lf_49:
    s_cmp_gt_i32 s59, 7
    s_cbranch_scc0 Lf_50
    v_mov_b32 v108, v243
    v_mov_b32 v109, v243
    v_mov_b32 v110, v243
    v_mov_b32 v111, v243
Lf_50:
    s_cmp_gt_i32 s59, 8
    s_cbranch_scc0 Lf_51
    v_mov_b32 v112, v243
    v_mov_b32 v113, v243
    v_mov_b32 v114, v243
    v_mov_b32 v115, v243
Lf_51:
    s_cmp_gt_i32 s59, 9
    s_cbranch_scc0 Lf_52
    v_mov_b32 v116, v243
    v_mov_b32 v117, v243
    v_mov_b32 v118, v243
    v_mov_b32 v119, v243
Lf_52:
    s_cmp_gt_i32 s59, 10
    s_cbranch_scc0 Lf_53
    v_mov_b32 v120, v243
    v_mov_b32 v121, v243
    v_mov_b32 v122, v243
    v_mov_b32 v123, v243
Lf_53:
    s_cmp_gt_i32 s59, 11
    s_cbranch_scc0 Lf_54
    v_mov_b32 v124, v243
    v_mov_b32 v125, v243
    v_mov_b32 v126, v243
    v_mov_b32 v127, v243
Lf_54:
    s_cmp_gt_i32 s59, 12
    s_cbranch_scc0 Lf_55
    v_mov_b32 v128, v243
    v_mov_b32 v129, v243
    v_mov_b32 v130, v243
    v_mov_b32 v131, v243
Lf_55:
    s_cmp_gt_i32 s59, 13
    s_cbranch_scc0 Lf_56
    v_mov_b32 v132, v243
    v_mov_b32 v133, v243
    v_mov_b32 v134, v243
    v_mov_b32 v135, v243
Lf_56:
    s_cmp_gt_i32 s59, 14
    s_cbranch_scc0 Lf_57
    v_mov_b32 v136, v243
    v_mov_b32 v137, v243
    v_mov_b32 v138, v243
    v_mov_b32 v139, v243
Lf_57:
    s_cmp_gt_i32 s59, 15
    s_cbranch_scc0 Lf_58
    v_mov_b32 v140, v243
    v_mov_b32 v141, v243
    v_mov_b32 v142, v243
    v_mov_b32 v143, v243
Lf_58:
Lnofix_44:
    s_nop 7
    v_max3_f32 v244, v80, v81, v82
    v_max3_f32 v245, v83, v84, v85
    v_max3_f32 v244, v244, v86, v87
    v_max3_f32 v245, v245, v88, v89
    v_max3_f32 v244, v244, v90, v91
    v_max3_f32 v245, v245, v92, v93
    v_max3_f32 v244, v244, v94, v95
    v_max3_f32 v245, v245, v96, v97
    v_max3_f32 v244, v244, v98, v99
    v_max3_f32 v245, v245, v100, v101
    v_max3_f32 v244, v244, v102, v103
    v_max3_f32 v245, v245, v104, v105
    v_max3_f32 v244, v244, v106, v107
    v_max3_f32 v245, v245, v108, v109
    v_max3_f32 v244, v244, v110, v111
    v_max3_f32 v245, v245, v112, v113
    v_max3_f32 v244, v244, v114, v115
    v_max3_f32 v245, v245, v116, v117
    v_max3_f32 v244, v244, v118, v119
    v_max3_f32 v245, v245, v120, v121
    v_max3_f32 v244, v244, v122, v123
    v_max3_f32 v245, v245, v124, v125
    v_max3_f32 v244, v244, v126, v127
    v_max3_f32 v245, v245, v128, v129
    v_max3_f32 v244, v244, v130, v131
    v_max3_f32 v245, v245, v132, v133
    v_max3_f32 v244, v244, v134, v135
    v_max3_f32 v245, v245, v136, v137
    v_max3_f32 v244, v244, v138, v139
    v_max3_f32 v245, v245, v140, v141
    v_max3_f32 v244, v244, v142, v143
    v_max3_f32 v245, v245, v144, v145
    v_max3_f32 v244, v244, v146, v147
    v_max3_f32 v245, v245, v148, v149
    v_max3_f32 v244, v244, v150, v151
    v_max_f32 v244, v244, v245
    v_mov_b32 v6, v244
    s_nop 1
    v_permlane32_swap_b32 v244, v6
    s_nop 1
    v_max_f32 v244, v244, v6
    v_mov_b32 v6, v244
    s_nop 1
    v_permlane16_swap_b32 v244, v6
    s_nop 1
    v_max_f32 v244, v244, v6
    s_mov_b32 s60, 0x3e8b97f6
    v_mul_f32 v244, 0xbe8b97f6, v244
    s_waitcnt lgkmcnt(0)
    v_fma_f32 v80, v80, s60, v244
    v_fma_f32 v81, v81, s60, v244
    v_fma_f32 v82, v82, s60, v244
    v_fma_f32 v83, v83, s60, v244
    v_fma_f32 v84, v84, s60, v244
    v_fma_f32 v85, v85, s60, v244
    v_fma_f32 v86, v86, s60, v244
    v_fma_f32 v87, v87, s60, v244
    v_exp_f32 v80, v80
    v_exp_f32 v81, v81
    v_exp_f32 v82, v82
    v_exp_f32 v83, v83
    v_exp_f32 v84, v84
    v_exp_f32 v85, v85
    v_exp_f32 v86, v86
    v_exp_f32 v87, v87
    s_nop 0
    v_cvt_pk_bf16_f32 v80, v80, v81
    v_cvt_pk_bf16_f32 v81, v82, v83
    v_cvt_pk_bf16_f32 v82, v84, v85
    v_cvt_pk_bf16_f32 v83, v86, v87
    s_nop 1
    v_permlane32_swap_b32 v80, v82
    v_permlane32_swap_b32 v81, v83
    s_nop 1
    v_permlane16_swap_b32 v80, v82
    v_permlane16_swap_b32 v81, v83
    s_nop 1
    v_mfma_f32_16x16x32_bf16 v[216:219], v[152:155], v[80:83], 0
    v_mfma_f32_16x16x32_bf16 v[220:223], v[156:159], v[80:83], 0
    v_mfma_f32_16x16x32_bf16 v[236:239], v[232:235], v[80:83], 0
    ds_read_b128 v[160:163], v241 offset:2048
    ds_read_b128 v[164:167], v241 offset:2560
    v_fma_f32 v88, v88, s60, v244
    v_fma_f32 v89, v89, s60, v244
    v_fma_f32 v90, v90, s60, v244
    v_fma_f32 v91, v91, s60, v244
    v_fma_f32 v92, v92, s60, v244
    v_fma_f32 v93, v93, s60, v244
    v_fma_f32 v94, v94, s60, v244
    v_fma_f32 v95, v95, s60, v244
    v_exp_f32 v88, v88
    v_exp_f32 v89, v89
    v_exp_f32 v90, v90
    v_exp_f32 v91, v91
    v_exp_f32 v92, v92
    v_exp_f32 v93, v93
    v_exp_f32 v94, v94
    v_exp_f32 v95, v95
    s_nop 0
    v_cvt_pk_bf16_f32 v88, v88, v89
    v_cvt_pk_bf16_f32 v89, v90, v91
    v_cvt_pk_bf16_f32 v90, v92, v93
    v_cvt_pk_bf16_f32 v91, v94, v95
    s_nop 1
    v_permlane32_swap_b32 v88, v90
    v_permlane32_swap_b32 v89, v91
    s_nop 1
    v_permlane16_swap_b32 v88, v90
    v_permlane16_swap_b32 v89, v91
    s_waitcnt lgkmcnt(0)
    s_nop 1
    v_mfma_f32_16x16x32_bf16 v[216:219], v[160:163], v[88:91], v[216:219]
    v_mfma_f32_16x16x32_bf16 v[220:223], v[164:167], v[88:91], v[220:223]
    v_mfma_f32_16x16x32_bf16 v[236:239], v[232:235], v[88:91], v[236:239]
    ds_read_b128 v[152:155], v241 offset:4096
    ds_read_b128 v[156:159], v241 offset:4608
    s_waitcnt lgkmcnt(0)
    s_cmp_lg_u32 s3, 0
    s_cbranch_scc1 Lps_59
    s_mov_b32 exec_lo, 0x3fff
    s_mov_b32 exec_hi, 0x0
    s_mov_b32 s63, 0
Lpl_60:
    buffer_load_dword v6, v197, s[12:15], 0 offen sc1
    s_waitcnt vmcnt(0)
    v_cmp_ne_u32 vcc, s29, v6
    s_nop 1
    s_cbranch_vccz Lpd_61
    s_sleep 4
    s_add_u32 s63, s63, 1
    s_cmp_lt_u32 s63, 200000
    s_cbranch_scc1 Lpl_60
    v_mov_b32 v6, 5
    v_mov_b32 v7, 4
    buffer_store_dword v6, v7, s[16:19], 0 offen
Lpd_61:
    s_mov_b64 exec, -1
Lps_59:
    s_barrier
    s_add_u32 s44, s47, 49152
    s_mov_b32 m0, s44
    s_mov_b32 s45, 0xc00000
    buffer_load_dwordx4 v177, s[12:15], s45 offen sc1 lds
    s_add_u32 s44, s47, 65536
    s_mov_b32 m0, s44
    s_mov_b32 s45, 0xc00800
    buffer_load_dwordx4 v177, s[12:15], s45 offen sc1 lds
    s_add_u32 s44, s47, 81920
    s_mov_b32 m0, s44
    s_mov_b32 s45, 0xc01000
    buffer_load_dwordx4 v177, s[12:15], s45 offen sc1 lds
    s_add_u32 s44, s47, 98304
    s_mov_b32 m0, s44
    s_mov_b32 s45, 0xc01800
    buffer_load_dwordx4 v177, s[12:15], s45 offen sc1 lds
    s_add_u32 s44, s47, 114688
    s_mov_b32 m0, s44
    s_mov_b32 s45, 0xc02000
    buffer_load_dwordx4 v177, s[12:15], s45 offen sc1 lds
    s_add_u32 s44, s47, 131072
    s_mov_b32 m0, s44
    s_mov_b32 s45, 0xc02800
    buffer_load_dwordx4 v177, s[12:15], s45 offen sc1 lds
    s_add_u32 s38, s48, 0x1483000
    v_lshl_add_u32 v197, v1, 2, s38
    v_fma_f32 v96, v96, s60, v244
    v_fma_f32 v97, v97, s60, v244
    v_fma_f32 v98, v98, s60, v244
    v_fma_f32 v99, v99, s60, v244
    v_fma_f32 v100, v100, s60, v244
    v_fma_f32 v101, v101, s60, v244
    v_fma_f32 v102, v102, s60, v244
    v_fma_f32 v103, v103, s60, v244
    v_exp_f32 v96, v96
    v_exp_f32 v97, v97
    v_exp_f32 v98, v98
    v_exp_f32 v99, v99
    v_exp_f32 v100, v100
    v_exp_f32 v101, v101
    v_exp_f32 v102, v102
    v_exp_f32 v103, v103
    s_nop 0
    v_cvt_pk_bf16_f32 v96, v96, v97
    v_cvt_pk_bf16_f32 v97, v98, v99
    v_cvt_pk_bf16_f32 v98, v100, v101
    v_cvt_pk_bf16_f32 v99, v102, v103
    s_nop 1
    v_permlane32_swap_b32 v96, v98
    v_permlane32_swap_b32 v97, v99
    s_nop 1
    v_permlane16_swap_b32 v96, v98
    v_permlane16_swap_b32 v97, v99
    s_nop 1
    v_mfma_f32_16x16x32_bf16 v[216:219], v[152:155], v[96:99], v[216:219]
    v_mfma_f32_16x16x32_bf16 v[220:223], v[156:159], v[96:99], v[220:223]
    v_mfma_f32_16x16x32_bf16 v[236:239], v[232:235], v[96:99], v[236:239]
    ds_read_b128 v[160:163], v241 offset:6144
    ds_read_b128 v[164:167], v241 offset:6656
    s_waitcnt lgkmcnt(0)
    v_fma_f32 v104, v104, s60, v244
    v_fma_f32 v105, v105, s60, v244
    v_fma_f32 v106, v106, s60, v244
    v_fma_f32 v107, v107, s60, v244
    v_fma_f32 v108, v108, s60, v244
    v_fma_f32 v109, v109, s60, v244
    v_fma_f32 v110, v110, s60, v244
    v_fma_f32 v111, v111, s60, v244
    v_exp_f32 v104, v104
    v_exp_f32 v105, v105
    v_exp_f32 v106, v106
    v_exp_f32 v107, v107
    v_exp_f32 v108, v108
    v_exp_f32 v109, v109
    v_exp_f32 v110, v110
    v_exp_f32 v111, v111
    s_nop 0
    v_cvt_pk_bf16_f32 v104, v104, v105
    v_cvt_pk_bf16_f32 v105, v106, v107
    v_cvt_pk_bf16_f32 v106, v108, v109
    v_cvt_pk_bf16_f32 v107, v110, v111
    s_nop 1
    v_permlane32_swap_b32 v104, v106
    v_permlane32_swap_b32 v105, v107
    s_nop 1
    v_permlane16_swap_b32 v104, v106
    v_permlane16_swap_b32 v105, v107
    s_nop 1
    v_mfma_f32_16x16x32_bf16 v[216:219], v[160:163], v[104:107], v[216:219]
    v_mfma_f32_16x16x32_bf16 v[220:223], v[164:167], v[104:107], v[220:223]
    v_mfma_f32_16x16x32_bf16 v[236:239], v[232:235], v[104:107], v[236:239]
    ds_read_b128 v[152:155], v241 offset:8192
    ds_read_b128 v[156:159], v241 offset:8704
    s_waitcnt lgkmcnt(0)
    s_waitcnt vmcnt(5)
    s_barrier
    s_add_u32 s44, s47, 147456
    s_mov_b32 m0, s44
    s_mov_b32 s45, 0xc03000
    buffer_load_dwordx4 v177, s[12:15], s45 offen sc1 lds
    ds_read_b128 v[48:51], v168 offset:49152
    ds_read_b64_tr_b16 v[16:17], v171 offset:49152
    ds_read_b64_tr_b16 v[18:19], v171 offset:51200
    ds_read_b64_tr_b16 v[20:21], v172 offset:49152
    ds_read_b64_tr_b16 v[22:23], v172 offset:51200
    ds_read_b128 v[52:55], v168 offset:53248
    ds_read_b64_tr_b16 v[24:25], v171 offset:53248
    ds_read_b64_tr_b16 v[26:27], v171 offset:55296
    ds_read_b64_tr_b16 v[28:29], v172 offset:53248
    ds_read_b64_tr_b16 v[30:31], v172 offset:55296
    v_fma_f32 v112, v112, s60, v244
    v_fma_f32 v113, v113, s60, v244
    v_fma_f32 v114, v114, s60, v244
    v_fma_f32 v115, v115, s60, v244
    v_fma_f32 v116, v116, s60, v244
    v_fma_f32 v117, v117, s60, v244
    v_fma_f32 v118, v118, s60, v244
    v_fma_f32 v119, v119, s60, v244
    v_exp_f32 v112, v112
    v_exp_f32 v113, v113
    v_exp_f32 v114, v114
    v_exp_f32 v115, v115
    v_exp_f32 v116, v116
    v_exp_f32 v117, v117
    v_exp_f32 v118, v118
    v_exp_f32 v119, v119
    s_nop 0
    v_cvt_pk_bf16_f32 v112, v112, v113
    v_cvt_pk_bf16_f32 v113, v114, v115
    v_cvt_pk_bf16_f32 v114, v116, v117
    v_cvt_pk_bf16_f32 v115, v118, v119
    s_nop 1
    v_permlane32_swap_b32 v112, v114
    v_permlane32_swap_b32 v113, v115
    s_nop 1
    v_permlane16_swap_b32 v112, v114
    v_permlane16_swap_b32 v113, v115
    s_nop 1
    v_mfma_f32_16x16x32_bf16 v[216:219], v[152:155], v[112:115], v[216:219]
    v_mfma_f32_16x16x32_bf16 v[220:223], v[156:159], v[112:115], v[220:223]
    v_mfma_f32_16x16x32_bf16 v[236:239], v[232:235], v[112:115], v[236:239]
    ds_read_b128 v[160:163], v241 offset:10240
    ds_read_b128 v[164:167], v241 offset:10752
    s_waitcnt lgkmcnt(0)
    s_waitcnt vmcnt(5)
    s_barrier
    s_add_u32 s44, s47, 49152
    s_mov_b32 m0, s44
    s_mov_b32 s45, 0xc03800
    buffer_load_dwordx4 v177, s[12:15], s45 offen sc1 lds
    s_add_u32 s44, s47, 57344
    s_mov_b32 m0, s44
    s_mov_b32 s45, 401408
    buffer_load_dwordx4 v194, s[20:23], s45 offen lds
    ds_read_b128 v[56:59], v169 offset:0
    ds_read_b64_tr_b16 v[32:33], v173 offset:0
    ds_read_b64_tr_b16 v[34:35], v173 offset:2048
    v_mfma_f32_16x16x32_bf16 v[72:75], v[16:19], v[48:51], 0
    ds_read_b64_tr_b16 v[36:37], v174 offset:0
    ds_read_b64_tr_b16 v[38:39], v174 offset:2048
    v_mfma_f32_16x16x32_bf16 v[76:79], v[20:23], v[48:51], 0
    ds_read_b128 v[60:63], v169 offset:4096
    ds_read_b64_tr_b16 v[40:41], v173 offset:4096
    ds_read_b64_tr_b16 v[42:43], v173 offset:6144
    v_mfma_f32_16x16x32_bf16 v[72:75], v[24:27], v[52:55], v[72:75]
    ds_read_b64_tr_b16 v[44:45], v174 offset:4096
    ds_read_b64_tr_b16 v[46:47], v174 offset:6144
    v_mfma_f32_16x16x32_bf16 v[76:79], v[28:31], v[52:55], v[76:79]
    v_fma_f32 v120, v120, s60, v244
    v_fma_f32 v121, v121, s60, v244
    v_fma_f32 v122, v122, s60, v244
    v_fma_f32 v123, v123, s60, v244
    v_fma_f32 v124, v124, s60, v244
    v_fma_f32 v125, v125, s60, v244
    v_fma_f32 v126, v126, s60, v244
    v_fma_f32 v127, v127, s60, v244
    v_exp_f32 v120, v120
    v_exp_f32 v121, v121
    v_exp_f32 v122, v122
    v_exp_f32 v123, v123
    v_exp_f32 v124, v124
    v_exp_f32 v125, v125
    v_exp_f32 v126, v126
    v_exp_f32 v127, v127
    s_nop 0
    v_cvt_pk_bf16_f32 v120, v120, v121
    v_cvt_pk_bf16_f32 v121, v122, v123
    v_cvt_pk_bf16_f32 v122, v124, v125
    v_cvt_pk_bf16_f32 v123, v126, v127
    s_nop 1
    v_permlane32_swap_b32 v120, v122
    v_permlane32_swap_b32 v121, v123
    s_nop 1
    v_permlane16_swap_b32 v120, v122
    v_permlane16_swap_b32 v121, v123
    s_nop 1
    v_mfma_f32_16x16x32_bf16 v[216:219], v[160:163], v[120:123], v[216:219]
    v_mfma_f32_16x16x32_bf16 v[220:223], v[164:167], v[120:123], v[220:223]
    v_mfma_f32_16x16x32_bf16 v[236:239], v[232:235], v[120:123], v[236:239]
    ds_read_b128 v[152:155], v241 offset:12288
    ds_read_b128 v[156:159], v241 offset:12800
    s_waitcnt lgkmcnt(0)
    s_waitcnt vmcnt(6)
    s_barrier
    s_add_u32 s44, s47, 65536
    s_mov_b32 m0, s44
    s_mov_b32 s45, 0xc04000
    buffer_load_dwordx4 v177, s[12:15], s45 offen sc1 lds
    s_add_u32 s44, s47, 73728
    s_mov_b32 m0, s44
    s_mov_b32 s45, 458752
    buffer_load_dwordx4 v194, s[20:23], s45 offen lds
    ds_read_b128 v[48:51], v169 offset:16384
    ds_read_b64_tr_b16 v[16:17], v173 offset:16384
    ds_read_b64_tr_b16 v[18:19], v173 offset:18432
    v_mfma_f32_16x16x32_bf16 v[72:75], v[32:35], v[56:59], v[72:75]
    ds_read_b64_tr_b16 v[20:21], v174 offset:16384
    ds_read_b64_tr_b16 v[22:23], v174 offset:18432
    v_mfma_f32_16x16x32_bf16 v[76:79], v[36:39], v[56:59], v[76:79]
    ds_read_b128 v[52:55], v169 offset:20480
    ds_read_b64_tr_b16 v[24:25], v173 offset:20480
    ds_read_b64_tr_b16 v[26:27], v173 offset:22528
    v_mfma_f32_16x16x32_bf16 v[72:75], v[40:43], v[60:63], v[72:75]
    ds_read_b64_tr_b16 v[28:29], v174 offset:20480
    ds_read_b64_tr_b16 v[30:31], v174 offset:22528
    v_mfma_f32_16x16x32_bf16 v[76:79], v[44:47], v[60:63], v[76:79]
    v_fma_f32 v128, v128, s60, v244
    v_fma_f32 v129, v129, s60, v244
    v_fma_f32 v130, v130, s60, v244
    v_fma_f32 v131, v131, s60, v244
    v_fma_f32 v132, v132, s60, v244
    v_fma_f32 v133, v133, s60, v244
    v_fma_f32 v134, v134, s60, v244
    v_fma_f32 v135, v135, s60, v244
    v_exp_f32 v128, v128
    v_exp_f32 v129, v129
    v_exp_f32 v130, v130
    v_exp_f32 v131, v131
    v_exp_f32 v132, v132
    v_exp_f32 v133, v133
    v_exp_f32 v134, v134
    v_exp_f32 v135, v135
    s_nop 0
    v_cvt_pk_bf16_f32 v128, v128, v129
    v_cvt_pk_bf16_f32 v129, v130, v131
    v_cvt_pk_bf16_f32 v130, v132, v133
    v_cvt_pk_bf16_f32 v131, v134, v135
    s_nop 1
    v_permlane32_swap_b32 v128, v130
    v_permlane32_swap_b32 v129, v131
    s_nop 1
    v_permlane16_swap_b32 v128, v130
    v_permlane16_swap_b32 v129, v131
    s_nop 1
    v_mfma_f32_16x16x32_bf16 v[216:219], v[152:155], v[128:131], v[216:219]
    v_mfma_f32_16x16x32_bf16 v[220:223], v[156:159], v[128:131], v[220:223]
    v_mfma_f32_16x16x32_bf16 v[236:239], v[232:235], v[128:131], v[236:239]
    ds_read_b128 v[160:163], v241 offset:14336
    ds_read_b128 v[164:167], v241 offset:14848
    s_waitcnt lgkmcnt(0)
    s_waitcnt vmcnt(7)
    s_barrier
    s_add_u32 s44, s47, 81920
    s_mov_b32 m0, s44
    s_mov_b32 s45, 0xc04800
    buffer_load_dwordx4 v177, s[12:15], s45 offen sc1 lds
    s_add_u32 s44, s47, 90112
    s_mov_b32 m0, s44
    s_mov_b32 s45, 516096
    buffer_load_dwordx4 v194, s[20:23], s45 offen lds
    ds_read_b128 v[56:59], v169 offset:32768
    ds_read_b64_tr_b16 v[32:33], v173 offset:32768
    ds_read_b64_tr_b16 v[34:35], v173 offset:34816
    v_mfma_f32_16x16x32_bf16 v[72:75], v[16:19], v[48:51], v[72:75]
    ds_read_b64_tr_b16 v[36:37], v174 offset:32768
    ds_read_b64_tr_b16 v[38:39], v174 offset:34816
    v_mfma_f32_16x16x32_bf16 v[76:79], v[20:23], v[48:51], v[76:79]
    ds_read_b128 v[60:63], v169 offset:36864
    ds_read_b64_tr_b16 v[40:41], v173 offset:36864
    ds_read_b64_tr_b16 v[42:43], v173 offset:38912
    v_mfma_f32_16x16x32_bf16 v[72:75], v[24:27], v[52:55], v[72:75]
    ds_read_b64_tr_b16 v[44:45], v174 offset:36864
    ds_read_b64_tr_b16 v[46:47], v174 offset:38912
    v_mfma_f32_16x16x32_bf16 v[76:79], v[28:31], v[52:55], v[76:79]
    v_fma_f32 v136, v136, s60, v244
    v_fma_f32 v137, v137, s60, v244
    v_fma_f32 v138, v138, s60, v244
    v_fma_f32 v139, v139, s60, v244
    v_fma_f32 v140, v140, s60, v244
    v_fma_f32 v141, v141, s60, v244
    v_fma_f32 v142, v142, s60, v244
    v_fma_f32 v143, v143, s60, v244
    v_exp_f32 v136, v136
    v_exp_f32 v137, v137
    v_exp_f32 v138, v138
    v_exp_f32 v139, v139
    v_exp_f32 v140, v140
    v_exp_f32 v141, v141
    v_exp_f32 v142, v142
    v_exp_f32 v143, v143
    s_nop 0
    v_cvt_pk_bf16_f32 v136, v136, v137
    v_cvt_pk_bf16_f32 v137, v138, v139
    v_cvt_pk_bf16_f32 v138, v140, v141
    v_cvt_pk_bf16_f32 v139, v142, v143
    s_nop 1
    v_permlane32_swap_b32 v136, v138
    v_permlane32_swap_b32 v137, v139
    s_nop 1
    v_permlane16_swap_b32 v136, v138
    v_permlane16_swap_b32 v137, v139
    s_nop 1
    v_mfma_f32_16x16x32_bf16 v[216:219], v[160:163], v[136:139], v[216:219]
    v_mfma_f32_16x16x32_bf16 v[220:223], v[164:167], v[136:139], v[220:223]
    v_mfma_f32_16x16x32_bf16 v[236:239], v[232:235], v[136:139], v[236:239]
    ds_read_b128 v[152:155], v241 offset:16384
    ds_read_b128 v[156:159], v241 offset:16896
    s_waitcnt lgkmcnt(0)
    s_waitcnt vmcnt(8)
    s_barrier
    s_add_u32 s44, s47, 98304
    s_mov_b32 m0, s44
    s_mov_b32 s45, 0xc05000
    buffer_load_dwordx4 v177, s[12:15], s45 offen sc1 lds
    s_add_u32 s44, s47, 106496
    s_mov_b32 m0, s44
    s_mov_b32 s45, 573440
    buffer_load_dwordx4 v194, s[20:23], s45 offen lds
    ds_read_b128 v[48:51], v169 offset:49152
    ds_read_b64_tr_b16 v[16:17], v173 offset:49152
    ds_read_b64_tr_b16 v[18:19], v173 offset:51200
    v_mfma_f32_16x16x32_bf16 v[72:75], v[32:35], v[56:59], v[72:75]
    ds_read_b64_tr_b16 v[20:21], v174 offset:49152
    ds_read_b64_tr_b16 v[22:23], v174 offset:51200
    v_mfma_f32_16x16x32_bf16 v[76:79], v[36:39], v[56:59], v[76:79]
    ds_read_b128 v[52:55], v169 offset:53248
    ds_read_b64_tr_b16 v[24:25], v173 offset:53248
    ds_read_b64_tr_b16 v[26:27], v173 offset:55296
    v_mfma_f32_16x16x32_bf16 v[72:75], v[40:43], v[60:63], v[72:75]
    ds_read_b64_tr_b16 v[28:29], v174 offset:53248
    ds_read_b64_tr_b16 v[30:31], v174 offset:55296
    v_mfma_f32_16x16x32_bf16 v[76:79], v[44:47], v[60:63], v[76:79]
    v_fma_f32 v144, v144, s60, v244
    v_fma_f32 v145, v145, s60, v244
    v_fma_f32 v146, v146, s60, v244
    v_fma_f32 v147, v147, s60, v244
    v_fma_f32 v148, v148, s60, v244
    v_fma_f32 v149, v149, s60, v244
    v_fma_f32 v150, v150, s60, v244
    v_fma_f32 v151, v151, s60, v244
    v_exp_f32 v144, v144
    v_exp_f32 v145, v145
    v_exp_f32 v146, v146
    v_exp_f32 v147, v147
    v_exp_f32 v148, v148
    v_exp_f32 v149, v149
    v_exp_f32 v150, v150
    v_exp_f32 v151, v151
    s_nop 0
    v_cvt_pk_bf16_f32 v144, v144, v145
    v_cvt_pk_bf16_f32 v145, v146, v147
    v_cvt_pk_bf16_f32 v146, v148, v149
    v_cvt_pk_bf16_f32 v147, v150, v151
    s_nop 1
    v_permlane32_swap_b32 v144, v146
    v_permlane32_swap_b32 v145, v147
    s_nop 1
    v_permlane16_swap_b32 v144, v146
    v_permlane16_swap_b32 v145, v147
    s_nop 1
    v_mfma_f32_16x16x32_bf16 v[216:219], v[152:155], v[144:147], v[216:219]
    v_mfma_f32_16x16x32_bf16 v[220:223], v[156:159], v[144:147], v[220:223]
    v_mfma_f32_16x16x32_bf16 v[236:239], v[232:235], v[144:147], v[236:239]
    s_waitcnt lgkmcnt(0)
    s_waitcnt vmcnt(9)
    s_barrier
    s_add_u32 s44, s47, 114688
    s_mov_b32 m0, s44
    s_mov_b32 s45, 0xc05800
    buffer_load_dwordx4 v177, s[12:15], s45 offen sc1 lds
    s_add_u32 s44, s47, 122880
    s_mov_b32 m0, s44
    s_mov_b32 s45, 630784
    buffer_load_dwordx4 v194, s[20:23], s45 offen lds
    ds_read_b128 v[56:59], v170 offset:0
    ds_read_b64_tr_b16 v[32:33], v175 offset:0
    ds_read_b64_tr_b16 v[34:35], v175 offset:2048
    v_mfma_f32_16x16x32_bf16 v[72:75], v[16:19], v[48:51], v[72:75]
    ds_read_b64_tr_b16 v[36:37], v176 offset:0
    ds_read_b64_tr_b16 v[38:39], v176 offset:2048
    v_mfma_f32_16x16x32_bf16 v[76:79], v[20:23], v[48:51], v[76:79]
    ds_read_b128 v[60:63], v170 offset:4096
    ds_read_b64_tr_b16 v[40:41], v175 offset:4096
    ds_read_b64_tr_b16 v[42:43], v175 offset:6144
    v_mfma_f32_16x16x32_bf16 v[72:75], v[24:27], v[52:55], v[72:75]
    ds_read_b64_tr_b16 v[44:45], v176 offset:4096
    ds_read_b64_tr_b16 v[46:47], v176 offset:6144
    v_mfma_f32_16x16x32_bf16 v[76:79], v[28:31], v[52:55], v[76:79]
    s_mul_i32 s41, s58, 14336
    s_add_u32 s41, s41, 0x800000
    s_mul_i32 s42, s28, 7
    v_add_u32 v6, s42, v3
    v_lshrrev_b32 v7, 1, v6
    v_lshlrev_b32 v10, 8, v7
    v_and_b32 v7, 1, v6
    v_lshl_add_u32 v10, v7, 3, v10
    v_lshl_add_u32 v10, v2, 4, v10
    v_add_u32 v6, s42, v3
    v_add_u32 v6, 4, v6
    v_lshrrev_b32 v7, 1, v6
    v_lshlrev_b32 v11, 8, v7
    v_and_b32 v7, 1, v6
    v_lshl_add_u32 v11, v7, 3, v11
    v_lshl_add_u32 v11, v2, 4, v11
    v_rcp_f32 v8, v236
    s_nop 0
    v_mul_f32 v216, v216, v8
    v_mul_f32 v217, v217, v8
    v_mul_f32 v218, v218, v8
    v_mul_f32 v219, v219, v8
    v_mul_f32 v220, v220, v8
    v_mul_f32 v221, v221, v8
    v_mul_f32 v222, v222, v8
    v_mul_f32 v223, v223, v8
    v_cvt_pk_bf16_f32 v224, v216, v217
    v_cvt_pk_bf16_f32 v225, v218, v219
    v_cvt_pk_bf16_f32 v226, v220, v221
    v_cvt_pk_bf16_f32 v227, v222, v223
    buffer_store_dwordx2 v[224:225], v10, s[12:15], s41 offen sc1
    s_mov_b32 exec_hi, 0xffff
    buffer_store_dwordx2 v[226:227], v11, s[12:15], s41 offen sc1
    s_mov_b64 exec, -1
    s_waitcnt lgkmcnt(0)
    s_waitcnt vmcnt(12)
    s_barrier
    s_add_u32 s44, s47, 131072
    s_mov_b32 m0, s44
    s_mov_b32 s45, 0xc06000
    buffer_load_dwordx4 v177, s[12:15], s45 offen sc1 lds
    s_add_u32 s44, s47, 139264
    s_mov_b32 m0, s44
    s_mov_b32 s45, 688128
    buffer_load_dwordx4 v194, s[20:23], s45 offen lds
    ds_read_b128 v[48:51], v170 offset:16384
    ds_read_b64_tr_b16 v[16:17], v175 offset:16384
    ds_read_b64_tr_b16 v[18:19], v175 offset:18432
    v_mfma_f32_16x16x32_bf16 v[72:75], v[32:35], v[56:59], v[72:75]
    ds_read_b64_tr_b16 v[20:21], v176 offset:16384
    ds_read_b64_tr_b16 v[22:23], v176 offset:18432
    v_mfma_f32_16x16x32_bf16 v[76:79], v[36:39], v[56:59], v[76:79]
    ds_read_b128 v[52:55], v170 offset:20480
    ds_read_b64_tr_b16 v[24:25], v175 offset:20480
    ds_read_b64_tr_b16 v[26:27], v175 offset:22528
    v_mfma_f32_16x16x32_bf16 v[72:75], v[40:43], v[60:63], v[72:75]
    ds_read_b64_tr_b16 v[28:29], v176 offset:20480
    ds_read_b64_tr_b16 v[30:31], v176 offset:22528
    v_mfma_f32_16x16x32_bf16 v[76:79], v[44:47], v[60:63], v[76:79]
    s_waitcnt lgkmcnt(0)
    s_waitcnt vmcnt(12)
    s_barrier
    s_add_u32 s44, s47, 147456
    s_mov_b32 m0, s44
    s_mov_b32 s45, 0xc06800
    buffer_load_dwordx4 v177, s[12:15], s45 offen sc1 lds
    s_add_u32 s44, s47, 155648
    s_mov_b32 m0, s44
    s_mov_b32 s45, 745472
    buffer_load_dwordx4 v194, s[20:23], s45 offen lds
    ds_read_b128 v[56:59], v168 offset:49152
    ds_read_b64_tr_b16 v[32:33], v171 offset:49152
    ds_read_b64_tr_b16 v[34:35], v171 offset:51200
    v_mfma_f32_16x16x32_bf16 v[72:75], v[16:19], v[48:51], v[72:75]
    ds_read_b64_tr_b16 v[36:37], v172 offset:49152
    ds_read_b64_tr_b16 v[38:39], v172 offset:51200
    v_mfma_f32_16x16x32_bf16 v[76:79], v[20:23], v[48:51], v[76:79]
    ds_read_b128 v[60:63], v168 offset:53248
    ds_read_b64_tr_b16 v[40:41], v171 offset:53248
    ds_read_b64_tr_b16 v[42:43], v171 offset:55296
    v_mfma_f32_16x16x32_bf16 v[72:75], v[24:27], v[52:55], v[72:75]
    ds_read_b64_tr_b16 v[44:45], v172 offset:53248
    ds_read_b64_tr_b16 v[46:47], v172 offset:55296
    v_mfma_f32_16x16x32_bf16 v[76:79], v[28:31], v[52:55], v[76:79]
    s_waitcnt lgkmcnt(0)
    s_waitcnt vmcnt(12)
    s_barrier
    s_add_u32 s44, s47, 49152
    s_mov_b32 m0, s44
    s_mov_b32 s45, 0xc07000
    buffer_load_dwordx4 v177, s[12:15], s45 offen sc1 lds
    s_add_u32 s44, s47, 57344
    s_mov_b32 m0, s44
    s_mov_b32 s45, 802816
    buffer_load_dwordx4 v194, s[20:23], s45 offen lds
    ds_read_b128 v[48:51], v169 offset:0
    ds_read_b64_tr_b16 v[16:17], v173 offset:0
    ds_read_b64_tr_b16 v[18:19], v173 offset:2048
    v_mfma_f32_16x16x32_bf16 v[72:75], v[32:35], v[56:59], v[72:75]
    ds_read_b64_tr_b16 v[20:21], v174 offset:0
    ds_read_b64_tr_b16 v[22:23], v174 offset:2048
    v_mfma_f32_16x16x32_bf16 v[76:79], v[36:39], v[56:59], v[76:79]
    ds_read_b128 v[52:55], v169 offset:4096
    ds_read_b64_tr_b16 v[24:25], v173 offset:4096
    ds_read_b64_tr_b16 v[26:27], v173 offset:6144
    v_mfma_f32_16x16x32_bf16 v[72:75], v[40:43], v[60:63], v[72:75]
    ds_read_b64_tr_b16 v[28:29], v174 offset:4096
    ds_read_b64_tr_b16 v[30:31], v174 offset:6144
    v_mfma_f32_16x16x32_bf16 v[76:79], v[44:47], v[60:63], v[76:79]
    s_waitcnt lgkmcnt(0)
    s_waitcnt vmcnt(6)
    s_barrier
    s_add_u32 s44, s47, 65536
    s_mov_b32 m0, s44
    s_mov_b32 s45, 0xc07800
    buffer_load_dwordx4 v177, s[12:15], s45 offen sc1 lds
    s_add_u32 s44, s47, 73728
    s_mov_b32 m0, s44
    s_mov_b32 s45, 860160
    buffer_load_dwordx4 v194, s[20:23], s45 offen lds
    s_lshl_b32 s37, s24, 7
    s_lshl_b32 s38, s28, 2
    s_add_u32 s37, s37, s38
    s_add_u32 s37, s37, 0x1483000
    s_cmp_lg_u32 s3, 0
    s_cbranch_scc1 Lpub_62
    v_mov_b32 v6, s29
    v_mov_b32 v7, 0
    s_mov_b64 exec, 1
    buffer_store_dword v6, v7, s[12:15], s37 offen sc1
    s_mov_b64 exec, -1
Lpub_62:
    ds_read_b128 v[56:59], v169 offset:16384
    ds_read_b64_tr_b16 v[32:33], v173 offset:16384
    ds_read_b64_tr_b16 v[34:35], v173 offset:18432
    v_mfma_f32_16x16x32_bf16 v[72:75], v[16:19], v[48:51], v[72:75]
    ds_read_b64_tr_b16 v[36:37], v174 offset:16384
    ds_read_b64_tr_b16 v[38:39], v174 offset:18432
    v_mfma_f32_16x16x32_bf16 v[76:79], v[20:23], v[48:51], v[76:79]
    ds_read_b128 v[60:63], v169 offset:20480
    ds_read_b64_tr_b16 v[40:41], v173 offset:20480
    ds_read_b64_tr_b16 v[42:43], v173 offset:22528
    v_mfma_f32_16x16x32_bf16 v[72:75], v[24:27], v[52:55], v[72:75]
    ds_read_b64_tr_b16 v[44:45], v174 offset:20480
    ds_read_b64_tr_b16 v[46:47], v174 offset:22528
    v_mfma_f32_16x16x32_bf16 v[76:79], v[28:31], v[52:55], v[76:79]
    s_waitcnt lgkmcnt(0)
    s_waitcnt vmcnt(12)
    s_barrier
    s_add_u32 s44, s47, 81920
    s_mov_b32 m0, s44
    s_mov_b32 s45, 0xc08000
    buffer_load_dwordx4 v177, s[12:15], s45 offen sc1 lds
    s_add_u32 s44, s47, 90112
    s_mov_b32 m0, s44
    s_mov_b32 s45, 917504
    buffer_load_dwordx4 v194, s[20:23], s45 offen lds
    ds_read_b128 v[48:51], v169 offset:32768
    ds_read_b64_tr_b16 v[16:17], v173 offset:32768
    ds_read_b64_tr_b16 v[18:19], v173 offset:34816
    v_mfma_f32_16x16x32_bf16 v[72:75], v[32:35], v[56:59], v[72:75]
    ds_read_b64_tr_b16 v[20:21], v174 offset:32768
    ds_read_b64_tr_b16 v[22:23], v174 offset:34816
    v_mfma_f32_16x16x32_bf16 v[76:79], v[36:39], v[56:59], v[76:79]
    ds_read_b128 v[52:55], v169 offset:36864
    ds_read_b64_tr_b16 v[24:25], v173 offset:36864
    ds_read_b64_tr_b16 v[26:27], v173 offset:38912
    v_mfma_f32_16x16x32_bf16 v[72:75], v[40:43], v[60:63], v[72:75]
    ds_read_b64_tr_b16 v[28:29], v174 offset:36864
    ds_read_b64_tr_b16 v[30:31], v174 offset:38912
    v_mfma_f32_16x16x32_bf16 v[76:79], v[44:47], v[60:63], v[76:79]
    s_waitcnt lgkmcnt(0)
    s_waitcnt vmcnt(12)
    s_barrier
    s_add_u32 s44, s47, 98304
    s_mov_b32 m0, s44
    s_mov_b32 s45, 0xc08800
    buffer_load_dwordx4 v177, s[12:15], s45 offen sc1 lds
    s_add_u32 s44, s47, 106496
    s_mov_b32 m0, s44
    s_mov_b32 s45, 974848
    buffer_load_dwordx4 v194, s[20:23], s45 offen lds
    ds_read_b128 v[56:59], v169 offset:49152
    ds_read_b64_tr_b16 v[32:33], v173 offset:49152
    ds_read_b64_tr_b16 v[34:35], v173 offset:51200
    v_mfma_f32_16x16x32_bf16 v[72:75], v[16:19], v[48:51], v[72:75]
    ds_read_b64_tr_b16 v[36:37], v174 offset:49152
    ds_read_b64_tr_b16 v[38:39], v174 offset:51200
    v_mfma_f32_16x16x32_bf16 v[76:79], v[20:23], v[48:51], v[76:79]
    ds_read_b128 v[60:63], v169 offset:53248
    ds_read_b64_tr_b16 v[40:41], v173 offset:53248
    ds_read_b64_tr_b16 v[42:43], v173 offset:55296
    v_mfma_f32_16x16x32_bf16 v[72:75], v[24:27], v[52:55], v[72:75]
    ds_read_b64_tr_b16 v[44:45], v174 offset:53248
    ds_read_b64_tr_b16 v[46:47], v174 offset:55296
    v_mfma_f32_16x16x32_bf16 v[76:79], v[28:31], v[52:55], v[76:79]
    s_waitcnt lgkmcnt(0)
    s_waitcnt vmcnt(10)
    s_barrier
    s_add_u32 s44, s47, 114688
    s_mov_b32 m0, s44
    s_mov_b32 s45, 0xc09000
    buffer_load_dwordx4 v177, s[12:15], s45 offen sc1 lds
    s_add_u32 s44, s47, 122880
    s_mov_b32 m0, s44
    s_mov_b32 s45, 1032192
    buffer_load_dwordx4 v194, s[20:23], s45 offen lds
    ds_read_b128 v[48:51], v170 offset:0
    ds_read_b64_tr_b16 v[16:17], v175 offset:0
    ds_read_b64_tr_b16 v[18:19], v175 offset:2048
    v_mfma_f32_16x16x32_bf16 v[72:75], v[32:35], v[56:59], v[72:75]
    ds_read_b64_tr_b16 v[20:21], v176 offset:0
    ds_read_b64_tr_b16 v[22:23], v176 offset:2048
    v_mfma_f32_16x16x32_bf16 v[76:79], v[36:39], v[56:59], v[76:79]
    ds_read_b128 v[52:55], v170 offset:4096
    ds_read_b64_tr_b16 v[24:25], v175 offset:4096
    ds_read_b64_tr_b16 v[26:27], v175 offset:6144
    v_mfma_f32_16x16x32_bf16 v[72:75], v[40:43], v[60:63], v[72:75]
    ds_read_b64_tr_b16 v[28:29], v176 offset:4096
    ds_read_b64_tr_b16 v[30:31], v176 offset:6144
    v_mfma_f32_16x16x32_bf16 v[76:79], v[44:47], v[60:63], v[76:79]
    s_waitcnt lgkmcnt(0)
    s_waitcnt vmcnt(10)
    s_barrier
    s_add_u32 s44, s47, 131072
    s_mov_b32 m0, s44
    s_mov_b32 s45, 0xc09800
    buffer_load_dwordx4 v177, s[12:15], s45 offen sc1 lds
    s_add_u32 s44, s47, 139264
    s_mov_b32 m0, s44
    s_mov_b32 s45, 1089536
    buffer_load_dwordx4 v194, s[20:23], s45 offen lds
    ds_read_b128 v[56:59], v170 offset:16384
    ds_read_b64_tr_b16 v[32:33], v175 offset:16384
    ds_read_b64_tr_b16 v[34:35], v175 offset:18432
    v_mfma_f32_16x16x32_bf16 v[72:75], v[16:19], v[48:51], v[72:75]
    ds_read_b64_tr_b16 v[36:37], v176 offset:16384
    ds_read_b64_tr_b16 v[38:39], v176 offset:18432
    v_mfma_f32_16x16x32_bf16 v[76:79], v[20:23], v[48:51], v[76:79]
    ds_read_b128 v[60:63], v170 offset:20480
    ds_read_b64_tr_b16 v[40:41], v175 offset:20480
    ds_read_b64_tr_b16 v[42:43], v175 offset:22528
    v_mfma_f32_16x16x32_bf16 v[72:75], v[24:27], v[52:55], v[72:75]
    ds_read_b64_tr_b16 v[44:45], v176 offset:20480
    ds_read_b64_tr_b16 v[46:47], v176 offset:22528
    v_mfma_f32_16x16x32_bf16 v[76:79], v[28:31], v[52:55], v[76:79]
    s_waitcnt lgkmcnt(0)
    s_waitcnt vmcnt(10)
    s_barrier
    s_add_u32 s44, s47, 147456
    s_mov_b32 m0, s44
    s_mov_b32 s45, 0xc0a000
    buffer_load_dwordx4 v177, s[12:15], s45 offen sc1 lds
    s_add_u32 s44, s47, 155648
    s_mov_b32 m0, s44
    s_mov_b32 s45, 1146880
    buffer_load_dwordx4 v194, s[20:23], s45 offen lds
    ds_read_b128 v[48:51], v168 offset:49152
    ds_read_b64_tr_b16 v[16:17], v171 offset:49152
    ds_read_b64_tr_b16 v[18:19], v171 offset:51200
    v_mfma_f32_16x16x32_bf16 v[72:75], v[32:35], v[56:59], v[72:75]
    ds_read_b64_tr_b16 v[20:21], v172 offset:49152
    ds_read_b64_tr_b16 v[22:23], v172 offset:51200
    v_mfma_f32_16x16x32_bf16 v[76:79], v[36:39], v[56:59], v[76:79]
    ds_read_b128 v[52:55], v168 offset:53248
    ds_read_b64_tr_b16 v[24:25], v171 offset:53248
    ds_read_b64_tr_b16 v[26:27], v171 offset:55296
    v_mfma_f32_16x16x32_bf16 v[72:75], v[40:43], v[60:63], v[72:75]
    ds_read_b64_tr_b16 v[28:29], v172 offset:53248
    ds_read_b64_tr_b16 v[30:31], v172 offset:55296
    v_mfma_f32_16x16x32_bf16 v[76:79], v[44:47], v[60:63], v[76:79]
    s_waitcnt lgkmcnt(0)
    s_waitcnt vmcnt(10)
    s_barrier
    s_add_u32 s44, s47, 49152
    s_mov_b32 m0, s44
    s_mov_b32 s45, 0xc0a800
    buffer_load_dwordx4 v177, s[12:15], s45 offen sc1 lds
    s_add_u32 s44, s47, 57344
    s_mov_b32 m0, s44
    s_mov_b32 s45, 1204224
    buffer_load_dwordx4 v194, s[20:23], s45 offen lds
    ds_read_b128 v[56:59], v169 offset:0
    ds_read_b64_tr_b16 v[32:33], v173 offset:0
    ds_read_b64_tr_b16 v[34:35], v173 offset:2048
    v_mfma_f32_16x16x32_bf16 v[72:75], v[16:19], v[48:51], v[72:75]
    ds_read_b64_tr_b16 v[36:37], v174 offset:0
    ds_read_b64_tr_b16 v[38:39], v174 offset:2048
    v_mfma_f32_16x16x32_bf16 v[76:79], v[20:23], v[48:51], v[76:79]
    ds_read_b128 v[60:63], v169 offset:4096
    ds_read_b64_tr_b16 v[40:41], v173 offset:4096
    ds_read_b64_tr_b16 v[42:43], v173 offset:6144
    v_mfma_f32_16x16x32_bf16 v[72:75], v[24:27], v[52:55], v[72:75]
    ds_read_b64_tr_b16 v[44:45], v174 offset:4096
    ds_read_b64_tr_b16 v[46:47], v174 offset:6144
    v_mfma_f32_16x16x32_bf16 v[76:79], v[28:31], v[52:55], v[76:79]
    s_waitcnt lgkmcnt(0)
    s_waitcnt vmcnt(10)
    s_barrier
    s_add_u32 s44, s47, 65536
    s_mov_b32 m0, s44
    s_mov_b32 s45, 0xc0b000
    buffer_load_dwordx4 v177, s[12:15], s45 offen sc1 lds
    s_add_u32 s44, s47, 73728
    s_mov_b32 m0, s44
    s_mov_b32 s45, 1261568
    buffer_load_dwordx4 v194, s[20:23], s45 offen lds
    ds_read_b128 v[48:51], v169 offset:16384
    ds_read_b64_tr_b16 v[16:17], v173 offset:16384
    ds_read_b64_tr_b16 v[18:19], v173 offset:18432
    v_mfma_f32_16x16x32_bf16 v[72:75], v[32:35], v[56:59], v[72:75]
    ds_read_b64_tr_b16 v[20:21], v174 offset:16384
    ds_read_b64_tr_b16 v[22:23], v174 offset:18432
    v_mfma_f32_16x16x32_bf16 v[76:79], v[36:39], v[56:59], v[76:79]
    ds_read_b128 v[52:55], v169 offset:20480
    ds_read_b64_tr_b16 v[24:25], v173 offset:20480
    ds_read_b64_tr_b16 v[26:27], v173 offset:22528
    v_mfma_f32_16x16x32_bf16 v[72:75], v[40:43], v[60:63], v[72:75]
    ds_read_b64_tr_b16 v[28:29], v174 offset:20480
    ds_read_b64_tr_b16 v[30:31], v174 offset:22528
    v_mfma_f32_16x16x32_bf16 v[76:79], v[44:47], v[60:63], v[76:79]
    s_waitcnt lgkmcnt(0)
    s_waitcnt vmcnt(10)
    s_barrier
    s_add_u32 s44, s47, 81920
    s_mov_b32 m0, s44
    s_mov_b32 s45, 0xc0b800
    buffer_load_dwordx4 v177, s[12:15], s45 offen sc1 lds
    s_add_u32 s44, s47, 90112
    s_mov_b32 m0, s44
    s_mov_b32 s45, 1318912
    buffer_load_dwordx4 v194, s[20:23], s45 offen lds
    s_cmp_lg_u32 s3, 0
    s_cbranch_scc1 Lfi_63
    s_mov_b32 exec_lo, 0xffff
    s_mov_b32 exec_hi, 0x0
    buffer_load_dword v198, v197, s[12:15], 0 offen sc1
    s_mov_b64 exec, -1
Lfi_63:
    ds_read_b128 v[56:59], v169 offset:32768
    ds_read_b64_tr_b16 v[32:33], v173 offset:32768
    ds_read_b64_tr_b16 v[34:35], v173 offset:34816
    v_mfma_f32_16x16x32_bf16 v[72:75], v[16:19], v[48:51], v[72:75]
    ds_read_b64_tr_b16 v[36:37], v174 offset:32768
    ds_read_b64_tr_b16 v[38:39], v174 offset:34816
    v_mfma_f32_16x16x32_bf16 v[76:79], v[20:23], v[48:51], v[76:79]
    ds_read_b128 v[60:63], v169 offset:36864
    ds_read_b64_tr_b16 v[40:41], v173 offset:36864
    ds_read_b64_tr_b16 v[42:43], v173 offset:38912
    v_mfma_f32_16x16x32_bf16 v[72:75], v[24:27], v[52:55], v[72:75]
    ds_read_b64_tr_b16 v[44:45], v174 offset:36864
    ds_read_b64_tr_b16 v[46:47], v174 offset:38912
    v_mfma_f32_16x16x32_bf16 v[76:79], v[28:31], v[52:55], v[76:79]
    s_waitcnt lgkmcnt(0)
    s_waitcnt vmcnt(10)
    s_barrier
    s_add_u32 s44, s47, 98304
    s_mov_b32 m0, s44
    s_mov_b32 s45, 0xc0c000
    buffer_load_dwordx4 v177, s[12:15], s45 offen sc1 lds
    s_add_u32 s44, s47, 106496
    s_mov_b32 m0, s44
    s_mov_b32 s45, 1376256
    buffer_load_dwordx4 v194, s[20:23], s45 offen lds
    ds_read_b128 v[48:51], v169 offset:49152
    ds_read_b64_tr_b16 v[16:17], v173 offset:49152
    ds_read_b64_tr_b16 v[18:19], v173 offset:51200
    v_mfma_f32_16x16x32_bf16 v[72:75], v[32:35], v[56:59], v[72:75]
    ds_read_b64_tr_b16 v[20:21], v174 offset:49152
    ds_read_b64_tr_b16 v[22:23], v174 offset:51200
    v_mfma_f32_16x16x32_bf16 v[76:79], v[36:39], v[56:59], v[76:79]
    ds_read_b128 v[52:55], v169 offset:53248
    ds_read_b64_tr_b16 v[24:25], v173 offset:53248
    ds_read_b64_tr_b16 v[26:27], v173 offset:55296
    v_mfma_f32_16x16x32_bf16 v[72:75], v[40:43], v[60:63], v[72:75]
    ds_read_b64_tr_b16 v[28:29], v174 offset:53248
    ds_read_b64_tr_b16 v[30:31], v174 offset:55296
    v_mfma_f32_16x16x32_bf16 v[76:79], v[44:47], v[60:63], v[76:79]
    s_waitcnt lgkmcnt(0)
    s_waitcnt vmcnt(10)
    s_barrier
    s_add_u32 s44, s47, 114688
    s_mov_b32 m0, s44
    s_mov_b32 s45, 0xc0c800
    buffer_load_dwordx4 v177, s[12:15], s45 offen sc1 lds
    s_add_u32 s44, s47, 122880
    s_mov_b32 m0, s44
    s_mov_b32 s45, 1433600
    buffer_load_dwordx4 v194, s[20:23], s45 offen lds
    ds_read_b128 v[56:59], v170 offset:0
    ds_read_b64_tr_b16 v[32:33], v175 offset:0
    ds_read_b64_tr_b16 v[34:35], v175 offset:2048
    v_mfma_f32_16x16x32_bf16 v[72:75], v[16:19], v[48:51], v[72:75]
    ds_read_b64_tr_b16 v[36:37], v176 offset:0
    ds_read_b64_tr_b16 v[38:39], v176 offset:2048
    v_mfma_f32_16x16x32_bf16 v[76:79], v[20:23], v[48:51], v[76:79]
    ds_read_b128 v[60:63], v170 offset:4096
    ds_read_b64_tr_b16 v[40:41], v175 offset:4096
    ds_read_b64_tr_b16 v[42:43], v175 offset:6144
    v_mfma_f32_16x16x32_bf16 v[72:75], v[24:27], v[52:55], v[72:75]
    ds_read_b64_tr_b16 v[44:45], v176 offset:4096
    ds_read_b64_tr_b16 v[46:47], v176 offset:6144
    v_mfma_f32_16x16x32_bf16 v[76:79], v[28:31], v[52:55], v[76:79]
    s_waitcnt lgkmcnt(0)
    s_cmp_lg_u32 s3, 0
    s_cbranch_scc1 Lfc_64
    s_mov_b32 exec_lo, 0xffff
    s_mov_b32 exec_hi, 0x0
    s_mov_b32 s63, 0
    s_waitcnt vmcnt(4)
Lfl_65:
    v_cmp_ne_u32 vcc, s29, v198
    s_nop 1
    s_cbranch_vccz Lfd_66
    s_sleep 4
    buffer_load_dword v198, v197, s[12:15], 0 offen sc1
    s_waitcnt vmcnt(0)
    s_add_u32 s63, s63, 1
    s_cmp_lt_u32 s63, 200000
    s_cbranch_scc1 Lfl_65
    v_mov_b32 v6, 4
    v_mov_b32 v7, 4
    buffer_store_dword v6, v7, s[16:19], 0 offen
Lfd_66:
    s_mov_b64 exec, -1
Lfc_64:
    s_waitcnt vmcnt(10)
    s_barrier
    s_add_u32 s44, s47, 131072
    s_mov_b32 m0, s44
    s_mov_b32 s45, 0xc0d000
    buffer_load_dwordx4 v177, s[12:15], s45 offen sc1 lds
    s_add_u32 s44, s47, 139264
    s_mov_b32 m0, s44
    s_mov_b32 s45, 1490944
    buffer_load_dwordx4 v194, s[20:23], s45 offen lds
    ds_read_b128 v[48:51], v170 offset:16384
    ds_read_b64_tr_b16 v[16:17], v175 offset:16384
    ds_read_b64_tr_b16 v[18:19], v175 offset:18432
    v_mfma_f32_16x16x32_bf16 v[72:75], v[32:35], v[56:59], v[72:75]
    ds_read_b64_tr_b16 v[20:21], v176 offset:16384
    ds_read_b64_tr_b16 v[22:23], v176 offset:18432
    v_mfma_f32_16x16x32_bf16 v[76:79], v[36:39], v[56:59], v[76:79]
    ds_read_b128 v[52:55], v170 offset:20480
    ds_read_b64_tr_b16 v[24:25], v175 offset:20480
    ds_read_b64_tr_b16 v[26:27], v175 offset:22528
    v_mfma_f32_16x16x32_bf16 v[72:75], v[40:43], v[60:63], v[72:75]
    ds_read_b64_tr_b16 v[28:29], v176 offset:20480
    ds_read_b64_tr_b16 v[30:31], v176 offset:22528
    v_mfma_f32_16x16x32_bf16 v[76:79], v[44:47], v[60:63], v[76:79]
    s_waitcnt lgkmcnt(0)
    s_waitcnt vmcnt(10)
    s_barrier
    s_add_u32 s44, s47, 147456
    s_mov_b32 m0, s44
    s_mov_b32 s45, 0xc0d800
    buffer_load_dwordx4 v177, s[12:15], s45 offen sc1 lds
    s_add_u32 s44, s47, 155648
    s_mov_b32 m0, s44
    s_mov_b32 s45, 1548288
    buffer_load_dwordx4 v194, s[20:23], s45 offen lds
    ds_read_b128 v[56:59], v168 offset:49152
    ds_read_b64_tr_b16 v[32:33], v171 offset:49152
    ds_read_b64_tr_b16 v[34:35], v171 offset:51200
    v_mfma_f32_16x16x32_bf16 v[72:75], v[16:19], v[48:51], v[72:75]
    ds_read_b64_tr_b16 v[36:37], v172 offset:49152
    ds_read_b64_tr_b16 v[38:39], v172 offset:51200
    v_mfma_f32_16x16x32_bf16 v[76:79], v[20:23], v[48:51], v[76:79]
    ds_read_b128 v[60:63], v168 offset:53248
    ds_read_b64_tr_b16 v[40:41], v171 offset:53248
    ds_read_b64_tr_b16 v[42:43], v171 offset:55296
    v_mfma_f32_16x16x32_bf16 v[72:75], v[24:27], v[52:55], v[72:75]
    ds_read_b64_tr_b16 v[44:45], v172 offset:53248
    ds_read_b64_tr_b16 v[46:47], v172 offset:55296
    v_mfma_f32_16x16x32_bf16 v[76:79], v[28:31], v[52:55], v[76:79]
    s_waitcnt lgkmcnt(0)
    s_waitcnt vmcnt(10)
    s_barrier
    s_add_u32 s44, s47, 49152
    s_mov_b32 m0, s44
    s_mov_b32 s45, 0x800000
    buffer_load_dwordx4 v192, s[12:15], s45 offen sc1 lds
    s_add_u32 s44, s47, 57344
    s_mov_b32 m0, s44
    s_mov_b32 s45, 0
    buffer_load_dwordx4 v194, s[4:7], s45 offen lds
    ds_read_b128 v[48:51], v169 offset:0
    ds_read_b64_tr_b16 v[16:17], v173 offset:0
    ds_read_b64_tr_b16 v[18:19], v173 offset:2048
    v_mfma_f32_16x16x32_bf16 v[72:75], v[32:35], v[56:59], v[72:75]
    ds_read_b64_tr_b16 v[20:21], v174 offset:0
    ds_read_b64_tr_b16 v[22:23], v174 offset:2048
    v_mfma_f32_16x16x32_bf16 v[76:79], v[36:39], v[56:59], v[76:79]
    ds_read_b128 v[52:55], v169 offset:4096
    ds_read_b64_tr_b16 v[24:25], v173 offset:4096
    ds_read_b64_tr_b16 v[26:27], v173 offset:6144
    v_mfma_f32_16x16x32_bf16 v[72:75], v[40:43], v[60:63], v[72:75]
    ds_read_b64_tr_b16 v[28:29], v174 offset:4096
    ds_read_b64_tr_b16 v[30:31], v174 offset:6144
    v_mfma_f32_16x16x32_bf16 v[76:79], v[44:47], v[60:63], v[76:79]
    s_waitcnt lgkmcnt(0)
    s_waitcnt vmcnt(10)
    s_barrier
    s_add_u32 s44, s47, 65536
    s_mov_b32 m0, s44
    s_mov_b32 s45, 0x800800
    buffer_load_dwordx4 v192, s[12:15], s45 offen sc1 lds
    s_add_u32 s44, s47, 73728
    s_mov_b32 m0, s44
    s_mov_b32 s45, 57344
    buffer_load_dwordx4 v194, s[4:7], s45 offen lds
    ds_read_b128 v[56:59], v169 offset:16384
    ds_read_b64_tr_b16 v[32:33], v173 offset:16384
    ds_read_b64_tr_b16 v[34:35], v173 offset:18432
    v_mfma_f32_16x16x32_bf16 v[72:75], v[16:19], v[48:51], v[72:75]
    ds_read_b64_tr_b16 v[36:37], v174 offset:16384
    ds_read_b64_tr_b16 v[38:39], v174 offset:18432
    v_mfma_f32_16x16x32_bf16 v[76:79], v[20:23], v[48:51], v[76:79]
    ds_read_b128 v[60:63], v169 offset:20480
    ds_read_b64_tr_b16 v[40:41], v173 offset:20480
    ds_read_b64_tr_b16 v[42:43], v173 offset:22528
    v_mfma_f32_16x16x32_bf16 v[72:75], v[24:27], v[52:55], v[72:75]
    ds_read_b64_tr_b16 v[44:45], v174 offset:20480
    ds_read_b64_tr_b16 v[46:47], v174 offset:22528
    v_mfma_f32_16x16x32_bf16 v[76:79], v[28:31], v[52:55], v[76:79]
    s_waitcnt lgkmcnt(0)
    s_waitcnt vmcnt(10)
    s_barrier
    s_add_u32 s44, s47, 81920
    s_mov_b32 m0, s44
    s_mov_b32 s45, 0x801000
    buffer_load_dwordx4 v192, s[12:15], s45 offen sc1 lds
    s_add_u32 s44, s47, 90112
    s_mov_b32 m0, s44
    s_mov_b32 s45, 114688
    buffer_load_dwordx4 v194, s[4:7], s45 offen lds
    ds_read_b128 v[48:51], v169 offset:32768
    ds_read_b64_tr_b16 v[16:17], v173 offset:32768
    ds_read_b64_tr_b16 v[18:19], v173 offset:34816
    v_mfma_f32_16x16x32_bf16 v[72:75], v[32:35], v[56:59], v[72:75]
    ds_read_b64_tr_b16 v[20:21], v174 offset:32768
    ds_read_b64_tr_b16 v[22:23], v174 offset:34816
    v_mfma_f32_16x16x32_bf16 v[76:79], v[36:39], v[56:59], v[76:79]
    ds_read_b128 v[52:55], v169 offset:36864
    ds_read_b64_tr_b16 v[24:25], v173 offset:36864
    ds_read_b64_tr_b16 v[26:27], v173 offset:38912
    v_mfma_f32_16x16x32_bf16 v[72:75], v[40:43], v[60:63], v[72:75]
    ds_read_b64_tr_b16 v[28:29], v174 offset:36864
    ds_read_b64_tr_b16 v[30:31], v174 offset:38912
    v_mfma_f32_16x16x32_bf16 v[76:79], v[44:47], v[60:63], v[76:79]
    s_waitcnt lgkmcnt(0)
    s_waitcnt vmcnt(10)
    s_barrier
    s_add_u32 s44, s47, 98304
    s_mov_b32 m0, s44
    s_mov_b32 s45, 0x801800
    buffer_load_dwordx4 v192, s[12:15], s45 offen sc1 lds
    s_add_u32 s44, s47, 106496
    s_mov_b32 m0, s44
    s_mov_b32 s45, 172032
    buffer_load_dwordx4 v194, s[4:7], s45 offen lds
    ds_read_b128 v[56:59], v169 offset:49152
    ds_read_b64_tr_b16 v[32:33], v173 offset:49152
    ds_read_b64_tr_b16 v[34:35], v173 offset:51200
    v_mfma_f32_16x16x32_bf16 v[72:75], v[16:19], v[48:51], v[72:75]
    ds_read_b64_tr_b16 v[36:37], v174 offset:49152
    ds_read_b64_tr_b16 v[38:39], v174 offset:51200
    v_mfma_f32_16x16x32_bf16 v[76:79], v[20:23], v[48:51], v[76:79]
    ds_read_b128 v[60:63], v169 offset:53248
    ds_read_b64_tr_b16 v[40:41], v173 offset:53248
    ds_read_b64_tr_b16 v[42:43], v173 offset:55296
    v_mfma_f32_16x16x32_bf16 v[72:75], v[24:27], v[52:55], v[72:75]
    ds_read_b64_tr_b16 v[44:45], v174 offset:53248
    ds_read_b64_tr_b16 v[46:47], v174 offset:55296
    v_mfma_f32_16x16x32_bf16 v[76:79], v[28:31], v[52:55], v[76:79]
    s_waitcnt lgkmcnt(0)
    s_waitcnt vmcnt(10)
    s_barrier
    s_add_u32 s44, s47, 114688
    s_mov_b32 m0, s44
    s_mov_b32 s45, 0x802000
    buffer_load_dwordx4 v192, s[12:15], s45 offen sc1 lds
    s_add_u32 s44, s47, 122880
    s_mov_b32 m0, s44
    s_mov_b32 s45, 229376
    buffer_load_dwordx4 v194, s[4:7], s45 offen lds
    ds_read_b128 v[48:51], v170 offset:0
    ds_read_b64_tr_b16 v[16:17], v175 offset:0
    ds_read_b64_tr_b16 v[18:19], v175 offset:2048
    v_mfma_f32_16x16x32_bf16 v[72:75], v[32:35], v[56:59], v[72:75]
    ds_read_b64_tr_b16 v[20:21], v176 offset:0
    ds_read_b64_tr_b16 v[22:23], v176 offset:2048
    v_mfma_f32_16x16x32_bf16 v[76:79], v[36:39], v[56:59], v[76:79]
    ds_read_b128 v[52:55], v170 offset:4096
    ds_read_b64_tr_b16 v[24:25], v175 offset:4096
    ds_read_b64_tr_b16 v[26:27], v175 offset:6144
    v_mfma_f32_16x16x32_bf16 v[72:75], v[40:43], v[60:63], v[72:75]
    ds_read_b64_tr_b16 v[28:29], v176 offset:4096
    ds_read_b64_tr_b16 v[30:31], v176 offset:6144
    v_mfma_f32_16x16x32_bf16 v[76:79], v[44:47], v[60:63], v[76:79]
    s_waitcnt lgkmcnt(0)
    s_waitcnt vmcnt(10)
    s_barrier
    s_add_u32 s44, s47, 131072
    s_mov_b32 m0, s44
    s_mov_b32 s45, 0x802800
    buffer_load_dwordx4 v192, s[12:15], s45 offen sc1 lds
    s_add_u32 s44, s47, 139264
    s_mov_b32 m0, s44
    s_mov_b32 s45, 286720
    buffer_load_dwordx4 v194, s[4:7], s45 offen lds
    ds_read_b128 v[56:59], v170 offset:16384
    ds_read_b64_tr_b16 v[32:33], v175 offset:16384
    ds_read_b64_tr_b16 v[34:35], v175 offset:18432
    v_mfma_f32_16x16x32_bf16 v[72:75], v[16:19], v[48:51], v[72:75]
    ds_read_b64_tr_b16 v[36:37], v176 offset:16384
    ds_read_b64_tr_b16 v[38:39], v176 offset:18432
    v_mfma_f32_16x16x32_bf16 v[76:79], v[20:23], v[48:51], v[76:79]
    ds_read_b128 v[60:63], v170 offset:20480
    ds_read_b64_tr_b16 v[40:41], v175 offset:20480
    ds_read_b64_tr_b16 v[42:43], v175 offset:22528
    v_mfma_f32_16x16x32_bf16 v[72:75], v[24:27], v[52:55], v[72:75]
    ds_read_b64_tr_b16 v[44:45], v176 offset:20480
    ds_read_b64_tr_b16 v[46:47], v176 offset:22528
    v_mfma_f32_16x16x32_bf16 v[76:79], v[28:31], v[52:55], v[76:79]
    s_waitcnt lgkmcnt(0)
    s_waitcnt vmcnt(10)
    s_barrier
    s_add_u32 s44, s47, 147456
    s_mov_b32 m0, s44
    s_mov_b32 s45, 0x803000
    buffer_load_dwordx4 v192, s[12:15], s45 offen sc1 lds
    s_add_u32 s44, s47, 155648
    s_mov_b32 m0, s44
    s_mov_b32 s45, 344064
    buffer_load_dwordx4 v194, s[4:7], s45 offen lds
    ds_read_b128 v[48:51], v168 offset:49152
    ds_read_b64_tr_b16 v[16:17], v171 offset:49152
    ds_read_b64_tr_b16 v[18:19], v171 offset:51200
    v_mfma_f32_16x16x32_bf16 v[72:75], v[32:35], v[56:59], v[72:75]
    ds_read_b64_tr_b16 v[20:21], v172 offset:49152
    ds_read_b64_tr_b16 v[22:23], v172 offset:51200
    v_mfma_f32_16x16x32_bf16 v[76:79], v[36:39], v[56:59], v[76:79]
    ds_read_b128 v[52:55], v168 offset:53248
    ds_read_b64_tr_b16 v[24:25], v171 offset:53248
    ds_read_b64_tr_b16 v[26:27], v171 offset:55296
    v_mfma_f32_16x16x32_bf16 v[72:75], v[40:43], v[60:63], v[72:75]
    ds_read_b64_tr_b16 v[28:29], v172 offset:53248
    ds_read_b64_tr_b16 v[30:31], v172 offset:55296
    v_mfma_f32_16x16x32_bf16 v[76:79], v[44:47], v[60:63], v[76:79]
    s_waitcnt lgkmcnt(0)
    s_waitcnt vmcnt(10)
    s_barrier
    ds_read_b128 v[56:59], v169 offset:0
    ds_read_b64_tr_b16 v[32:33], v173 offset:0
    ds_read_b64_tr_b16 v[34:35], v173 offset:2048
    v_mfma_f32_16x16x32_bf16 v[64:67], v[16:19], v[48:51], 0
    ds_read_b64_tr_b16 v[36:37], v174 offset:0
    ds_read_b64_tr_b16 v[38:39], v174 offset:2048
    v_mfma_f32_16x16x32_bf16 v[68:71], v[20:23], v[48:51], 0
    ds_read_b128 v[60:63], v169 offset:4096
    ds_read_b64_tr_b16 v[40:41], v173 offset:4096
    ds_read_b64_tr_b16 v[42:43], v173 offset:6144
    v_mfma_f32_16x16x32_bf16 v[64:67], v[24:27], v[52:55], v[64:67]
    ds_read_b64_tr_b16 v[44:45], v174 offset:4096
    ds_read_b64_tr_b16 v[46:47], v174 offset:6144
    v_mfma_f32_16x16x32_bf16 v[68:71], v[28:31], v[52:55], v[68:71]
    s_waitcnt lgkmcnt(0)
    s_waitcnt vmcnt(8)
    s_barrier
    ds_read_b128 v[48:51], v169 offset:16384
    ds_read_b64_tr_b16 v[16:17], v173 offset:16384
    ds_read_b64_tr_b16 v[18:19], v173 offset:18432
    v_mfma_f32_16x16x32_bf16 v[64:67], v[32:35], v[56:59], v[64:67]
    ds_read_b64_tr_b16 v[20:21], v174 offset:16384
    ds_read_b64_tr_b16 v[22:23], v174 offset:18432
    v_mfma_f32_16x16x32_bf16 v[68:71], v[36:39], v[56:59], v[68:71]
    ds_read_b128 v[52:55], v169 offset:20480
    ds_read_b64_tr_b16 v[24:25], v173 offset:20480
    ds_read_b64_tr_b16 v[26:27], v173 offset:22528
    v_mfma_f32_16x16x32_bf16 v[64:67], v[40:43], v[60:63], v[64:67]
    ds_read_b64_tr_b16 v[28:29], v174 offset:20480
    ds_read_b64_tr_b16 v[30:31], v174 offset:22528
    v_mfma_f32_16x16x32_bf16 v[68:71], v[44:47], v[60:63], v[68:71]
    s_waitcnt lgkmcnt(0)
    s_waitcnt vmcnt(6)
    s_barrier
    ds_read_b128 v[56:59], v169 offset:32768
    ds_read_b64_tr_b16 v[32:33], v173 offset:32768
    ds_read_b64_tr_b16 v[34:35], v173 offset:34816
    v_mfma_f32_16x16x32_bf16 v[64:67], v[16:19], v[48:51], v[64:67]
    ds_read_b64_tr_b16 v[36:37], v174 offset:32768
    ds_read_b64_tr_b16 v[38:39], v174 offset:34816
    v_mfma_f32_16x16x32_bf16 v[68:71], v[20:23], v[48:51], v[68:71]
    ds_read_b128 v[60:63], v169 offset:36864
    ds_read_b64_tr_b16 v[40:41], v173 offset:36864
    ds_read_b64_tr_b16 v[42:43], v173 offset:38912
    v_mfma_f32_16x16x32_bf16 v[64:67], v[24:27], v[52:55], v[64:67]
    ds_read_b64_tr_b16 v[44:45], v174 offset:36864
    ds_read_b64_tr_b16 v[46:47], v174 offset:38912
    v_mfma_f32_16x16x32_bf16 v[68:71], v[28:31], v[52:55], v[68:71]
    s_waitcnt lgkmcnt(0)
    s_waitcnt vmcnt(4)
    s_barrier
    ds_read_b128 v[48:51], v169 offset:49152
    ds_read_b64_tr_b16 v[16:17], v173 offset:49152
    ds_read_b64_tr_b16 v[18:19], v173 offset:51200
    v_mfma_f32_16x16x32_bf16 v[64:67], v[32:35], v[56:59], v[64:67]
    ds_read_b64_tr_b16 v[20:21], v174 offset:49152
    ds_read_b64_tr_b16 v[22:23], v174 offset:51200
    v_mfma_f32_16x16x32_bf16 v[68:71], v[36:39], v[56:59], v[68:71]
    ds_read_b128 v[52:55], v169 offset:53248
    ds_read_b64_tr_b16 v[24:25], v173 offset:53248
    ds_read_b64_tr_b16 v[26:27], v173 offset:55296
    v_mfma_f32_16x16x32_bf16 v[64:67], v[40:43], v[60:63], v[64:67]
    ds_read_b64_tr_b16 v[28:29], v174 offset:53248
    ds_read_b64_tr_b16 v[30:31], v174 offset:55296
    v_mfma_f32_16x16x32_bf16 v[68:71], v[44:47], v[60:63], v[68:71]
    s_waitcnt lgkmcnt(0)
    s_waitcnt vmcnt(2)
    s_barrier
    ds_read_b128 v[56:59], v170 offset:0
    ds_read_b64_tr_b16 v[32:33], v175 offset:0
    ds_read_b64_tr_b16 v[34:35], v175 offset:2048
    v_mfma_f32_16x16x32_bf16 v[64:67], v[16:19], v[48:51], v[64:67]
    ds_read_b64_tr_b16 v[36:37], v176 offset:0
    ds_read_b64_tr_b16 v[38:39], v176 offset:2048
    v_mfma_f32_16x16x32_bf16 v[68:71], v[20:23], v[48:51], v[68:71]
    ds_read_b128 v[60:63], v170 offset:4096
    ds_read_b64_tr_b16 v[40:41], v175 offset:4096
    ds_read_b64_tr_b16 v[42:43], v175 offset:6144
    v_mfma_f32_16x16x32_bf16 v[64:67], v[24:27], v[52:55], v[64:67]
    ds_read_b64_tr_b16 v[44:45], v176 offset:4096
    ds_read_b64_tr_b16 v[46:47], v176 offset:6144
    v_mfma_f32_16x16x32_bf16 v[68:71], v[28:31], v[52:55], v[68:71]
    s_waitcnt lgkmcnt(0)
    s_waitcnt vmcnt(0)
    s_barrier
    ds_read_b128 v[48:51], v170 offset:16384
    ds_read_b64_tr_b16 v[16:17], v175 offset:16384
    ds_read_b64_tr_b16 v[18:19], v175 offset:18432
    v_mfma_f32_16x16x32_bf16 v[64:67], v[32:35], v[56:59], v[64:67]
    ds_read_b64_tr_b16 v[20:21], v176 offset:16384
    ds_read_b64_tr_b16 v[22:23], v176 offset:18432
    v_mfma_f32_16x16x32_bf16 v[68:71], v[36:39], v[56:59], v[68:71]
    ds_read_b128 v[52:55], v170 offset:20480
    ds_read_b64_tr_b16 v[24:25], v175 offset:20480
    ds_read_b64_tr_b16 v[26:27], v175 offset:22528
    v_mfma_f32_16x16x32_bf16 v[64:67], v[40:43], v[60:63], v[64:67]
    ds_read_b64_tr_b16 v[28:29], v176 offset:20480
    ds_read_b64_tr_b16 v[30:31], v176 offset:22528
    v_mfma_f32_16x16x32_bf16 v[68:71], v[44:47], v[60:63], v[68:71]
    s_waitcnt lgkmcnt(0)
    v_mfma_f32_16x16x32_bf16 v[64:67], v[16:19], v[48:51], v[64:67]
    v_mfma_f32_16x16x32_bf16 v[68:71], v[20:23], v[48:51], v[68:71]
    v_mfma_f32_16x16x32_bf16 v[64:67], v[24:27], v[52:55], v[64:67]
    v_mfma_f32_16x16x32_bf16 v[68:71], v[28:31], v[52:55], v[68:71]
    s_waitcnt lgkmcnt(0)
    s_nop 7
    v_sub_f32 v12, 1.0, v179
    v_lshlrev_b32 v6, 16, v180
    v_and_b32 v7, 0xffff0000, v180
    v_add_f32 v72, v72, v6
    v_add_f32 v73, v73, v7
    v_mul_f32 v72, v72, v12
    v_mul_f32 v73, v73, v12
    v_fmac_f32 v72, v64, v179
    v_fmac_f32 v73, v65, v179
    v_cvt_pk_bf16_f32 v48, v72, v73
    v_lshlrev_b32 v6, 16, v181
    v_and_b32 v7, 0xffff0000, v181
    v_add_f32 v74, v74, v6
    v_add_f32 v75, v75, v7
    v_mul_f32 v74, v74, v12
    v_mul_f32 v75, v75, v12
    v_fmac_f32 v74, v66, v179
    v_fmac_f32 v75, v67, v179
    v_cvt_pk_bf16_f32 v49, v74, v75
    v_lshlrev_b32 v6, 16, v182
    v_and_b32 v7, 0xffff0000, v182
    v_add_f32 v76, v76, v6
    v_add_f32 v77, v77, v7
    v_mul_f32 v76, v76, v12
    v_mul_f32 v77, v77, v12
    v_fmac_f32 v76, v68, v179
    v_fmac_f32 v77, v69, v179
    v_cvt_pk_bf16_f32 v50, v76, v77
    v_lshlrev_b32 v6, 16, v183
    v_and_b32 v7, 0xffff0000, v183
    v_add_f32 v78, v78, v6
    v_add_f32 v79, v79, v7
    v_mul_f32 v78, v78, v12
    v_mul_f32 v79, v79, v12
    v_fmac_f32 v78, v70, v179
    v_fmac_f32 v79, v71, v179
    v_cvt_pk_bf16_f32 v51, v78, v79
    buffer_store_dwordx2 v[48:49], v178, s[8:11], s49 offen
    buffer_store_dwordx2 v[50:51], v178, s[8:11], s49 offen offset:32
    s_endpgm
L_spare:
    s_sub_u32 s33, s30, 28
    s_lshl_b32 s32, s31, 2
    s_add_u32 s30, s32, s33
    s_lshl_b32 s47, s3, 10
    s_lshl_b32 s38, s3, 10
    s_mov_b32 s4, s74
    s_mov_b32 s5, s75
    s_mov_b32 s6, 0x62000
    s_mov_b32 s7, 0x00020000
    s_mul_i32 s37, s30, 12544
    s_add_u32 s37, s37, s38
    buffer_load_dwordx4 v[200:203], v4, s[4:7], s37 offen
    s_add_u32 s37, s37, 8192
    buffer_load_dwordx4 v[204:207], v4, s[4:7], s37 offen
    s_add_u32 s37, s37, 8192
    s_mov_b32 s4, s78
    s_mov_b32 s5, s79
    s_mov_b32 s6, 0x188000
    s_mov_b32 s7, 0x00020000
    s_mul_i32 s37, s30, 50176
    s_add_u32 s37, s37, s38
    buffer_load_dwordx4 v[200:203], v4, s[4:7], s37 offen
    s_add_u32 s37, s37, 8192
    buffer_load_dwordx4 v[204:207], v4, s[4:7], s37 offen
    s_add_u32 s37, s37, 8192
    buffer_load_dwordx4 v[208:211], v4, s[4:7], s37 offen
    s_add_u32 s37, s37, 8192
    buffer_load_dwordx4 v[212:215], v4, s[4:7], s37 offen
    s_add_u32 s37, s37, 8192
    buffer_load_dwordx4 v[216:219], v4, s[4:7], s37 offen
    s_add_u32 s37, s37, 8192
    buffer_load_dwordx4 v[220:223], v4, s[4:7], s37 offen
    s_add_u32 s37, s37, 8192
    buffer_load_dwordx4 v[224:227], v4, s[4:7], s37 offen
    s_add_u32 s37, s37, 8192
    s_mov_b32 s4, s68
    s_mov_b32 s5, s69
    s_mov_b32 s6, 0x62000
    s_mov_b32 s7, 0x00020000
    s_mul_i32 s37, s30, 12544
    s_add_u32 s37, s37, s38
    buffer_load_dwordx4 v[200:203], v4, s[4:7], s37 offen
    s_add_u32 s37, s37, 8192
    buffer_load_dwordx4 v[204:207], v4, s[4:7], s37 offen
    s_add_u32 s37, s37, 8192
    s_mov_b32 s4, s64
    s_mov_b32 s5, s65
    s_mov_b32 s6, 0x1c0000
    s_mov_b32 s7, 0x00020000
    s_mov_b32 s8, s80
    s_mov_b32 s9, s81
    s_mov_b32 s10, 0x380
    s_mov_b32 s11, 0x00020000
    s_lshl_b32 s37, s30, 7
    s_add_u32 s20, s76, s37
    s_addc_u32 s21, s77, 0
    s_sub_u32 s22, 0x188000, s37
    s_mov_b32 s23, 0x00020000
    s_cmp_ge_u32 s3, 4
    s_cbranch_scc1 Lcs_67
    s_lshl_b32 s37, s30, 6
    s_lshl_b32 s38, s3, 4
    s_add_u32 s37, s37, s38
    v_add_u32 v168, s37, v2
    v_mul_u32_u24 v8, 896, v168
    v_lshl_add_u32 v8, v3, 4, v8
    v_lshlrev_b32 v9, 4, v3
    buffer_load_dwordx4 v[16:19], v8, s[4:7], 0 offen offset:0
    buffer_load_dwordx4 v[104:107], v9, s[8:11], 0 offen offset:0
    buffer_load_dwordx4 v[20:23], v8, s[4:7], 0 offen offset:64
    buffer_load_dwordx4 v[108:111], v9, s[8:11], 0 offen offset:64
    buffer_load_dwordx4 v[24:27], v8, s[4:7], 0 offen offset:128
    buffer_load_dwordx4 v[112:115], v9, s[8:11], 0 offen offset:128
    buffer_load_dwordx4 v[28:31], v8, s[4:7], 0 offen offset:192
    buffer_load_dwordx4 v[116:119], v9, s[8:11], 0 offen offset:192
    buffer_load_dwordx4 v[32:35], v8, s[4:7], 0 offen offset:256
    buffer_load_dwordx4 v[120:123], v9, s[8:11], 0 offen offset:256
    buffer_load_dwordx4 v[36:39], v8, s[4:7], 0 offen offset:320
    buffer_load_dwordx4 v[124:127], v9, s[8:11], 0 offen offset:320
    buffer_load_dwordx4 v[40:43], v8, s[4:7], 0 offen offset:384
    buffer_load_dwordx4 v[128:131], v9, s[8:11], 0 offen offset:384
    buffer_load_dwordx4 v[44:47], v8, s[4:7], 0 offen offset:448
    buffer_load_dwordx4 v[132:135], v9, s[8:11], 0 offen offset:448
    buffer_load_dwordx4 v[48:51], v8, s[4:7], 0 offen offset:512
    buffer_load_dwordx4 v[136:139], v9, s[8:11], 0 offen offset:512
    buffer_load_dwordx4 v[52:55], v8, s[4:7], 0 offen offset:576
    buffer_load_dwordx4 v[140:143], v9, s[8:11], 0 offen offset:576
    buffer_load_dwordx4 v[56:59], v8, s[4:7], 0 offen offset:640
    buffer_load_dwordx4 v[144:147], v9, s[8:11], 0 offen offset:640
    buffer_load_dwordx4 v[60:63], v8, s[4:7], 0 offen offset:704
    buffer_load_dwordx4 v[148:151], v9, s[8:11], 0 offen offset:704
    buffer_load_dwordx4 v[64:67], v8, s[4:7], 0 offen offset:768
    buffer_load_dwordx4 v[152:155], v9, s[8:11], 0 offen offset:768
    buffer_load_dwordx4 v[68:71], v8, s[4:7], 0 offen offset:832
    buffer_load_dwordx4 v[156:159], v9, s[8:11], 0 offen offset:832
    v_mov_b32 v10, 0
    v_mov_b32 v11, 0
    s_waitcnt vmcnt(26)
    v_dot2_f32_bf16 v10, v16, v104, v10
    v_dot2_f32_bf16 v11, v17, v105, v11
    v_dot2_f32_bf16 v10, v18, v106, v10
    v_dot2_f32_bf16 v11, v19, v107, v11
    s_waitcnt vmcnt(24)
    v_dot2_f32_bf16 v10, v20, v108, v10
    v_dot2_f32_bf16 v11, v21, v109, v11
    v_dot2_f32_bf16 v10, v22, v110, v10
    v_dot2_f32_bf16 v11, v23, v111, v11
    s_waitcnt vmcnt(22)
    v_dot2_f32_bf16 v10, v24, v112, v10
    v_dot2_f32_bf16 v11, v25, v113, v11
    v_dot2_f32_bf16 v10, v26, v114, v10
    v_dot2_f32_bf16 v11, v27, v115, v11
    s_waitcnt vmcnt(20)
    v_dot2_f32_bf16 v10, v28, v116, v10
    v_dot2_f32_bf16 v11, v29, v117, v11
    v_dot2_f32_bf16 v10, v30, v118, v10
    v_dot2_f32_bf16 v11, v31, v119, v11
    s_waitcnt vmcnt(18)
    v_dot2_f32_bf16 v10, v32, v120, v10
    v_dot2_f32_bf16 v11, v33, v121, v11
    v_dot2_f32_bf16 v10, v34, v122, v10
    v_dot2_f32_bf16 v11, v35, v123, v11
    s_waitcnt vmcnt(16)
    v_dot2_f32_bf16 v10, v36, v124, v10
    v_dot2_f32_bf16 v11, v37, v125, v11
    v_dot2_f32_bf16 v10, v38, v126, v10
    v_dot2_f32_bf16 v11, v39, v127, v11
    s_waitcnt vmcnt(14)
    v_dot2_f32_bf16 v10, v40, v128, v10
    v_dot2_f32_bf16 v11, v41, v129, v11
    v_dot2_f32_bf16 v10, v42, v130, v10
    v_dot2_f32_bf16 v11, v43, v131, v11
    s_waitcnt vmcnt(12)
    v_dot2_f32_bf16 v10, v44, v132, v10
    v_dot2_f32_bf16 v11, v45, v133, v11
    v_dot2_f32_bf16 v10, v46, v134, v10
    v_dot2_f32_bf16 v11, v47, v135, v11
    s_waitcnt vmcnt(10)
    v_dot2_f32_bf16 v10, v48, v136, v10
    v_dot2_f32_bf16 v11, v49, v137, v11
    v_dot2_f32_bf16 v10, v50, v138, v10
    v_dot2_f32_bf16 v11, v51, v139, v11
    s_waitcnt vmcnt(8)
    v_dot2_f32_bf16 v10, v52, v140, v10
    v_dot2_f32_bf16 v11, v53, v141, v11
    v_dot2_f32_bf16 v10, v54, v142, v10
    v_dot2_f32_bf16 v11, v55, v143, v11
    s_waitcnt vmcnt(6)
    v_dot2_f32_bf16 v10, v56, v144, v10
    v_dot2_f32_bf16 v11, v57, v145, v11
    v_dot2_f32_bf16 v10, v58, v146, v10
    v_dot2_f32_bf16 v11, v59, v147, v11
    s_waitcnt vmcnt(4)
    v_dot2_f32_bf16 v10, v60, v148, v10
    v_dot2_f32_bf16 v11, v61, v149, v11
    v_dot2_f32_bf16 v10, v62, v150, v10
    v_dot2_f32_bf16 v11, v63, v151, v11
    s_waitcnt vmcnt(2)
    v_dot2_f32_bf16 v10, v64, v152, v10
    v_dot2_f32_bf16 v11, v65, v153, v11
    v_dot2_f32_bf16 v10, v66, v154, v10
    v_dot2_f32_bf16 v11, v67, v155, v11
    s_waitcnt vmcnt(0)
    v_dot2_f32_bf16 v10, v68, v156, v10
    v_dot2_f32_bf16 v11, v69, v157, v11
    v_dot2_f32_bf16 v10, v70, v158, v10
    v_dot2_f32_bf16 v11, v71, v159, v11
    s_nop 3
    v_add_f32 v10, v10, v11
    v_mov_b32 v6, v10
    s_nop 1
    v_permlane32_swap_b32 v10, v6
    s_nop 1
    v_add_f32 v10, v10, v6
    v_mov_b32 v6, v10
    s_nop 1
    v_permlane16_swap_b32 v10, v6
    s_nop 1
    v_add_f32 v10, v10, v6
    v_mul_f32 v10, 0xbfb8aa3b, v10
    v_exp_f32 v10, v10
    s_nop 0
    v_add_f32 v10, 1.0, v10
    v_rcp_f32 v10, v10
    v_lshlrev_b32 v6, 2, v168
    s_mov_b32 s38, 0x1400000
    s_mov_b64 exec, 0xffff
    buffer_store_dword v10, v6, s[12:15], s38 offen sc1
    s_mov_b64 exec, -1
Lcs_67:
    s_cmp_ge_u32 s30, 28
    s_cbranch_scc1 Lnocs_68
    v_lshrrev_b32 v6, 3, v1
    s_mul_i32 s37, s3, 56
    v_add_u32 v6, s37, v6
    v_mul_u32_u24 v6, 3584, v6
    v_and_b32 v7, 7, v1
    v_lshl_add_u32 v6, v7, 4, v6
    s_mov_b32 s37, 0
    buffer_load_dwordx4 v[16:19], v6, s[20:23], s37 offen
    s_mov_b32 s37, 28672
    buffer_load_dwordx4 v[20:23], v6, s[20:23], s37 offen
    s_mov_b32 s37, 57344
    buffer_load_dwordx4 v[24:27], v6, s[20:23], s37 offen
    s_mov_b32 s37, 86016
    buffer_load_dwordx4 v[28:31], v6, s[20:23], s37 offen
    s_mov_b32 s37, 114688
    buffer_load_dwordx4 v[32:35], v6, s[20:23], s37 offen
    s_mov_b32 s37, 143360
    buffer_load_dwordx4 v[36:39], v6, s[20:23], s37 offen
    s_mov_b32 s37, 172032
    buffer_load_dwordx4 v[40:43], v6, s[20:23], s37 offen
    v_mov_b32 v72, 0
    v_mov_b32 v73, 0
    v_mov_b32 v74, 0
    v_mov_b32 v75, 0
    v_mov_b32 v76, 0
    v_mov_b32 v77, 0
    v_mov_b32 v78, 0
    v_mov_b32 v79, 0
    s_waitcnt vmcnt(6)
    v_lshlrev_b32 v8, 16, v16
    v_and_b32 v9, 0xffff0000, v16
    v_pk_add_f32 v[72:73], v[72:73], v[8:9]
    v_lshlrev_b32 v8, 16, v17
    v_and_b32 v9, 0xffff0000, v17
    v_pk_add_f32 v[74:75], v[74:75], v[8:9]
    v_lshlrev_b32 v8, 16, v18
    v_and_b32 v9, 0xffff0000, v18
    v_pk_add_f32 v[76:77], v[76:77], v[8:9]
    v_lshlrev_b32 v8, 16, v19
    v_and_b32 v9, 0xffff0000, v19
    v_pk_add_f32 v[78:79], v[78:79], v[8:9]
    s_waitcnt vmcnt(5)
    v_lshlrev_b32 v8, 16, v20
    v_and_b32 v9, 0xffff0000, v20
    v_pk_add_f32 v[72:73], v[72:73], v[8:9]
    v_lshlrev_b32 v8, 16, v21
    v_and_b32 v9, 0xffff0000, v21
    v_pk_add_f32 v[74:75], v[74:75], v[8:9]
    v_lshlrev_b32 v8, 16, v22
    v_and_b32 v9, 0xffff0000, v22
    v_pk_add_f32 v[76:77], v[76:77], v[8:9]
    v_lshlrev_b32 v8, 16, v23
    v_and_b32 v9, 0xffff0000, v23
    v_pk_add_f32 v[78:79], v[78:79], v[8:9]
    s_waitcnt vmcnt(4)
    v_lshlrev_b32 v8, 16, v24
    v_and_b32 v9, 0xffff0000, v24
    v_pk_add_f32 v[72:73], v[72:73], v[8:9]
    v_lshlrev_b32 v8, 16, v25
    v_and_b32 v9, 0xffff0000, v25
    v_pk_add_f32 v[74:75], v[74:75], v[8:9]
    v_lshlrev_b32 v8, 16, v26
    v_and_b32 v9, 0xffff0000, v26
    v_pk_add_f32 v[76:77], v[76:77], v[8:9]
    v_lshlrev_b32 v8, 16, v27
    v_and_b32 v9, 0xffff0000, v27
    v_pk_add_f32 v[78:79], v[78:79], v[8:9]
    s_waitcnt vmcnt(3)
    v_lshlrev_b32 v8, 16, v28
    v_and_b32 v9, 0xffff0000, v28
    v_pk_add_f32 v[72:73], v[72:73], v[8:9]
    v_lshlrev_b32 v8, 16, v29
    v_and_b32 v9, 0xffff0000, v29
    v_pk_add_f32 v[74:75], v[74:75], v[8:9]
    v_lshlrev_b32 v8, 16, v30
    v_and_b32 v9, 0xffff0000, v30
    v_pk_add_f32 v[76:77], v[76:77], v[8:9]
    v_lshlrev_b32 v8, 16, v31
    v_and_b32 v9, 0xffff0000, v31
    v_pk_add_f32 v[78:79], v[78:79], v[8:9]
    s_waitcnt vmcnt(2)
    v_lshlrev_b32 v8, 16, v32
    v_and_b32 v9, 0xffff0000, v32
    v_pk_add_f32 v[72:73], v[72:73], v[8:9]
    v_lshlrev_b32 v8, 16, v33
    v_and_b32 v9, 0xffff0000, v33
    v_pk_add_f32 v[74:75], v[74:75], v[8:9]
    v_lshlrev_b32 v8, 16, v34
    v_and_b32 v9, 0xffff0000, v34
    v_pk_add_f32 v[76:77], v[76:77], v[8:9]
    v_lshlrev_b32 v8, 16, v35
    v_and_b32 v9, 0xffff0000, v35
    v_pk_add_f32 v[78:79], v[78:79], v[8:9]
    s_waitcnt vmcnt(1)
    v_lshlrev_b32 v8, 16, v36
    v_and_b32 v9, 0xffff0000, v36
    v_pk_add_f32 v[72:73], v[72:73], v[8:9]
    v_lshlrev_b32 v8, 16, v37
    v_and_b32 v9, 0xffff0000, v37
    v_pk_add_f32 v[74:75], v[74:75], v[8:9]
    v_lshlrev_b32 v8, 16, v38
    v_and_b32 v9, 0xffff0000, v38
    v_pk_add_f32 v[76:77], v[76:77], v[8:9]
    v_lshlrev_b32 v8, 16, v39
    v_and_b32 v9, 0xffff0000, v39
    v_pk_add_f32 v[78:79], v[78:79], v[8:9]
    s_waitcnt vmcnt(0)
    v_lshlrev_b32 v8, 16, v40
    v_and_b32 v9, 0xffff0000, v40
    v_pk_add_f32 v[72:73], v[72:73], v[8:9]
    v_lshlrev_b32 v8, 16, v41
    v_and_b32 v9, 0xffff0000, v41
    v_pk_add_f32 v[74:75], v[74:75], v[8:9]
    v_lshlrev_b32 v8, 16, v42
    v_and_b32 v9, 0xffff0000, v42
    v_pk_add_f32 v[76:77], v[76:77], v[8:9]
    v_lshlrev_b32 v8, 16, v43
    v_and_b32 v9, 0xffff0000, v43
    v_pk_add_f32 v[78:79], v[78:79], v[8:9]
    v_mov_b32 v8, v72
    s_nop 1
    v_permlane32_swap_b32 v72, v8
    s_nop 1
    v_add_f32 v72, v72, v8
    v_mov_b32 v8, v72
    s_nop 1
    v_permlane16_swap_b32 v72, v8
    s_nop 1
    v_add_f32 v72, v72, v8
    s_nop 1
    v_add_f32_dpp v72, v72, v72 row_ror:8
    v_mov_b32 v8, v73
    s_nop 1
    v_permlane32_swap_b32 v73, v8
    s_nop 1
    v_add_f32 v73, v73, v8
    v_mov_b32 v8, v73
    s_nop 1
    v_permlane16_swap_b32 v73, v8
    s_nop 1
    v_add_f32 v73, v73, v8
    s_nop 1
    v_add_f32_dpp v73, v73, v73 row_ror:8
    v_mov_b32 v8, v74
    s_nop 1
    v_permlane32_swap_b32 v74, v8
    s_nop 1
    v_add_f32 v74, v74, v8
    v_mov_b32 v8, v74
    s_nop 1
    v_permlane16_swap_b32 v74, v8
    s_nop 1
    v_add_f32 v74, v74, v8
    s_nop 1
    v_add_f32_dpp v74, v74, v74 row_ror:8
    v_mov_b32 v8, v75
    s_nop 1
    v_permlane32_swap_b32 v75, v8
    s_nop 1
    v_add_f32 v75, v75, v8
    v_mov_b32 v8, v75
    s_nop 1
    v_permlane16_swap_b32 v75, v8
    s_nop 1
    v_add_f32 v75, v75, v8
    s_nop 1
    v_add_f32_dpp v75, v75, v75 row_ror:8
    v_mov_b32 v8, v76
    s_nop 1
    v_permlane32_swap_b32 v76, v8
    s_nop 1
    v_add_f32 v76, v76, v8
    v_mov_b32 v8, v76
    s_nop 1
    v_permlane16_swap_b32 v76, v8
    s_nop 1
    v_add_f32 v76, v76, v8
    s_nop 1
    v_add_f32_dpp v76, v76, v76 row_ror:8
    v_mov_b32 v8, v77
    s_nop 1
    v_permlane32_swap_b32 v77, v8
    s_nop 1
    v_add_f32 v77, v77, v8
    v_mov_b32 v8, v77
    s_nop 1
    v_permlane16_swap_b32 v77, v8
    s_nop 1
    v_add_f32 v77, v77, v8
    s_nop 1
    v_add_f32_dpp v77, v77, v77 row_ror:8
    v_mov_b32 v8, v78
    s_nop 1
    v_permlane32_swap_b32 v78, v8
    s_nop 1
    v_add_f32 v78, v78, v8
    v_mov_b32 v8, v78
    s_nop 1
    v_permlane16_swap_b32 v78, v8
    s_nop 1
    v_add_f32 v78, v78, v8
    s_nop 1
    v_add_f32_dpp v78, v78, v78 row_ror:8
    v_mov_b32 v8, v79
    s_nop 1
    v_permlane32_swap_b32 v79, v8
    s_nop 1
    v_add_f32 v79, v79, v8
    v_mov_b32 v8, v79
    s_nop 1
    v_permlane16_swap_b32 v79, v8
    s_nop 1
    v_add_f32 v79, v79, v8
    s_nop 1
    v_add_f32_dpp v79, v79, v79 row_ror:8
    s_lshl_b32 s37, s3, 8
    v_lshl_add_u32 v8, v1, 5, s37
    s_mov_b64 exec, 0xff
    ds_write_b128 v8, v[72:75]
    ds_write_b128 v8, v[76:79] offset:16
    s_mov_b64 exec, -1
    s_waitcnt lgkmcnt(0)
    s_barrier
    s_cmp_lg_u32 s3, 0
    s_cbranch_scc1 Lcw_69
    v_lshlrev_b32 v8, 2, v1
    ds_read_b32 v72, v8 offset:0
    ds_read_b32 v73, v8 offset:256
    ds_read_b32 v74, v8 offset:512
    ds_read_b32 v75, v8 offset:768
    ds_read_b32 v76, v8 offset:1024
    ds_read_b32 v77, v8 offset:1280
    ds_read_b32 v78, v8 offset:1536
    ds_read_b32 v79, v8 offset:1792
    s_waitcnt lgkmcnt(0)
    v_add_f32 v72, v72, v73
    v_add_f32 v72, v72, v74
    v_add_f32 v72, v72, v75
    v_add_f32 v72, v72, v76
    v_add_f32 v72, v72, v77
    v_add_f32 v72, v72, v78
    v_add_f32 v72, v72, v79
    s_lshl_b32 s37, s30, 8
    s_add_u32 s37, s37, 0x1404000
    buffer_store_dword v72, v8, s[12:15], s37 offen sc1
Lcw_69:
Lnocs_68:
    s_waitcnt vmcnt(0)
    s_barrier
    s_lshl_b32 s37, s30, 2
    s_add_u32 s37, s37, 0x1485000
    s_waitcnt lgkmcnt(0)
    s_mul_i32 s29, s29, 0x9E3779B1
    s_add_u32 s29, s29, 0x7F4A7C15
    s_cmp_lg_u32 s3, 0
    s_cbranch_scc1 Lpub_70
    v_mov_b32 v6, s29
    v_mov_b32 v7, 0
    s_mov_b64 exec, 1
    buffer_store_dword v6, v7, s[12:15], s37 offen sc1
    s_mov_b64 exec, -1
Lpub_70:
    s_mov_b32 s4, s74
    s_mov_b32 s5, s75
    s_mov_b32 s6, 0x62000
    s_mov_b32 s7, 0x00020000
    s_mul_i32 s37, s33, 100352
    s_add_u32 s37, s37, s47
    s_mov_b32 s38, 0
Lpf_71:
    buffer_load_dwordx4 v[200:203], v4, s[4:7], s37 offen
    s_add_u32 s37, s37, 8192
    s_waitcnt vmcnt(10)
    s_add_u32 s38, s38, 1
    s_cmp_lt_u32 s38, 13
    s_cbranch_scc1 Lpf_71
    s_mov_b32 s4, s76
    s_mov_b32 s5, s77
    s_mov_b32 s6, 0x188000
    s_mov_b32 s7, 0x00020000
    s_mul_i32 s37, s33, 401408
    s_add_u32 s37, s37, s47
    s_mov_b32 s38, 0
Lpf_72:
    buffer_load_dwordx4 v[200:203], v4, s[4:7], s37 offen
    s_add_u32 s37, s37, 8192
    s_waitcnt vmcnt(10)
    s_add_u32 s38, s38, 1
    s_cmp_lt_u32 s38, 49
    s_cbranch_scc1 Lpf_72
    s_sub_u32 s37, s24, 2
    v_add_u32 v6, s37, v3
    v_max_i32 v6, 0, v6
    v_lshlrev_b32 v6, 7, v6
    v_lshl_add_u32 v6, v2, 2, v6
    v_add_u32 v197, 0x1481000, v6
    s_cmp_lg_u32 s3, 0
    s_cbranch_scc1 Lps_73
    s_mov_b32 exec_lo, 0x3fff3fff
    s_mov_b32 exec_hi, 0x3fff
    s_mov_b32 s63, 0
Lpl_74:
    buffer_load_dword v6, v197, s[12:15], 0 offen sc1
    s_waitcnt vmcnt(0)
    v_cmp_ne_u32 vcc, s29, v6
    s_nop 1
    s_cbranch_vccz Lpd_75
    s_sleep 4
    s_add_u32 s63, s63, 1
    s_cmp_lt_u32 s63, 200000
    s_cbranch_scc1 Lpl_74
    v_mov_b32 v6, 2
    v_mov_b32 v7, 4
    buffer_store_dword v6, v7, s[16:19], 0 offen
Lpd_75:
    s_mov_b64 exec, -1
Lps_73:
    s_barrier
    s_mul_i32 s38, s28, 7
    s_lshr_b32 s38, s38, 1
    v_add_u32 v6, s38, v3
    v_lshlrev_b32 v6, 8, v6
    v_lshl_add_u32 v6, v2, 4, v6
    s_mul_i32 s38, s28, 28
    s_add_u32 s38, s38, 896
    v_lshrrev_b32 v7, 1, v3
    v_lshl_add_u32 v7, v7, 4, v2
    v_add_u32 v7, s38, v7
    v_lshrrev_b32 v8, 4, v7
    v_lshlrev_b32 v8, 9, v8
    v_and_b32 v7, 15, v7
    v_lshl_add_u32 v8, v7, 4, v8
    v_and_b32 v7, 1, v3
    v_lshl_add_u32 v8, v7, 8, v8
    s_lshl_b32 s39, s24, 3
    s_sub_u32 s39, s39, 16
    s_add_u32 s39, s39, s3
    s_add_i32 s40, s39, 0
    s_max_i32 s40, s40, 0
    s_mul_i32 s42, s40, 43008
    s_add_u32 s41, s42, 14336
    s_add_u32 s43, s47, 0
    s_mov_b32 m0, s43
    s_add_u32 s43, s47, 24576
    buffer_load_dwordx4 v6, s[12:15], s41 offen sc1 lds
    s_mov_b32 m0, s43
    s_nop 0
    buffer_load_dwordx4 v8, s[12:15], s42 offen sc1 lds
    s_add_i32 s40, s39, 8
    s_max_i32 s40, s40, 0
    s_mul_i32 s42, s40, 43008
    s_add_u32 s41, s42, 14336
    s_add_u32 s43, s47, 8192
    s_mov_b32 m0, s43
    s_add_u32 s43, s47, 32768
    buffer_load_dwordx4 v6, s[12:15], s41 offen sc1 lds
    s_mov_b32 m0, s43
    s_nop 0
    buffer_load_dwordx4 v8, s[12:15], s42 offen sc1 lds
    s_add_i32 s40, s39, 16
    s_max_i32 s40, s40, 0
    s_mul_i32 s42, s40, 43008
    s_add_u32 s41, s42, 14336
    s_add_u32 s43, s47, 16384
    s_mov_b32 m0, s43
    s_add_u32 s43, s47, 40960
    buffer_load_dwordx4 v6, s[12:15], s41 offen sc1 lds
    s_mov_b32 m0, s43
    s_nop 0
    buffer_load_dwordx4 v8, s[12:15], s42 offen sc1 lds
    s_lshl_b32 s40, s24, 3
    s_add_u32 s40, s40, s3
    s_mul_i32 s41, s40, 43008
    buffer_load_dwordx4 v[184:187], v6, s[12:15], s41 offen sc1
    s_waitcnt vmcnt(0)
    s_barrier
    s_lshl_b32 s40, s24, 3
    s_add_u32 s40, s40, s3
    s_and_b32 s42, s3, 6
    s_and_b32 s43, s3, 1
    s_lshl_b32 s44, s42, 10
    v_add_u32 v136, s44, v4
    v_lshrrev_b32 v6, 1, v3
    v_lshlrev_b32 v6, 10, v6
    v_and_b32 v7, 1, v3
    v_lshl_add_u32 v6, v7, 8, v6
    v_lshl_add_u32 v6, v2, 4, v6
    s_add_u32 s44, s44, 24576
    v_add_u32 v137, s44, v6
    s_and_b32 s44, s28, 1
    s_mul_i32 s46, s44, 3
    s_xor_b32 s46, s46, 3
    v_cmp_ne_u32 vcc, s46, v3
    s_cmp_eq_u32 s44, 0
    s_cselect_b64 s[50:51], -1, vcc
    s_cselect_b64 s[52:53], vcc, -1
    v_cndmask_b32 v184, 0, v184, s[50:51]
    v_cndmask_b32 v185, 0, v185, s[50:51]
    v_cndmask_b32 v186, 0, v186, s[52:53]
    v_cndmask_b32 v187, 0, v187, s[52:53]
    v_mov_b32 v144, 0x3f803f80
    v_mov_b32 v145, 0x3f803f80
    v_mov_b32 v146, 0x3f803f80
    v_mov_b32 v147, 0x3f803f80
    ds_read_b128 v[104:107], v136 offset:0
    ds_read_b128 v[108:111], v136 offset:1024
    s_lshl_b32 s44, s43, 4
    s_add_u32 s44, s44, 256
    v_lshlrev_b32 v6, 2, v3
    v_sub_u32 v138, v2, v6
    v_add_u32 v138, s44, v138
    s_add_u32 s45, s43, 16
    s_sub_i32 s45, s45, s40
    s_max_i32 s45, s45, 0
    v_mov_b32 v139, 0xf149f2ca
    v_subrev_u32 v6, 0, v138
    v_cmp_gt_u32 vcc, 256, v6
    s_nop 1
    v_cndmask_b32 v120, v139, 0, vcc
    v_subrev_u32 v6, 1, v138
    v_cmp_gt_u32 vcc, 256, v6
    s_nop 1
    v_cndmask_b32 v121, v139, 0, vcc
    v_subrev_u32 v6, 2, v138
    v_cmp_gt_u32 vcc, 256, v6
    s_nop 1
    v_cndmask_b32 v122, v139, 0, vcc
    v_subrev_u32 v6, 3, v138
    v_cmp_gt_u32 vcc, 256, v6
    s_nop 1
    v_cndmask_b32 v123, v139, 0, vcc
    v_subrev_u32 v6, 16, v138
    v_cmp_gt_u32 vcc, 256, v6
    s_nop 1
    v_cndmask_b32 v124, v139, 0, vcc
    v_subrev_u32 v6, 17, v138
    v_cmp_gt_u32 vcc, 256, v6
    s_nop 1
    v_cndmask_b32 v125, v139, 0, vcc
    v_subrev_u32 v6, 18, v138
    v_cmp_gt_u32 vcc, 256, v6
    s_nop 1
    v_cndmask_b32 v126, v139, 0, vcc
    v_subrev_u32 v6, 19, v138
    v_cmp_gt_u32 vcc, 256, v6
    s_nop 1
    v_cndmask_b32 v127, v139, 0, vcc
    v_subrev_u32 v6, 256, v138
    v_cmp_gt_u32 vcc, 256, v6
    s_nop 1
    v_cndmask_b32 v128, v139, 0, vcc
    v_subrev_u32 v6, 257, v138
    v_cmp_gt_u32 vcc, 256, v6
    s_nop 1
    v_cndmask_b32 v129, v139, 0, vcc
    v_subrev_u32 v6, 258, v138
    v_cmp_gt_u32 vcc, 256, v6
    s_nop 1
    v_cndmask_b32 v130, v139, 0, vcc
    v_subrev_u32 v6, 259, v138
    v_cmp_gt_u32 vcc, 256, v6
    s_nop 1
    v_cndmask_b32 v131, v139, 0, vcc
    v_subrev_u32 v6, 272, v138
    v_cmp_gt_u32 vcc, 256, v6
    s_nop 1
    v_cndmask_b32 v132, v139, 0, vcc
    v_subrev_u32 v6, 273, v138
    v_cmp_gt_u32 vcc, 256, v6
    s_nop 1
    v_cndmask_b32 v133, v139, 0, vcc
    v_subrev_u32 v6, 274, v138
    v_cmp_gt_u32 vcc, 256, v6
    s_nop 1
    v_cndmask_b32 v134, v139, 0, vcc
    v_subrev_u32 v6, 275, v138
    v_cmp_gt_u32 vcc, 256, v6
    s_nop 1
    v_cndmask_b32 v135, v139, 0, vcc
    s_cmp_gt_i32 s45, 0
    s_cbranch_scc0 Lb_76
    v_mov_b32 v120, v139
    v_mov_b32 v121, v139
    v_mov_b32 v122, v139
    v_mov_b32 v123, v139
Lb_76:
    s_cmp_gt_i32 s45, 1
    s_cbranch_scc0 Lb_77
    v_mov_b32 v124, v139
    v_mov_b32 v125, v139
    v_mov_b32 v126, v139
    v_mov_b32 v127, v139
Lb_77:
    s_nop 1
    ds_read_b128 v[112:115], v136 offset:2048
    s_waitcnt lgkmcnt(2)
    v_mfma_f32_16x16x32_bf16 v[16:19], v[104:107], v[184:187], v[120:123]
    ds_read_b128 v[116:119], v136 offset:3072
    s_waitcnt lgkmcnt(2)
    v_mfma_f32_16x16x32_bf16 v[20:23], v[108:111], v[184:187], v[124:127]
    ds_read_b128 v[104:107], v136 offset:4096
    s_waitcnt lgkmcnt(2)
    v_mfma_f32_16x16x32_bf16 v[24:27], v[112:115], v[184:187], 0
    ds_read_b128 v[108:111], v136 offset:5120
    s_waitcnt lgkmcnt(2)
    v_mfma_f32_16x16x32_bf16 v[28:31], v[116:119], v[184:187], 0
    ds_read_b128 v[112:115], v136 offset:6144
    s_waitcnt lgkmcnt(2)
    v_mfma_f32_16x16x32_bf16 v[32:35], v[104:107], v[184:187], 0
    ds_read_b128 v[116:119], v136 offset:7168
    s_waitcnt lgkmcnt(2)
    v_mfma_f32_16x16x32_bf16 v[36:39], v[108:111], v[184:187], 0
    ds_read_b128 v[104:107], v136 offset:8192
    s_waitcnt lgkmcnt(2)
    v_mfma_f32_16x16x32_bf16 v[40:43], v[112:115], v[184:187], 0
    ds_read_b128 v[108:111], v136 offset:9216
    s_waitcnt lgkmcnt(2)
    v_mfma_f32_16x16x32_bf16 v[44:47], v[116:119], v[184:187], 0
    ds_read_b128 v[112:115], v136 offset:10240
    s_waitcnt lgkmcnt(2)
    v_mfma_f32_16x16x32_bf16 v[48:51], v[104:107], v[184:187], 0
    ds_read_b128 v[116:119], v136 offset:11264
    s_waitcnt lgkmcnt(2)
    v_mfma_f32_16x16x32_bf16 v[52:55], v[108:111], v[184:187], 0
    ds_read_b128 v[104:107], v136 offset:12288
    s_waitcnt lgkmcnt(2)
    v_mfma_f32_16x16x32_bf16 v[56:59], v[112:115], v[184:187], 0
    ds_read_b128 v[108:111], v136 offset:13312
    s_waitcnt lgkmcnt(2)
    v_mfma_f32_16x16x32_bf16 v[60:63], v[116:119], v[184:187], 0
    ds_read_b128 v[112:115], v136 offset:14336
    s_waitcnt lgkmcnt(2)
    v_mfma_f32_16x16x32_bf16 v[64:67], v[104:107], v[184:187], 0
    ds_read_b128 v[116:119], v136 offset:15360
    s_waitcnt lgkmcnt(2)
    v_mfma_f32_16x16x32_bf16 v[68:71], v[108:111], v[184:187], 0
    ds_read_b128 v[104:107], v136 offset:16384
    s_waitcnt lgkmcnt(2)
    v_mfma_f32_16x16x32_bf16 v[72:75], v[112:115], v[184:187], 0
    ds_read_b128 v[108:111], v136 offset:17408
    s_waitcnt lgkmcnt(2)
    v_mfma_f32_16x16x32_bf16 v[76:79], v[116:119], v[184:187], 0
    s_waitcnt lgkmcnt(1)
    v_mfma_f32_16x16x32_bf16 v[80:83], v[104:107], v[184:187], v[128:131]
    s_waitcnt lgkmcnt(0)
    v_mfma_f32_16x16x32_bf16 v[84:87], v[108:111], v[184:187], v[132:135]
    ds_read_b128 v[88:91], v137 offset:0
    ds_read_b128 v[92:95], v137 offset:512
    s_cmp_le_i32 s45, 2
    s_cbranch_scc1 Lnofix_78
    s_nop 7
    s_cmp_gt_i32 s45, 2
    s_cbranch_scc0 Lf_79
    v_mov_b32 v24, v139
    v_mov_b32 v25, v139
    v_mov_b32 v26, v139
    v_mov_b32 v27, v139
Lf_79:
    s_cmp_gt_i32 s45, 3
    s_cbranch_scc0 Lf_80
    v_mov_b32 v28, v139
    v_mov_b32 v29, v139
    v_mov_b32 v30, v139
    v_mov_b32 v31, v139
Lf_80:
    s_cmp_gt_i32 s45, 4
    s_cbranch_scc0 Lf_81
    v_mov_b32 v32, v139
    v_mov_b32 v33, v139
    v_mov_b32 v34, v139
    v_mov_b32 v35, v139
Lf_81:
    s_cmp_gt_i32 s45, 5
    s_cbranch_scc0 Lf_82
    v_mov_b32 v36, v139
    v_mov_b32 v37, v139
    v_mov_b32 v38, v139
    v_mov_b32 v39, v139
Lf_82:
    s_cmp_gt_i32 s45, 6
    s_cbranch_scc0 Lf_83
    v_mov_b32 v40, v139
    v_mov_b32 v41, v139
    v_mov_b32 v42, v139
    v_mov_b32 v43, v139
Lf_83:
    s_cmp_gt_i32 s45, 7
    s_cbranch_scc0 Lf_84
    v_mov_b32 v44, v139
    v_mov_b32 v45, v139
    v_mov_b32 v46, v139
    v_mov_b32 v47, v139
Lf_84:
    s_cmp_gt_i32 s45, 8
    s_cbranch_scc0 Lf_85
    v_mov_b32 v48, v139
    v_mov_b32 v49, v139
    v_mov_b32 v50, v139
    v_mov_b32 v51, v139
Lf_85:
    s_cmp_gt_i32 s45, 9
    s_cbranch_scc0 Lf_86
    v_mov_b32 v52, v139
    v_mov_b32 v53, v139
    v_mov_b32 v54, v139
    v_mov_b32 v55, v139
Lf_86:
    s_cmp_gt_i32 s45, 10
    s_cbranch_scc0 Lf_87
    v_mov_b32 v56, v139
    v_mov_b32 v57, v139
    v_mov_b32 v58, v139
    v_mov_b32 v59, v139
Lf_87:
    s_cmp_gt_i32 s45, 11
    s_cbranch_scc0 Lf_88
    v_mov_b32 v60, v139
    v_mov_b32 v61, v139
    v_mov_b32 v62, v139
    v_mov_b32 v63, v139
Lf_88:
    s_cmp_gt_i32 s45, 12
    s_cbranch_scc0 Lf_89
    v_mov_b32 v64, v139
    v_mov_b32 v65, v139
    v_mov_b32 v66, v139
    v_mov_b32 v67, v139
Lf_89:
    s_cmp_gt_i32 s45, 13
    s_cbranch_scc0 Lf_90
    v_mov_b32 v68, v139
    v_mov_b32 v69, v139
    v_mov_b32 v70, v139
    v_mov_b32 v71, v139
Lf_90:
    s_cmp_gt_i32 s45, 14
    s_cbranch_scc0 Lf_91
    v_mov_b32 v72, v139
    v_mov_b32 v73, v139
    v_mov_b32 v74, v139
    v_mov_b32 v75, v139
Lf_91:
    s_cmp_gt_i32 s45, 15
    s_cbranch_scc0 Lf_92
    v_mov_b32 v76, v139
    v_mov_b32 v77, v139
    v_mov_b32 v78, v139
    v_mov_b32 v79, v139
Lf_92:
Lnofix_78:
    s_nop 7
    v_max3_f32 v140, v16, v17, v18
    v_max3_f32 v141, v19, v20, v21
    v_max3_f32 v140, v140, v22, v23
    v_max3_f32 v141, v141, v24, v25
    v_max3_f32 v140, v140, v26, v27
    v_max3_f32 v141, v141, v28, v29
    v_max3_f32 v140, v140, v30, v31
    v_max3_f32 v141, v141, v32, v33
    v_max3_f32 v140, v140, v34, v35
    v_max3_f32 v141, v141, v36, v37
    v_max3_f32 v140, v140, v38, v39
    v_max3_f32 v141, v141, v40, v41
    v_max3_f32 v140, v140, v42, v43
    v_max3_f32 v141, v141, v44, v45
    v_max3_f32 v140, v140, v46, v47
    v_max3_f32 v141, v141, v48, v49
    v_max3_f32 v140, v140, v50, v51
    v_max3_f32 v141, v141, v52, v53
    v_max3_f32 v140, v140, v54, v55
    v_max3_f32 v141, v141, v56, v57
    v_max3_f32 v140, v140, v58, v59
    v_max3_f32 v141, v141, v60, v61
    v_max3_f32 v140, v140, v62, v63
    v_max3_f32 v141, v141, v64, v65
    v_max3_f32 v140, v140, v66, v67
    v_max3_f32 v141, v141, v68, v69
    v_max3_f32 v140, v140, v70, v71
    v_max3_f32 v141, v141, v72, v73
    v_max3_f32 v140, v140, v74, v75
    v_max3_f32 v141, v141, v76, v77
    v_max3_f32 v140, v140, v78, v79
    v_max3_f32 v141, v141, v80, v81
    v_max3_f32 v140, v140, v82, v83
    v_max3_f32 v141, v141, v84, v85
    v_max3_f32 v140, v140, v86, v87
    v_max_f32 v140, v140, v141
    v_mov_b32 v6, v140
    s_nop 1
    v_permlane32_swap_b32 v140, v6
    s_nop 1
    v_max_f32 v140, v140, v6
    v_mov_b32 v6, v140
    s_nop 1
    v_permlane16_swap_b32 v140, v6
    s_nop 1
    v_max_f32 v140, v140, v6
    s_mov_b32 s46, 0x3e8b97f6
    v_mul_f32 v140, 0xbe8b97f6, v140
    v_fma_f32 v16, v16, s46, v140
    v_fma_f32 v17, v17, s46, v140
    v_fma_f32 v18, v18, s46, v140
    v_fma_f32 v19, v19, s46, v140
    v_fma_f32 v20, v20, s46, v140
    v_fma_f32 v21, v21, s46, v140
    v_fma_f32 v22, v22, s46, v140
    v_fma_f32 v23, v23, s46, v140
    ds_read_b128 v[96:99], v137 offset:2048
    ds_read_b128 v[100:103], v137 offset:2560
    v_exp_f32 v16, v16
    v_exp_f32 v17, v17
    v_exp_f32 v18, v18
    v_exp_f32 v19, v19
    v_exp_f32 v20, v20
    v_exp_f32 v21, v21
    v_exp_f32 v22, v22
    v_exp_f32 v23, v23
    s_nop 0
    v_cvt_pk_bf16_f32 v16, v16, v17
    v_cvt_pk_bf16_f32 v17, v18, v19
    v_cvt_pk_bf16_f32 v18, v20, v21
    v_cvt_pk_bf16_f32 v19, v22, v23
    s_nop 1
    v_permlane32_swap_b32 v16, v18
    v_permlane32_swap_b32 v17, v19
    s_nop 1
    v_permlane16_swap_b32 v16, v18
    v_permlane16_swap_b32 v17, v19
    s_waitcnt lgkmcnt(2)
    s_nop 0
    v_mfma_f32_16x16x32_bf16 v[120:123], v[88:91], v[16:19], 0
    v_mfma_f32_16x16x32_bf16 v[124:127], v[92:95], v[16:19], 0
    v_mfma_f32_16x16x32_bf16 v[148:151], v[144:147], v[16:19], 0
    v_fma_f32 v24, v24, s46, v140
    v_fma_f32 v25, v25, s46, v140
    v_fma_f32 v26, v26, s46, v140
    v_fma_f32 v27, v27, s46, v140
    v_fma_f32 v28, v28, s46, v140
    v_fma_f32 v29, v29, s46, v140
    v_fma_f32 v30, v30, s46, v140
    v_fma_f32 v31, v31, s46, v140
    ds_read_b128 v[88:91], v137 offset:4096
    ds_read_b128 v[92:95], v137 offset:4608
    v_exp_f32 v24, v24
    v_exp_f32 v25, v25
    v_exp_f32 v26, v26
    v_exp_f32 v27, v27
    v_exp_f32 v28, v28
    v_exp_f32 v29, v29
    v_exp_f32 v30, v30
    v_exp_f32 v31, v31
    s_nop 0
    v_cvt_pk_bf16_f32 v24, v24, v25
    v_cvt_pk_bf16_f32 v25, v26, v27
    v_cvt_pk_bf16_f32 v26, v28, v29
    v_cvt_pk_bf16_f32 v27, v30, v31
    s_nop 1
    v_permlane32_swap_b32 v24, v26
    v_permlane32_swap_b32 v25, v27
    s_nop 1
    v_permlane16_swap_b32 v24, v26
    v_permlane16_swap_b32 v25, v27
    s_waitcnt lgkmcnt(2)
    s_nop 0
    v_mfma_f32_16x16x32_bf16 v[120:123], v[96:99], v[24:27], v[120:123]
    v_mfma_f32_16x16x32_bf16 v[124:127], v[100:103], v[24:27], v[124:127]
    v_mfma_f32_16x16x32_bf16 v[148:151], v[144:147], v[24:27], v[148:151]
    v_fma_f32 v32, v32, s46, v140
    v_fma_f32 v33, v33, s46, v140
    v_fma_f32 v34, v34, s46, v140
    v_fma_f32 v35, v35, s46, v140
    v_fma_f32 v36, v36, s46, v140
    v_fma_f32 v37, v37, s46, v140
    v_fma_f32 v38, v38, s46, v140
    v_fma_f32 v39, v39, s46, v140
    ds_read_b128 v[96:99], v137 offset:6144
    ds_read_b128 v[100:103], v137 offset:6656
    v_exp_f32 v32, v32
    v_exp_f32 v33, v33
    v_exp_f32 v34, v34
    v_exp_f32 v35, v35
    v_exp_f32 v36, v36
    v_exp_f32 v37, v37
    v_exp_f32 v38, v38
    v_exp_f32 v39, v39
    s_nop 0
    v_cvt_pk_bf16_f32 v32, v32, v33
    v_cvt_pk_bf16_f32 v33, v34, v35
    v_cvt_pk_bf16_f32 v34, v36, v37
    v_cvt_pk_bf16_f32 v35, v38, v39
    s_nop 1
    v_permlane32_swap_b32 v32, v34
    v_permlane32_swap_b32 v33, v35
    s_nop 1
    v_permlane16_swap_b32 v32, v34
    v_permlane16_swap_b32 v33, v35
    s_waitcnt lgkmcnt(2)
    s_nop 0
    v_mfma_f32_16x16x32_bf16 v[120:123], v[88:91], v[32:35], v[120:123]
    v_mfma_f32_16x16x32_bf16 v[124:127], v[92:95], v[32:35], v[124:127]
    v_mfma_f32_16x16x32_bf16 v[148:151], v[144:147], v[32:35], v[148:151]
    v_fma_f32 v40, v40, s46, v140
    v_fma_f32 v41, v41, s46, v140
    v_fma_f32 v42, v42, s46, v140
    v_fma_f32 v43, v43, s46, v140
    v_fma_f32 v44, v44, s46, v140
    v_fma_f32 v45, v45, s46, v140
    v_fma_f32 v46, v46, s46, v140
    v_fma_f32 v47, v47, s46, v140
    ds_read_b128 v[88:91], v137 offset:8192
    ds_read_b128 v[92:95], v137 offset:8704
    v_exp_f32 v40, v40
    v_exp_f32 v41, v41
    v_exp_f32 v42, v42
    v_exp_f32 v43, v43
    v_exp_f32 v44, v44
    v_exp_f32 v45, v45
    v_exp_f32 v46, v46
    v_exp_f32 v47, v47
    s_nop 0
    v_cvt_pk_bf16_f32 v40, v40, v41
    v_cvt_pk_bf16_f32 v41, v42, v43
    v_cvt_pk_bf16_f32 v42, v44, v45
    v_cvt_pk_bf16_f32 v43, v46, v47
    s_nop 1
    v_permlane32_swap_b32 v40, v42
    v_permlane32_swap_b32 v41, v43
    s_nop 1
    v_permlane16_swap_b32 v40, v42
    v_permlane16_swap_b32 v41, v43
    s_waitcnt lgkmcnt(2)
    s_nop 0
    v_mfma_f32_16x16x32_bf16 v[120:123], v[96:99], v[40:43], v[120:123]
    v_mfma_f32_16x16x32_bf16 v[124:127], v[100:103], v[40:43], v[124:127]
    v_mfma_f32_16x16x32_bf16 v[148:151], v[144:147], v[40:43], v[148:151]
    v_fma_f32 v48, v48, s46, v140
    v_fma_f32 v49, v49, s46, v140
    v_fma_f32 v50, v50, s46, v140
    v_fma_f32 v51, v51, s46, v140
    v_fma_f32 v52, v52, s46, v140
    v_fma_f32 v53, v53, s46, v140
    v_fma_f32 v54, v54, s46, v140
    v_fma_f32 v55, v55, s46, v140
    ds_read_b128 v[96:99], v137 offset:10240
    ds_read_b128 v[100:103], v137 offset:10752
    v_exp_f32 v48, v48
    v_exp_f32 v49, v49
    v_exp_f32 v50, v50
    v_exp_f32 v51, v51
    v_exp_f32 v52, v52
    v_exp_f32 v53, v53
    v_exp_f32 v54, v54
    v_exp_f32 v55, v55
    s_nop 0
    v_cvt_pk_bf16_f32 v48, v48, v49
    v_cvt_pk_bf16_f32 v49, v50, v51
    v_cvt_pk_bf16_f32 v50, v52, v53
    v_cvt_pk_bf16_f32 v51, v54, v55
    s_nop 1
    v_permlane32_swap_b32 v48, v50
    v_permlane32_swap_b32 v49, v51
    s_nop 1
    v_permlane16_swap_b32 v48, v50
    v_permlane16_swap_b32 v49, v51
    s_waitcnt lgkmcnt(2)
    s_nop 0
    v_mfma_f32_16x16x32_bf16 v[120:123], v[88:91], v[48:51], v[120:123]
    v_mfma_f32_16x16x32_bf16 v[124:127], v[92:95], v[48:51], v[124:127]
    v_mfma_f32_16x16x32_bf16 v[148:151], v[144:147], v[48:51], v[148:151]
    v_fma_f32 v56, v56, s46, v140
    v_fma_f32 v57, v57, s46, v140
    v_fma_f32 v58, v58, s46, v140
    v_fma_f32 v59, v59, s46, v140
    v_fma_f32 v60, v60, s46, v140
    v_fma_f32 v61, v61, s46, v140
    v_fma_f32 v62, v62, s46, v140
    v_fma_f32 v63, v63, s46, v140
    ds_read_b128 v[88:91], v137 offset:12288
    ds_read_b128 v[92:95], v137 offset:12800
    v_exp_f32 v56, v56
    v_exp_f32 v57, v57
    v_exp_f32 v58, v58
    v_exp_f32 v59, v59
    v_exp_f32 v60, v60
    v_exp_f32 v61, v61
    v_exp_f32 v62, v62
    v_exp_f32 v63, v63
    s_nop 0
    v_cvt_pk_bf16_f32 v56, v56, v57
    v_cvt_pk_bf16_f32 v57, v58, v59
    v_cvt_pk_bf16_f32 v58, v60, v61
    v_cvt_pk_bf16_f32 v59, v62, v63
    s_nop 1
    v_permlane32_swap_b32 v56, v58
    v_permlane32_swap_b32 v57, v59
    s_nop 1
    v_permlane16_swap_b32 v56, v58
    v_permlane16_swap_b32 v57, v59
    s_waitcnt lgkmcnt(2)
    s_nop 0
    v_mfma_f32_16x16x32_bf16 v[120:123], v[96:99], v[56:59], v[120:123]
    v_mfma_f32_16x16x32_bf16 v[124:127], v[100:103], v[56:59], v[124:127]
    v_mfma_f32_16x16x32_bf16 v[148:151], v[144:147], v[56:59], v[148:151]
    v_fma_f32 v64, v64, s46, v140
    v_fma_f32 v65, v65, s46, v140
    v_fma_f32 v66, v66, s46, v140
    v_fma_f32 v67, v67, s46, v140
    v_fma_f32 v68, v68, s46, v140
    v_fma_f32 v69, v69, s46, v140
    v_fma_f32 v70, v70, s46, v140
    v_fma_f32 v71, v71, s46, v140
    ds_read_b128 v[96:99], v137 offset:14336
    ds_read_b128 v[100:103], v137 offset:14848
    v_exp_f32 v64, v64
    v_exp_f32 v65, v65
    v_exp_f32 v66, v66
    v_exp_f32 v67, v67
    v_exp_f32 v68, v68
    v_exp_f32 v69, v69
    v_exp_f32 v70, v70
    v_exp_f32 v71, v71
    s_nop 0
    v_cvt_pk_bf16_f32 v64, v64, v65
    v_cvt_pk_bf16_f32 v65, v66, v67
    v_cvt_pk_bf16_f32 v66, v68, v69
    v_cvt_pk_bf16_f32 v67, v70, v71
    s_nop 1
    v_permlane32_swap_b32 v64, v66
    v_permlane32_swap_b32 v65, v67
    s_nop 1
    v_permlane16_swap_b32 v64, v66
    v_permlane16_swap_b32 v65, v67
    s_waitcnt lgkmcnt(2)
    s_nop 0
    v_mfma_f32_16x16x32_bf16 v[120:123], v[88:91], v[64:67], v[120:123]
    v_mfma_f32_16x16x32_bf16 v[124:127], v[92:95], v[64:67], v[124:127]
    v_mfma_f32_16x16x32_bf16 v[148:151], v[144:147], v[64:67], v[148:151]
    v_fma_f32 v72, v72, s46, v140
    v_fma_f32 v73, v73, s46, v140
    v_fma_f32 v74, v74, s46, v140
    v_fma_f32 v75, v75, s46, v140
    v_fma_f32 v76, v76, s46, v140
    v_fma_f32 v77, v77, s46, v140
    v_fma_f32 v78, v78, s46, v140
    v_fma_f32 v79, v79, s46, v140
    ds_read_b128 v[88:91], v137 offset:16384
    ds_read_b128 v[92:95], v137 offset:16896
    v_exp_f32 v72, v72
    v_exp_f32 v73, v73
    v_exp_f32 v74, v74
    v_exp_f32 v75, v75
    v_exp_f32 v76, v76
    v_exp_f32 v77, v77
    v_exp_f32 v78, v78
    v_exp_f32 v79, v79
    s_nop 0
    v_cvt_pk_bf16_f32 v72, v72, v73
    v_cvt_pk_bf16_f32 v73, v74, v75
    v_cvt_pk_bf16_f32 v74, v76, v77
    v_cvt_pk_bf16_f32 v75, v78, v79
    s_nop 1
    v_permlane32_swap_b32 v72, v74
    v_permlane32_swap_b32 v73, v75
    s_nop 1
    v_permlane16_swap_b32 v72, v74
    v_permlane16_swap_b32 v73, v75
    s_waitcnt lgkmcnt(2)
    s_nop 0
    v_mfma_f32_16x16x32_bf16 v[120:123], v[96:99], v[72:75], v[120:123]
    v_mfma_f32_16x16x32_bf16 v[124:127], v[100:103], v[72:75], v[124:127]
    v_mfma_f32_16x16x32_bf16 v[148:151], v[144:147], v[72:75], v[148:151]
    v_fma_f32 v80, v80, s46, v140
    v_fma_f32 v81, v81, s46, v140
    v_fma_f32 v82, v82, s46, v140
    v_fma_f32 v83, v83, s46, v140
    v_fma_f32 v84, v84, s46, v140
    v_fma_f32 v85, v85, s46, v140
    v_fma_f32 v86, v86, s46, v140
    v_fma_f32 v87, v87, s46, v140
    v_exp_f32 v80, v80
    v_exp_f32 v81, v81
    v_exp_f32 v82, v82
    v_exp_f32 v83, v83
    v_exp_f32 v84, v84
    v_exp_f32 v85, v85
    v_exp_f32 v86, v86
    v_exp_f32 v87, v87
    s_nop 0
    v_cvt_pk_bf16_f32 v80, v80, v81
    v_cvt_pk_bf16_f32 v81, v82, v83
    v_cvt_pk_bf16_f32 v82, v84, v85
    v_cvt_pk_bf16_f32 v83, v86, v87
    s_nop 1
    v_permlane32_swap_b32 v80, v82
    v_permlane32_swap_b32 v81, v83
    s_nop 1
    v_permlane16_swap_b32 v80, v82
    v_permlane16_swap_b32 v81, v83
    s_waitcnt lgkmcnt(0)
    s_nop 0
    v_mfma_f32_16x16x32_bf16 v[120:123], v[88:91], v[80:83], v[120:123]
    v_mfma_f32_16x16x32_bf16 v[124:127], v[92:95], v[80:83], v[124:127]
    v_mfma_f32_16x16x32_bf16 v[148:151], v[144:147], v[80:83], v[148:151]
    s_mul_i32 s41, s40, 14336
    s_add_u32 s41, s41, 0x800000
    s_mul_i32 s42, s28, 7
    v_add_u32 v6, s42, v3
    v_lshrrev_b32 v7, 1, v6
    v_lshlrev_b32 v10, 8, v7
    v_and_b32 v7, 1, v6
    v_lshl_add_u32 v10, v7, 3, v10
    v_lshl_add_u32 v10, v2, 4, v10
    v_add_u32 v6, s42, v3
    v_add_u32 v6, 4, v6
    v_lshrrev_b32 v7, 1, v6
    v_lshlrev_b32 v11, 8, v7
    v_and_b32 v7, 1, v6
    v_lshl_add_u32 v11, v7, 3, v11
    v_lshl_add_u32 v11, v2, 4, v11
    v_rcp_f32 v8, v148
    s_nop 0
    v_mul_f32 v120, v120, v8
    v_mul_f32 v121, v121, v8
    v_mul_f32 v122, v122, v8
    v_mul_f32 v123, v123, v8
    v_mul_f32 v124, v124, v8
    v_mul_f32 v125, v125, v8
    v_mul_f32 v126, v126, v8
    v_mul_f32 v127, v127, v8
    v_cvt_pk_bf16_f32 v128, v120, v121
    v_cvt_pk_bf16_f32 v129, v122, v123
    v_cvt_pk_bf16_f32 v130, v124, v125
    v_cvt_pk_bf16_f32 v131, v126, v127
    buffer_store_dwordx2 v[128:129], v10, s[12:15], s41 offen sc1
    s_mov_b32 exec_hi, 0xffff
    buffer_store_dwordx2 v[130:131], v11, s[12:15], s41 offen sc1
    s_mov_b64 exec, -1
    s_waitcnt vmcnt(0)
    s_barrier
    s_lshl_b32 s37, s24, 7
    s_lshl_b32 s38, s28, 2
    s_add_u32 s37, s37, s38
    s_add_u32 s37, s37, 0x1483000
    s_cmp_lg_u32 s3, 0
    s_cbranch_scc1 Lpub_93
    v_mov_b32 v6, s29
    v_mov_b32 v7, 0
    s_mov_b64 exec, 1
    buffer_store_dword v6, v7, s[12:15], s37 offen sc1
    s_mov_b64 exec, -1
Lpub_93:
    s_mov_b32 s4, s68
    s_mov_b32 s5, s69
    s_mov_b32 s6, 0x62000
    s_mov_b32 s7, 0x00020000
    s_mul_i32 s37, s33, 100352
    s_add_u32 s37, s37, s47
    s_mov_b32 s38, 0
Lpf_94:
    buffer_load_dwordx4 v[200:203], v4, s[4:7], s37 offen
    s_add_u32 s37, s37, 8192
    s_waitcnt vmcnt(10)
    s_add_u32 s38, s38, 1
    s_cmp_lt_u32 s38, 13
    s_cbranch_scc1 Lpf_94
    s_mov_b32 s4, s78
    s_mov_b32 s5, s79
    s_mov_b32 s6, 0x188000
    s_mov_b32 s7, 0x00020000
    s_mul_i32 s37, s33, 401408
    s_add_u32 s37, s37, s47
    s_mov_b32 s38, 0
Lpf_95:
    buffer_load_dwordx4 v[200:203], v4, s[4:7], s37 offen
    s_add_u32 s37, s37, 8192
    s_waitcnt vmcnt(10)
    s_add_u32 s38, s38, 1
    s_cmp_lt_u32 s38, 49
    s_cbranch_scc1 Lpf_95
    s_cmp_lg_u32 s30, 0
    s_cbranch_scc1 L_end
    v_lshlrev_b32 v8, 7, v3
    v_lshl_add_u32 v8, v2, 2, v8
    v_add_u32 v8, 0x1483000, v8
    s_cmp_lg_u32 s3, 0
    s_cbranch_scc1 Lps_96
    s_mov_b32 exec_lo, 0xffffffff
    s_mov_b32 exec_hi, 0xffffffff
    s_mov_b32 s63, 0
Lpl_97:
    buffer_load_dword v6, v8, s[12:15], 0 offen sc1
    s_waitcnt vmcnt(0)
    v_cmp_ne_u32 vcc, s29, v6
    s_nop 1
    s_cbranch_vccz Lpd_98
    s_sleep 4
    s_add_u32 s63, s63, 1
    s_cmp_lt_u32 s63, 200000
    s_cbranch_scc1 Lpl_97
    v_mov_b32 v6, 6
    v_mov_b32 v7, 4
    buffer_store_dword v6, v7, s[16:19], 0 offen
Lpd_98:
    s_mov_b64 exec, -1
Lps_96:
    s_barrier
    v_lshlrev_b32 v8, 7, v3
    v_lshl_add_u32 v8, v2, 2, v8
    v_add_u32 v8, 0x1483200, v8
    s_cmp_lg_u32 s3, 0
    s_cbranch_scc1 Lps_99
    s_mov_b32 exec_lo, 0xffffffff
    s_mov_b32 exec_hi, 0xffffffff
    s_mov_b32 s63, 0
Lpl_100:
    buffer_load_dword v6, v8, s[12:15], 0 offen sc1
    s_waitcnt vmcnt(0)
    v_cmp_ne_u32 vcc, s29, v6
    s_nop 1
    s_cbranch_vccz Lpd_101
    s_sleep 4
    s_add_u32 s63, s63, 1
    s_cmp_lt_u32 s63, 200000
    s_cbranch_scc1 Lpl_100
    v_mov_b32 v6, 6
    v_mov_b32 v7, 4
    buffer_store_dword v6, v7, s[16:19], 0 offen
Lpd_101:
    s_mov_b64 exec, -1
Lps_99:
    s_barrier
    v_lshlrev_b32 v8, 7, v3
    v_lshl_add_u32 v8, v2, 2, v8
    v_add_u32 v8, 0x1483400, v8
    s_cmp_lg_u32 s3, 0
    s_cbranch_scc1 Lps_102
    s_mov_b32 exec_lo, 0xffffffff
    s_mov_b32 exec_hi, 0xffffffff
    s_mov_b32 s63, 0
Lpl_103:
    buffer_load_dword v6, v8, s[12:15], 0 offen sc1
    s_waitcnt vmcnt(0)
    v_cmp_ne_u32 vcc, s29, v6
    s_nop 1
    s_cbranch_vccz Lpd_104
    s_sleep 4
    s_add_u32 s63, s63, 1
    s_cmp_lt_u32 s63, 200000
    s_cbranch_scc1 Lpl_103
    v_mov_b32 v6, 6
    v_mov_b32 v7, 4
    buffer_store_dword v6, v7, s[16:19], 0 offen
Lpd_104:
    s_mov_b64 exec, -1
Lps_102:
    s_barrier
    v_lshlrev_b32 v8, 7, v3
    v_lshl_add_u32 v8, v2, 2, v8
    v_add_u32 v8, 0x1483600, v8
    s_cmp_lg_u32 s3, 0
    s_cbranch_scc1 Lps_105
    s_mov_b32 exec_lo, 0xffffffff
    s_mov_b32 exec_hi, 0xffffffff
    s_mov_b32 s63, 0
Lpl_106:
    buffer_load_dword v6, v8, s[12:15], 0 offen sc1
    s_waitcnt vmcnt(0)
    v_cmp_ne_u32 vcc, s29, v6
    s_nop 1
    s_cbranch_vccz Lpd_107
    s_sleep 4
    s_add_u32 s63, s63, 1
    s_cmp_lt_u32 s63, 200000
    s_cbranch_scc1 Lpl_106
    v_mov_b32 v6, 6
    v_mov_b32 v7, 4
    buffer_store_dword v6, v7, s[16:19], 0 offen
Lpd_107:
    s_mov_b64 exec, -1
Lps_105:
    s_barrier
    s_mov_b32 s37, 0x1486000
    s_cmp_lg_u32 s3, 0
    s_cbranch_scc1 Lpub_108
    v_mov_b32 v6, s29
    v_mov_b32 v7, 0
    s_mov_b64 exec, 1
    buffer_store_dword v6, v7, s[12:15], s37 offen sc1
    s_mov_b64 exec, -1
Lpub_108:
L_end:
    s_endpgm

.section .rodata,"a"
.p2align 6
.amdhsa_kernel gated_mix__sliding_block__mixer_s_mlp__prompt_kernel
  .amdhsa_next_free_vgpr 256
  .amdhsa_next_free_sgpr 102
  .amdhsa_accum_offset 256
  .amdhsa_group_segment_fixed_size 0
  .amdhsa_kernarg_size 96
  .amdhsa_user_sgpr_count 2
  .amdhsa_user_sgpr_kernarg_segment_ptr 1
  .amdhsa_system_sgpr_workgroup_id_x 1
.end_amdhsa_kernel
```
